```python
import torch

def _softmax(x, axis=-1):
    return torch.softmax(x, dim=axis)

def _gelu(x):
    return torch.nn.functional.gelu(x, approximate='tanh')

def _silu(x):
    return torch.nn.functional.silu(x)

def _sigmoid(x):
    return torch.sigmoid(x)

def _layernorm(x, axis=-1, eps=1e-05):
    m = x.mean(dim=axis, keepdim=True)
    v = x.var(dim=axis, keepdim=True, unbiased=False)
    return (x - m) / torch.sqrt(v + eps)

def _scatter_add(tgt, idx, src, axis=0):
    return tgt.clone().index_add_(axis, idx, src)

def _segment_sum(src, seg, n):
    out = torch.zeros((n,) + src.shape[1:], dtype=src.dtype)
    return out.index_add_(0, seg, src)

def _pad(x, pw):
    flat = tuple((v for pair in reversed(pw) for v in pair))
    return torch.nn.functional.pad(x, flat)
kernel_name = 'parallel_sum__memory_aug_recurrent_mem_tr__dense_activation_silu__prompt'

def setup_inputs():

    _w = lambda a: (lambda t: t.to(torch.bfloat16) if t.is_floating_point() else t)(torch.as_tensor(a))

    def _A_setup():
        B, S, Dm = (1, 2048, 512)
        H, Dh = (32, 128)
        M, seg = (8, 32)
        seg = min(seg, S)
        S = S // seg * seg
        return {'x': _w((lambda *s: torch.randn(*s, dtype=torch.bfloat16) * 0.05)(B, S, Dm)), 'mem0': _w((lambda *s: torch.randn(*s, dtype=torch.bfloat16) * 0.4)(B, M, Dm)), 'Wq': _w((lambda *s: torch.randn(*s, dtype=torch.bfloat16) * 3.2)(Dm, H, Dh) * Dm ** (-0.5)), 'Wk': _w((lambda *s: torch.randn(*s, dtype=torch.bfloat16) * 3.2)(Dm, H, Dh) * Dm ** (-0.5)), 'Wv': _w((lambda *s: torch.randn(*s, dtype=torch.bfloat16) * 0.4)(Dm, H, Dh) * Dm ** (-0.5)), 'Wo': _w((lambda *s: torch.randn(*s, dtype=torch.bfloat16) * 0.4)(H, Dh, Dm) * (H * Dh) ** (-0.5)), 'seg_len': seg}
    _A_in = _A_setup()

    def _B_setup():
        B, S, D, F = (1, 2048, 512, 1792)
        return {'x': _w((lambda *s: torch.randn(*s, dtype=torch.bfloat16) * 0.05)(B, S, D)), 'w1': _w((lambda *s: torch.randn(*s, dtype=torch.bfloat16) * 1.6)(D, F) * D ** (-0.5)), 'w2': _w((lambda *s: torch.randn(*s, dtype=torch.bfloat16) * 0.1)(F, D) * F ** (-0.5))}
    _B_in = _B_setup()
    return {'A_x': _A_in['x'], 'A_mem0': _A_in['mem0'], 'A_Wq': _A_in['Wq'], 'A_Wk': _A_in['Wk'], 'A_Wv': _A_in['Wv'], 'A_Wo': _A_in['Wo'], 'A_seg_len': _A_in['seg_len'], 'B_x': _B_in['x'], 'B_w1': _B_in['w1'], 'B_w2': _B_in['w2']}

def reference(A_x, A_mem0, A_Wq, A_Wk, A_Wv, A_Wo, A_seg_len, B_x, B_w1, B_w2):

    def _A_ref(x, mem0, Wq, Wk, Wv, Wo, seg_len):
        B, S, Dm = x.shape
        H, Dh = (Wq.shape[1], Wq.shape[2])
        M = mem0.shape[1]
        scale = Dh ** (-0.5)
        n_seg = S // seg_len
        L = M + seg_len
        idx = torch.arange(L)
        mask = (idx[:, None] < M) | (idx[:, None] >= idx[None, :])
        mem = mem0
        outs = []
        for s in range(n_seg):
            xs = x[:, s * seg_len:(s + 1) * seg_len, :].clone()
            h = torch.concatenate([mem, xs], axis=1)
            q = torch.einsum('btd,dhe->bhte', h, Wq)
            k = torch.einsum('btd,dhe->bhte', h, Wk)
            v = torch.einsum('btd,dhe->bhte', h, Wv)
            scores = torch.einsum('bhqe,bhke->bhqk', q, k) * scale
            scores = torch.where(mask[None, None], scores, -1000000000.0)
            p = _softmax(scores, axis=-1)
            o = torch.einsum('bhqk,bhke->bhqe', p, v)
            o = torch.einsum('bhte,hed->btd', o, Wo)
            mem = o[:, :M, :].clone()
            outs.append(o[:, M:, :])
        return torch.concatenate(outs, axis=1)

    def _B_ref(x, w1, w2):
        h = torch.einsum('bsd,df->bsf', x, w1)
        h = _silu(h)
        out = torch.einsum('bsf,fd->bsd', h, w2)
        return out
    x = A_x
    xn = _layernorm(x, axis=-1)
    return x + _A_ref(xn, A_mem0, A_Wq, A_Wk, A_Wv, A_Wo, A_seg_len) + _B_ref(xn, B_w1, B_w2)
```

```asm
; @launch grid=(256,1,1) block=(256,1,1) lds=163840
.amdgcn_target "amdgcn-amd-amdhsa--gfx950"
.text
.globl parallel_sum__memory_aug_recurrent_mem_tr__dense_activation_silu__prompt_kernel
.p2align 8
.type parallel_sum__memory_aug_recurrent_mem_tr__dense_activation_silu__prompt_kernel,@function
parallel_sum__memory_aug_recurrent_mem_tr__dense_activation_silu__prompt_kernel:
    s_cmp_ge_u32 s2, 256
    s_cbranch_scc1 L_rec_exit
    s_load_dwordx4 s[52:55], s[0:1], 0
    s_load_dwordx8 s[16:23], s[0:1], 16
    s_load_dwordx4 s[36:39], s[0:1], 88
    s_load_dwordx2 s[50:51], s[0:1], 64
    v_lshrrev_b32 v1, 6, v0
    v_and_b32 v99, 63, v0
    s_getreg_b32 s47, hwreg(HW_REG_XCC_ID)
    v_readfirstlane_b32 s25, v1
    s_and_b32 s47, s47, 15
    v_and_b32 v2, 3, v0
    v_lshl_add_u32 v6, v1, 2, v2
    v_bfe_u32 v2, v0, 2, 4
    v_lshlrev_b32 v3, 10, v6
    v_lshl_add_u32 v3, v2, 4, v3
    v_lshlrev_b32 v4, 8, v2
    v_lshl_add_u32 v4, v6, 4, v4
    s_lshl_b32 s3, s2, 14
    s_waitcnt lgkmcnt(0)
    s_mov_b32 s4, s38
    s_mov_b32 s5, s39
    s_mov_b32 s6, 268435456
    s_mov_b32 s7, 0x20000
    s_mov_b32 s8, s36
    s_mov_b32 s9, s37
    s_mov_b32 s10, 256
    s_mov_b32 s11, 0x20000
    s_mov_b32 s12, s52
    s_mov_b32 s13, s53
    s_mov_b32 s14, 0x200000
    s_mov_b32 s15, 0x20000
    buffer_load_dwordx4 v[8:11], v3, s[12:15], s3 offen offset:0
    buffer_load_dwordx4 v[12:15], v3, s[12:15], s3 offen offset:256
    buffer_load_dwordx4 v[16:19], v3, s[12:15], s3 offen offset:512
    buffer_load_dwordx4 v[20:23], v3, s[12:15], s3 offen offset:768
    v_mov_b32 v98, 0
    v_mov_b32 v97, 32
    s_mov_b32 s74, 0
    s_or_b32 s34, s25, s47
    s_cmp_lg_u32 s34, 0
    s_cbranch_scc1 L_el_skip
    s_mov_b32 s74, 1
    v_mov_b32 v97, 1
    s_mov_b64 exec, 1
    buffer_atomic_add v97, v98, s[8:11], 0 offen offset:0 sc0
    s_mov_b64 exec, -1
L_el_skip:
    s_cmp_ge_u32 s2, 128
    s_cbranch_scc1 L_no_ln
    s_waitcnt vmcnt(1)
    s_cmp_eq_u32 s74, 1
    s_cbranch_scc1 L_ln_go
    s_waitcnt vmcnt(0)
L_ln_go:
    v_lshlrev_b32 v24, 16, v8
    v_and_b32 v25, 0xffff0000, v8
    v_lshlrev_b32 v26, 16, v9
    v_and_b32 v27, 0xffff0000, v9
    v_lshlrev_b32 v28, 16, v10
    v_and_b32 v29, 0xffff0000, v10
    v_lshlrev_b32 v30, 16, v11
    v_and_b32 v31, 0xffff0000, v11
    v_lshlrev_b32 v32, 16, v12
    v_and_b32 v33, 0xffff0000, v12
    v_lshlrev_b32 v34, 16, v13
    v_and_b32 v35, 0xffff0000, v13
    v_lshlrev_b32 v36, 16, v14
    v_and_b32 v37, 0xffff0000, v14
    v_lshlrev_b32 v38, 16, v15
    v_and_b32 v39, 0xffff0000, v15
    v_lshlrev_b32 v40, 16, v16
    v_and_b32 v41, 0xffff0000, v16
    v_lshlrev_b32 v42, 16, v17
    v_and_b32 v43, 0xffff0000, v17
    v_lshlrev_b32 v44, 16, v18
    v_and_b32 v45, 0xffff0000, v18
    v_lshlrev_b32 v46, 16, v19
    v_and_b32 v47, 0xffff0000, v19
    v_lshlrev_b32 v48, 16, v20
    v_and_b32 v49, 0xffff0000, v20
    v_lshlrev_b32 v50, 16, v21
    v_and_b32 v51, 0xffff0000, v21
    v_lshlrev_b32 v52, 16, v22
    v_and_b32 v53, 0xffff0000, v22
    v_lshlrev_b32 v54, 16, v23
    v_and_b32 v55, 0xffff0000, v23
    v_add_f32 v56, v24, v40
    v_add_f32 v57, v25, v41
    v_add_f32 v58, v26, v42
    v_add_f32 v59, v27, v43
    v_add_f32 v60, v28, v44
    v_add_f32 v61, v29, v45
    v_add_f32 v62, v30, v46
    v_add_f32 v63, v31, v47
    v_add_f32 v64, v32, v48
    v_add_f32 v65, v33, v49
    v_add_f32 v66, v34, v50
    v_add_f32 v67, v35, v51
    v_add_f32 v68, v36, v52
    v_add_f32 v69, v37, v53
    v_add_f32 v70, v38, v54
    v_add_f32 v71, v39, v55
    v_add_f32 v56, v56, v64
    v_add_f32 v57, v57, v65
    v_add_f32 v58, v58, v66
    v_add_f32 v59, v59, v67
    v_add_f32 v60, v60, v68
    v_add_f32 v61, v61, v69
    v_add_f32 v62, v62, v70
    v_add_f32 v63, v63, v71
    v_add_f32 v56, v56, v60
    v_add_f32 v57, v57, v61
    v_add_f32 v58, v58, v62
    v_add_f32 v59, v59, v63
    v_add_f32 v56, v56, v58
    v_add_f32 v57, v57, v59
    v_add_f32 v56, v56, v57
    v_mov_b32 v5, v56
    s_nop 1
    v_add_f32_dpp v5, v5, v5 row_ror:4 row_mask:0xf bank_mask:0xf
    s_nop 1
    v_add_f32_dpp v5, v5, v5 row_ror:8 row_mask:0xf bank_mask:0xf
    v_mov_b32 v6, v5
    s_nop 1
    v_permlane16_swap_b32 v5, v6
    v_add_f32 v5, v5, v6
    v_mov_b32 v6, v5
    s_nop 1
    v_permlane32_swap_b32 v5, v6
    v_add_f32 v5, v5, v6
    v_mul_f32 v5, 989855744, v5
    v_sub_f32 v56, v24, v5
    v_sub_f32 v57, v25, v5
    v_sub_f32 v58, v26, v5
    v_sub_f32 v59, v27, v5
    v_sub_f32 v60, v28, v5
    v_sub_f32 v61, v29, v5
    v_sub_f32 v62, v30, v5
    v_sub_f32 v63, v31, v5
    v_sub_f32 v64, v32, v5
    v_sub_f32 v65, v33, v5
    v_sub_f32 v66, v34, v5
    v_sub_f32 v67, v35, v5
    v_sub_f32 v68, v36, v5
    v_sub_f32 v69, v37, v5
    v_sub_f32 v70, v38, v5
    v_sub_f32 v71, v39, v5
    v_sub_f32 v72, v40, v5
    v_sub_f32 v73, v41, v5
    v_sub_f32 v74, v42, v5
    v_sub_f32 v75, v43, v5
    v_sub_f32 v76, v44, v5
    v_sub_f32 v77, v45, v5
    v_sub_f32 v78, v46, v5
    v_sub_f32 v79, v47, v5
    v_sub_f32 v80, v48, v5
    v_sub_f32 v81, v49, v5
    v_sub_f32 v82, v50, v5
    v_sub_f32 v83, v51, v5
    v_sub_f32 v84, v52, v5
    v_sub_f32 v85, v53, v5
    v_sub_f32 v86, v54, v5
    v_sub_f32 v87, v55, v5
    v_mul_f32 v7, v56, v56
    v_mul_f32 v2, v57, v57
    v_fmac_f32 v7, v58, v58
    v_fmac_f32 v2, v59, v59
    v_fmac_f32 v7, v60, v60
    v_fmac_f32 v2, v61, v61
    v_fmac_f32 v7, v62, v62
    v_fmac_f32 v2, v63, v63
    v_fmac_f32 v7, v64, v64
    v_fmac_f32 v2, v65, v65
    v_fmac_f32 v7, v66, v66
    v_fmac_f32 v2, v67, v67
    v_fmac_f32 v7, v68, v68
    v_fmac_f32 v2, v69, v69
    v_fmac_f32 v7, v70, v70
    v_fmac_f32 v2, v71, v71
    v_fmac_f32 v7, v72, v72
    v_fmac_f32 v2, v73, v73
    v_fmac_f32 v7, v74, v74
    v_fmac_f32 v2, v75, v75
    v_fmac_f32 v7, v76, v76
    v_fmac_f32 v2, v77, v77
    v_fmac_f32 v7, v78, v78
    v_fmac_f32 v2, v79, v79
    v_fmac_f32 v7, v80, v80
    v_fmac_f32 v2, v81, v81
    v_fmac_f32 v7, v82, v82
    v_fmac_f32 v2, v83, v83
    v_fmac_f32 v7, v84, v84
    v_fmac_f32 v2, v85, v85
    v_fmac_f32 v7, v86, v86
    v_fmac_f32 v2, v87, v87
    v_add_f32 v7, v7, v2
    s_nop 1
    v_add_f32_dpp v7, v7, v7 row_ror:4 row_mask:0xf bank_mask:0xf
    s_nop 1
    v_add_f32_dpp v7, v7, v7 row_ror:8 row_mask:0xf bank_mask:0xf
    v_mov_b32 v6, v7
    s_nop 1
    v_permlane16_swap_b32 v7, v6
    v_add_f32 v7, v7, v6
    v_mov_b32 v6, v7
    s_nop 1
    v_permlane32_swap_b32 v7, v6
    v_add_f32 v7, v7, v6
    v_mul_f32 v7, 989855744, v7
    v_cvt_pk_bf16_f32 v5, v5, v5
    v_and_b32 v5, 0xffff0000, v5
    v_cvt_pk_bf16_f32 v7, v7, v7
    v_and_b32 v7, 0xffff0000, v7
    v_add_f32 v7, 925353388, v7
    v_cvt_pk_bf16_f32 v7, v7, v7
    v_and_b32 v7, 0xffff0000, v7
    v_sqrt_f32 v7, v7
    s_nop 0
    v_cvt_pk_bf16_f32 v7, v7, v7
    v_and_b32 v7, 0xffff0000, v7
    v_rcp_f32 v7, v7
    v_sub_f32 v24, v24, v5
    v_sub_f32 v25, v25, v5
    v_sub_f32 v26, v26, v5
    v_sub_f32 v27, v27, v5
    v_sub_f32 v28, v28, v5
    v_sub_f32 v29, v29, v5
    v_sub_f32 v30, v30, v5
    v_sub_f32 v31, v31, v5
    v_sub_f32 v32, v32, v5
    v_sub_f32 v33, v33, v5
    v_sub_f32 v34, v34, v5
    v_sub_f32 v35, v35, v5
    v_sub_f32 v36, v36, v5
    v_sub_f32 v37, v37, v5
    v_sub_f32 v38, v38, v5
    v_sub_f32 v39, v39, v5
    v_sub_f32 v40, v40, v5
    v_sub_f32 v41, v41, v5
    v_sub_f32 v42, v42, v5
    v_sub_f32 v43, v43, v5
    v_sub_f32 v44, v44, v5
    v_sub_f32 v45, v45, v5
    v_sub_f32 v46, v46, v5
    v_sub_f32 v47, v47, v5
    v_sub_f32 v48, v48, v5
    v_sub_f32 v49, v49, v5
    v_sub_f32 v50, v50, v5
    v_sub_f32 v51, v51, v5
    v_sub_f32 v52, v52, v5
    v_sub_f32 v53, v53, v5
    v_sub_f32 v54, v54, v5
    v_sub_f32 v55, v55, v5
    v_cvt_pk_bf16_f32 v8, v24, v25
    v_cvt_pk_bf16_f32 v9, v26, v27
    v_cvt_pk_bf16_f32 v10, v28, v29
    v_cvt_pk_bf16_f32 v11, v30, v31
    v_cvt_pk_bf16_f32 v12, v32, v33
    v_cvt_pk_bf16_f32 v13, v34, v35
    v_cvt_pk_bf16_f32 v14, v36, v37
    v_cvt_pk_bf16_f32 v15, v38, v39
    v_cvt_pk_bf16_f32 v16, v40, v41
    v_cvt_pk_bf16_f32 v17, v42, v43
    v_cvt_pk_bf16_f32 v18, v44, v45
    v_cvt_pk_bf16_f32 v19, v46, v47
    v_cvt_pk_bf16_f32 v20, v48, v49
    v_cvt_pk_bf16_f32 v21, v50, v51
    v_cvt_pk_bf16_f32 v22, v52, v53
    v_cvt_pk_bf16_f32 v23, v54, v55
    v_lshlrev_b32 v24, 16, v8
    v_and_b32 v25, 0xffff0000, v8
    v_lshlrev_b32 v26, 16, v9
    v_and_b32 v27, 0xffff0000, v9
    v_lshlrev_b32 v28, 16, v10
    v_and_b32 v29, 0xffff0000, v10
    v_lshlrev_b32 v30, 16, v11
    v_and_b32 v31, 0xffff0000, v11
    v_lshlrev_b32 v32, 16, v12
    v_and_b32 v33, 0xffff0000, v12
    v_lshlrev_b32 v34, 16, v13
    v_and_b32 v35, 0xffff0000, v13
    v_lshlrev_b32 v36, 16, v14
    v_and_b32 v37, 0xffff0000, v14
    v_lshlrev_b32 v38, 16, v15
    v_and_b32 v39, 0xffff0000, v15
    v_lshlrev_b32 v40, 16, v16
    v_and_b32 v41, 0xffff0000, v16
    v_lshlrev_b32 v42, 16, v17
    v_and_b32 v43, 0xffff0000, v17
    v_lshlrev_b32 v44, 16, v18
    v_and_b32 v45, 0xffff0000, v18
    v_lshlrev_b32 v46, 16, v19
    v_and_b32 v47, 0xffff0000, v19
    v_lshlrev_b32 v48, 16, v20
    v_and_b32 v49, 0xffff0000, v20
    v_lshlrev_b32 v50, 16, v21
    v_and_b32 v51, 0xffff0000, v21
    v_lshlrev_b32 v52, 16, v22
    v_and_b32 v53, 0xffff0000, v22
    v_lshlrev_b32 v54, 16, v23
    v_and_b32 v55, 0xffff0000, v23
    v_mul_f32 v24, v24, v7
    v_mul_f32 v25, v25, v7
    v_mul_f32 v26, v26, v7
    v_mul_f32 v27, v27, v7
    v_mul_f32 v28, v28, v7
    v_mul_f32 v29, v29, v7
    v_mul_f32 v30, v30, v7
    v_mul_f32 v31, v31, v7
    v_mul_f32 v32, v32, v7
    v_mul_f32 v33, v33, v7
    v_mul_f32 v34, v34, v7
    v_mul_f32 v35, v35, v7
    v_mul_f32 v36, v36, v7
    v_mul_f32 v37, v37, v7
    v_mul_f32 v38, v38, v7
    v_mul_f32 v39, v39, v7
    v_mul_f32 v40, v40, v7
    v_mul_f32 v41, v41, v7
    v_mul_f32 v42, v42, v7
    v_mul_f32 v43, v43, v7
    v_mul_f32 v44, v44, v7
    v_mul_f32 v45, v45, v7
    v_mul_f32 v46, v46, v7
    v_mul_f32 v47, v47, v7
    v_mul_f32 v48, v48, v7
    v_mul_f32 v49, v49, v7
    v_mul_f32 v50, v50, v7
    v_mul_f32 v51, v51, v7
    v_mul_f32 v52, v52, v7
    v_mul_f32 v53, v53, v7
    v_mul_f32 v54, v54, v7
    v_mul_f32 v55, v55, v7
    v_cvt_pk_bf16_f32 v8, v24, v25
    v_cvt_pk_bf16_f32 v9, v26, v27
    v_cvt_pk_bf16_f32 v10, v28, v29
    v_cvt_pk_bf16_f32 v11, v30, v31
    v_cvt_pk_bf16_f32 v12, v32, v33
    v_cvt_pk_bf16_f32 v13, v34, v35
    v_cvt_pk_bf16_f32 v14, v36, v37
    v_cvt_pk_bf16_f32 v15, v38, v39
    v_cvt_pk_bf16_f32 v16, v40, v41
    v_cvt_pk_bf16_f32 v17, v42, v43
    v_cvt_pk_bf16_f32 v18, v44, v45
    v_cvt_pk_bf16_f32 v19, v46, v47
    v_cvt_pk_bf16_f32 v20, v48, v49
    v_cvt_pk_bf16_f32 v21, v50, v51
    v_cvt_pk_bf16_f32 v22, v52, v53
    v_cvt_pk_bf16_f32 v23, v54, v55
    s_add_u32 s3, s3, 0
    buffer_store_dwordx4 v[8:11], v4, s[4:7], s3 offen sc1
    s_add_u32 s3, s3, 4096
    buffer_store_dwordx4 v[12:15], v4, s[4:7], s3 offen sc1
    s_add_u32 s3, s3, 4096
    buffer_store_dwordx4 v[16:19], v4, s[4:7], s3 offen sc1
    s_add_u32 s3, s3, 4096
    buffer_store_dwordx4 v[20:23], v4, s[4:7], s3 offen sc1
    buffer_load_dword v96, off, s[8:11], 0 offset:128 sc0 sc1
    s_lshr_b32 s75, s2, 3
    s_lshl_b32 s75, s75, 7
    s_add_u32 s75, s75, 87109632
    s_branch L_sig
L_no_ln:
    s_waitcnt vmcnt(0)
    s_mov_b32 s75, 0x7ffffff0
    s_cmp_lg_u32 s2, 128
    s_cbranch_scc1 L_pf
    v_lshlrev_b32 v5, 4, v0
    v_mov_b32 v8, 0
    v_mov_b32 v9, 0
    v_mov_b32 v10, 0
    v_mov_b32 v11, 0
    s_mov_b32 s34, 87097344
    buffer_store_dwordx4 v[8:11], v5, s[4:7], s34 offen sc1
    s_add_u32 s34, s34, 4096
    buffer_store_dwordx4 v[8:11], v5, s[4:7], s34 offen sc1
    s_add_u32 s34, s34, 4096
    buffer_store_dwordx4 v[8:11], v5, s[4:7], s34 offen sc1
    s_add_u32 s34, s34, 4096
    buffer_store_dwordx4 v[8:11], v5, s[4:7], s34 offen sc1
    v_mov_b32 v12, 1
    s_waitcnt vmcnt(0)
    s_barrier
    buffer_store_dword v12, off, s[8:11], 0 offset:128 sc1
L_sig:
    s_cmp_lg_u32 s47, 0
    s_cbranch_scc1 L_wk_entry
    s_waitcnt vmcnt(5)
    s_cmp_lg_u32 s25, 0
    s_cbranch_scc1 L_rec_elected
    v_mov_b32 v2, 31744
    s_mov_b64 exec, 1
    ds_write_b32 v2, v97
    s_mov_b64 exec, -1
    s_waitcnt lgkmcnt(0)
L_rec_elected:
    s_barrier
    v_mov_b32 v2, 31744
    ds_read_b32 v1, v2
    s_mov_b32 s14, 0x400000
    s_waitcnt lgkmcnt(0)
    v_readfirstlane_b32 s48, v1
    s_nop 0
    s_cmp_ge_u32 s48, 32
    s_cbranch_scc1 L_wk_entry
L_rec_start:
    s_and_b32 s24, s48, 31
    v_lshrrev_b32 v100, 4, v99
    v_bfe_u32 v101, v99, 2, 2
    v_and_b32 v102, 3, v99
    v_and_b32 v103, 1, v100
    v_lshl_or_b32 v103, v103, 2, v101
    v_lshl_add_u32 v104, v100, 4, v101
    v_lshlrev_b32 v104, 8, v104
    v_lshl_add_u32 v104, v102, 3, v104
    s_lshl_b32 s34, s25, 1
    v_xor_b32 v109, s34, v103
    v_lshl_add_u32 v109, v109, 5, v104
    s_or_b32 s34, s34, 1
    v_xor_b32 v110, s34, v103
    v_lshl_add_u32 v110, v110, 5, v104
    s_lshl_b32 s37, s25, 15
    v_add_u32 v111, s37, v104
    v_and_b32 v113, 15, v99
    v_lshlrev_b32 v25, 1, v100
    v_xor_b32 v24, v113, v25
    v_lshlrev_b32 v24, 4, v24
    v_xor_b32 v25, 0x80, v24
    v_lshrrev_b32 v26, 1, v100
    v_and_b32 v27, 1, v100
    v_lshlrev_b32 v115, 14, v26
    v_lshl_add_u32 v115, v27, 17, v115
    s_lshl_b32 s34, s25, 20
    s_lshl_b32 s35, s24, 8
    s_add_u32 s34, s34, s35
    v_add_u32 v115, s34, v115
    v_add_u32 v105, v115, v24
    v_add_u32 v106, v115, v25
    v_lshlrev_b32 v115, 15, v26
    v_lshl_add_u32 v115, v27, 10, v115
    s_lshl_b32 s34, s24, 17
    s_lshl_b32 s35, s25, 8
    s_add_u32 s34, s34, s35
    v_add_u32 v115, s34, v115
    v_add_u32 v107, v115, v24
    v_add_u32 v108, v115, v25
    s_cmp_eq_u32 s75, 0x7ffffff0
    s_cbranch_scc1 L_skipsig
    s_waitcnt vmcnt(0)
    s_barrier
    s_cmp_lg_u32 s25, 1
    s_cbranch_scc1 L_nosig_r
    s_cmp_eq_u32 s75, 0x7ffffff0
    s_cbranch_scc1 L_nosig_r
    s_mov_b32 s46, 0
    s_branch L_sigc_r
L_sigp_r:
    buffer_load_dword v96, off, s[8:11], 0 offset:128 sc0 sc1
    s_add_u32 s46, s46, 1
    s_cmp_lt_u32 s46, 262144
    s_cbranch_scc0 L_rec_exit
    s_waitcnt vmcnt(0)
L_sigc_r:
    v_readfirstlane_b32 s34, v96
    s_nop 0
    s_cmp_eq_u32 s34, 0
    s_cbranch_scc1 L_sigp_r
    s_mov_b64 exec, 1
    buffer_atomic_add v96, v98, s[4:7], s75 offen
    s_mov_b64 exec, -1
L_nosig_r:
    s_mov_b32 s75, 0x7ffffff0
L_skipsig:
    s_mov_b32 s12, s16
    s_mov_b32 s13, s17
    s_add_u32 m0, s37, 32768
    s_mov_b32 s34, 0
    buffer_load_dwordx4 v105, s[12:15], s34 offen lds
    s_add_u32 m0, s37, 33792
    s_mov_b32 s34, 262144
    buffer_load_dwordx4 v105, s[12:15], s34 offen lds
    s_add_u32 m0, s37, 36864
    s_mov_b32 s34, 8192
    buffer_load_dwordx4 v106, s[12:15], s34 offen lds
    s_add_u32 m0, s37, 37888
    s_mov_b32 s34, 270336
    buffer_load_dwordx4 v106, s[12:15], s34 offen lds
    s_add_u32 m0, s37, 40960
    s_mov_b32 s34, 32768
    buffer_load_dwordx4 v105, s[12:15], s34 offen lds
    s_add_u32 m0, s37, 41984
    s_mov_b32 s34, 294912
    buffer_load_dwordx4 v105, s[12:15], s34 offen lds
    s_add_u32 m0, s37, 45056
    s_mov_b32 s34, 40960
    buffer_load_dwordx4 v106, s[12:15], s34 offen lds
    s_add_u32 m0, s37, 46080
    s_mov_b32 s34, 303104
    buffer_load_dwordx4 v106, s[12:15], s34 offen lds
    s_mov_b32 s12, s16
    s_mov_b32 s13, s17
    s_add_u32 m0, s37, 34816
    s_mov_b32 s34, 65536
    buffer_load_dwordx4 v105, s[12:15], s34 offen lds
    s_add_u32 m0, s37, 35840
    s_mov_b32 s34, 327680
    buffer_load_dwordx4 v105, s[12:15], s34 offen lds
    s_add_u32 m0, s37, 38912
    s_mov_b32 s34, 73728
    buffer_load_dwordx4 v106, s[12:15], s34 offen lds
    s_add_u32 m0, s37, 39936
    s_mov_b32 s34, 335872
    buffer_load_dwordx4 v106, s[12:15], s34 offen lds
    s_add_u32 m0, s37, 43008
    s_mov_b32 s34, 98304
    buffer_load_dwordx4 v105, s[12:15], s34 offen lds
    s_add_u32 m0, s37, 44032
    s_mov_b32 s34, 360448
    buffer_load_dwordx4 v105, s[12:15], s34 offen lds
    s_add_u32 m0, s37, 47104
    s_mov_b32 s34, 106496
    buffer_load_dwordx4 v106, s[12:15], s34 offen lds
    s_add_u32 m0, s37, 48128
    s_mov_b32 s34, 368640
    buffer_load_dwordx4 v106, s[12:15], s34 offen lds
    s_mov_b32 s12, s16
    s_mov_b32 s13, s17
    s_add_u32 m0, s37, 49152
    s_mov_b32 s34, 524288
    buffer_load_dwordx4 v105, s[12:15], s34 offen lds
    s_add_u32 m0, s37, 50176
    s_mov_b32 s34, 786432
    buffer_load_dwordx4 v105, s[12:15], s34 offen lds
    s_add_u32 m0, s37, 53248
    s_mov_b32 s34, 532480
    buffer_load_dwordx4 v106, s[12:15], s34 offen lds
    s_add_u32 m0, s37, 54272
    s_mov_b32 s34, 794624
    buffer_load_dwordx4 v106, s[12:15], s34 offen lds
    s_add_u32 m0, s37, 57344
    s_mov_b32 s34, 557056
    buffer_load_dwordx4 v105, s[12:15], s34 offen lds
    s_add_u32 m0, s37, 58368
    s_mov_b32 s34, 819200
    buffer_load_dwordx4 v105, s[12:15], s34 offen lds
    s_add_u32 m0, s37, 61440
    s_mov_b32 s34, 565248
    buffer_load_dwordx4 v106, s[12:15], s34 offen lds
    s_add_u32 m0, s37, 62464
    s_mov_b32 s34, 827392
    buffer_load_dwordx4 v106, s[12:15], s34 offen lds
    s_mov_b32 s12, s16
    s_mov_b32 s13, s17
    s_add_u32 m0, s37, 51200
    s_mov_b32 s34, 589824
    buffer_load_dwordx4 v105, s[12:15], s34 offen lds
    s_add_u32 m0, s37, 52224
    s_mov_b32 s34, 851968
    buffer_load_dwordx4 v105, s[12:15], s34 offen lds
    s_add_u32 m0, s37, 55296
    s_mov_b32 s34, 598016
    buffer_load_dwordx4 v106, s[12:15], s34 offen lds
    s_add_u32 m0, s37, 56320
    s_mov_b32 s34, 860160
    buffer_load_dwordx4 v106, s[12:15], s34 offen lds
    s_add_u32 m0, s37, 59392
    s_mov_b32 s34, 622592
    buffer_load_dwordx4 v105, s[12:15], s34 offen lds
    s_add_u32 m0, s37, 60416
    s_mov_b32 s34, 884736
    buffer_load_dwordx4 v105, s[12:15], s34 offen lds
    s_add_u32 m0, s37, 63488
    s_mov_b32 s34, 630784
    buffer_load_dwordx4 v106, s[12:15], s34 offen lds
    s_add_u32 m0, s37, 64512
    s_mov_b32 s34, 892928
    buffer_load_dwordx4 v106, s[12:15], s34 offen lds
    v_lshlrev_b32 v24, 4, v99
    v_and_b32 v25, 1, v99
    v_mov_b32 v0, 0xffff4444
    v_mov_b32 v26, 0xffffeeee
    v_cmp_ne_u32 vcc, 0, v25
    s_nop 1
    v_cndmask_b32 v0, v0, v26, vcc
    s_lshl_b32 s34, s25, 10
    v_add_u32 v1, s34, v24
    s_add_u32 s35, s37, 32768
    v_add_u32 v2, s35, v24
    v_add_u32 v6, 8192, v24
    v_and_b32 v114, 7, v99
    s_lshl_b32 s35, s25, 6
    v_mul_u32_u24 v3, 1088, v100
    v_lshl_add_u32 v3, v113, 2, v3
    s_add_u32 s36, s35, 24576
    v_add_u32 v3, s36, v3
    v_mul_u32_u24 v4, 544, v114
    v_lshl_add_u32 v4, v100, 4, v4
    v_add_u32 v4, 24576, v4
    v_lshrrev_b32 v115, 2, v113
    v_lshl_add_u32 v115, v115, 1, v25
    v_mul_u32_u24 v5, 544, v115
    v_lshl_add_u32 v5, v100, 4, v5
    v_add_u32 v5, 24848, v5
    v_mul_u32_u24 v8, 272, v114
    v_lshl_add_u32 v8, v100, 4, v8
    s_add_u32 s36, s35, 29184
    v_add_u32 v8, s36, v8
    v_lshrrev_b32 v115, 1, v113
    v_mul_u32_u24 v9, 272, v115
    v_lshl_add_u32 v9, v100, 4, v9
    v_lshl_add_u32 v9, v25, 6, v9
    v_add_u32 v9, 29184, v9
    v_xor_b32 v14, 1024, v1
    v_xor_b32 v15, 2048, v1
    v_mov_b32 v13, 0xfffe0000
    v_lshlrev_b32 v7, 6, v113
    v_lshl_add_u32 v7, v100, 4, v7
    s_lshl_b32 s36, s24, 13
    s_lshl_b32 s34, s25, 11
    s_add_u32 s36, s36, s34
    s_add_u32 s36, s36, 35651584
    v_add_u32 v7, s36, v7
    v_lshrrev_b32 v10, 2, v113
    v_lshlrev_b32 v10, 14, v10
    v_lshrrev_b32 v115, 5, v99
    v_lshl_add_u32 v10, v115, 13, v10
    v_and_b32 v115, 1, v100
    v_lshl_add_u32 v10, v115, 11, v10
    v_lshl_add_u32 v10, v102, 4, v10
    s_lshl_b32 s36, s25, 16
    s_lshl_b32 s34, s24, 6
    s_add_u32 s36, s36, s34
    s_add_u32 s36, s36, 85983232
    v_add_u32 v10, s36, v10
    v_lshlrev_b32 v11, 6, v101
    v_lshl_add_u32 v11, v100, 8, v11
    v_lshl_add_u32 v11, v102, 4, v11
    s_lshl_b32 s36, s24, 13
    s_lshl_b32 s34, s25, 11
    s_add_u32 s36, s36, s34
    s_add_u32 s36, s36, 85983232
    v_add_u32 v11, s36, v11
    v_bfe_u32 v12, v99, 2, 1
    v_lshlrev_b32 v12, 5, v12
    v_lshl_add_u32 v12, v100, 3, v12
    v_bfe_u32 v115, v99, 1, 1
    v_lshl_add_u32 v12, v115, 2, v12
    s_lshl_b32 s36, s24, 7
    s_lshr_b32 s34, s25, 1
    s_lshl_b32 s34, s34, 12
    s_add_u32 s36, s36, s34
    s_and_b32 s34, s25, 1
    s_lshl_b32 s34, s34, 6
    s_add_u32 s36, s36, s34
    v_add_u32 v12, s36, v12
    v_and_b32 v115, 9, v99
    v_cmp_ne_u32 vcc, 0, v115
    v_mov_b32 v115, 0x7ffffff0
    s_nop 0
    v_cndmask_b32 v12, v12, v115, vcc
    v_lshlrev_b32 v115, 4, v25
    v_mov_b32 v116, 0x3f80
    v_lshlrev_b32 v116, v115, v116
    v_lshrrev_b32 v115, 1, v114
    v_cmp_eq_u32 vcc, 0, v115
    s_nop 1
    v_cndmask_b32 v16, 0, v116, vcc
    v_cmp_eq_u32 vcc, 1, v115
    s_nop 1
    v_cndmask_b32 v17, 0, v116, vcc
    v_cmp_eq_u32 vcc, 2, v115
    s_nop 1
    v_cndmask_b32 v18, 0, v116, vcc
    v_cmp_eq_u32 vcc, 3, v115
    s_nop 1
    v_cndmask_b32 v19, 0, v116, vcc
    s_mov_b32 s44, 1040356334
    s_mov_b32 s43, 0xfffeffff
    s_mov_b32 s45, 1040356334
    v_mov_b32 v20, 0x3f803f80
    v_mov_b32 v21, 0x3f803f80
    v_mov_b32 v22, 0x3f803f80
    v_mov_b32 v23, 0x3f803f80
    s_mov_b32 s56, s54
    s_mov_b32 s57, s55
    s_mov_b32 s58, 8192
    s_mov_b32 s59, 0x20000
    v_bfe_u32 v115, v99, 1, 1
    v_lshl_add_u32 v115, v115, 5, v100
    v_bfe_u32 v116, v99, 2, 1
    v_lshl_add_u32 v115, v116, 9, v115
    v_lshlrev_b32 v115, 1, v115
    s_lshr_b32 s34, s24, 3
    s_lshl_b32 s34, s34, 8
    s_lshr_b32 s35, s25, 1
    s_lshl_b32 s35, s35, 7
    s_add_u32 s34, s34, s35
    s_bfe_u32 s35, s24, 0x20001
    s_lshl_b32 s35, s35, 3
    s_add_u32 s34, s34, s35
    s_and_b32 s35, s24, 1
    s_lshl_b32 s35, s35, 12
    s_add_u32 s34, s34, s35
    s_and_b32 s35, s25, 1
    s_lshl_b32 s35, s35, 11
    s_add_u32 s34, s34, s35
    buffer_load_ushort v92, v115, s[56:59], s34 offen
    buffer_load_ushort v93, v115, s[56:59], s34 offen offset:32
    v_mov_b32 v120, -1
    v_mov_b32 v121, -1
    v_mov_b32 v122, -1
    v_mov_b32 v123, -1
    s_mov_b32 s35, 87040000
    buffer_store_dwordx4 v[120:123], v11, s[4:7], 0 offen sc1
    buffer_store_dwordx4 v[120:123], v11, s[4:7], 0 offen offset:1024 sc1
    buffer_store_dword v120, v12, s[4:7], s35 offen sc1
    s_waitcnt vmcnt(29)
    s_barrier
    s_xor_b32 s34, s25, 0
    s_lshl_b32 s34, s34, 15
    s_add_u32 s34, s34, 32768
    v_add_u32 v112, s34, v109
    ds_read_b64_tr_b16 a[0:1], v112 offset:0
    ds_read_b64_tr_b16 a[2:3], v112 offset:1024
    s_xor_b32 s34, s25, 0
    s_lshl_b32 s34, s34, 15
    s_add_u32 s34, s34, 32768
    v_add_u32 v112, s34, v110
    ds_read_b64_tr_b16 a[8:9], v112 offset:0
    ds_read_b64_tr_b16 a[10:11], v112 offset:1024
    s_xor_b32 s34, s25, 1
    s_lshl_b32 s34, s34, 15
    s_add_u32 s34, s34, 32768
    v_add_u32 v112, s34, v109
    ds_read_b64_tr_b16 a[16:17], v112 offset:0
    ds_read_b64_tr_b16 a[18:19], v112 offset:1024
    s_xor_b32 s34, s25, 1
    s_lshl_b32 s34, s34, 15
    s_add_u32 s34, s34, 32768
    v_add_u32 v112, s34, v110
    ds_read_b64_tr_b16 a[24:25], v112 offset:0
    ds_read_b64_tr_b16 a[26:27], v112 offset:1024
    s_xor_b32 s34, s25, 2
    s_lshl_b32 s34, s34, 15
    s_add_u32 s34, s34, 32768
    v_add_u32 v112, s34, v109
    ds_read_b64_tr_b16 a[32:33], v112 offset:0
    ds_read_b64_tr_b16 a[34:35], v112 offset:1024
    s_xor_b32 s34, s25, 2
    s_lshl_b32 s34, s34, 15
    s_add_u32 s34, s34, 32768
    v_add_u32 v112, s34, v110
    ds_read_b64_tr_b16 a[40:41], v112 offset:0
    ds_read_b64_tr_b16 a[42:43], v112 offset:1024
    s_xor_b32 s34, s25, 3
    s_lshl_b32 s34, s34, 15
    s_add_u32 s34, s34, 32768
    v_add_u32 v112, s34, v109
    ds_read_b64_tr_b16 a[48:49], v112 offset:0
    ds_read_b64_tr_b16 a[50:51], v112 offset:1024
    s_xor_b32 s34, s25, 3
    s_lshl_b32 s34, s34, 15
    s_add_u32 s34, s34, 32768
    v_add_u32 v112, s34, v110
    ds_read_b64_tr_b16 a[56:57], v112 offset:0
    ds_read_b64_tr_b16 a[58:59], v112 offset:1024
    s_waitcnt lgkmcnt(0)
    s_barrier
    s_mov_b32 s12, s20
    s_mov_b32 s13, s21
    s_add_u32 m0, s37, 32768
    s_mov_b32 s34, 0
    buffer_load_dwordx4 v105, s[12:15], s34 offen lds
    s_add_u32 m0, s37, 33792
    s_mov_b32 s34, 262144
    buffer_load_dwordx4 v105, s[12:15], s34 offen lds
    s_add_u32 m0, s37, 36864
    s_mov_b32 s34, 8192
    buffer_load_dwordx4 v106, s[12:15], s34 offen lds
    s_add_u32 m0, s37, 37888
    s_mov_b32 s34, 270336
    buffer_load_dwordx4 v106, s[12:15], s34 offen lds
    s_add_u32 m0, s37, 40960
    s_mov_b32 s34, 32768
    buffer_load_dwordx4 v105, s[12:15], s34 offen lds
    s_add_u32 m0, s37, 41984
    s_mov_b32 s34, 294912
    buffer_load_dwordx4 v105, s[12:15], s34 offen lds
    s_add_u32 m0, s37, 45056
    s_mov_b32 s34, 40960
    buffer_load_dwordx4 v106, s[12:15], s34 offen lds
    s_add_u32 m0, s37, 46080
    s_mov_b32 s34, 303104
    buffer_load_dwordx4 v106, s[12:15], s34 offen lds
    s_waitcnt vmcnt(29)
    s_barrier
    s_xor_b32 s34, s25, 0
    s_lshl_b32 s34, s34, 15
    s_add_u32 s34, s34, 32768
    v_add_u32 v112, s34, v109
    ds_read_b64_tr_b16 a[4:5], v112 offset:2048
    ds_read_b64_tr_b16 a[6:7], v112 offset:3072
    s_xor_b32 s34, s25, 0
    s_lshl_b32 s34, s34, 15
    s_add_u32 s34, s34, 32768
    v_add_u32 v112, s34, v110
    ds_read_b64_tr_b16 a[12:13], v112 offset:2048
    ds_read_b64_tr_b16 a[14:15], v112 offset:3072
    s_xor_b32 s34, s25, 1
    s_lshl_b32 s34, s34, 15
    s_add_u32 s34, s34, 32768
    v_add_u32 v112, s34, v109
    ds_read_b64_tr_b16 a[20:21], v112 offset:2048
    ds_read_b64_tr_b16 a[22:23], v112 offset:3072
    s_xor_b32 s34, s25, 1
    s_lshl_b32 s34, s34, 15
    s_add_u32 s34, s34, 32768
    v_add_u32 v112, s34, v110
    ds_read_b64_tr_b16 a[28:29], v112 offset:2048
    ds_read_b64_tr_b16 a[30:31], v112 offset:3072
    s_xor_b32 s34, s25, 2
    s_lshl_b32 s34, s34, 15
    s_add_u32 s34, s34, 32768
    v_add_u32 v112, s34, v109
    ds_read_b64_tr_b16 a[36:37], v112 offset:2048
    ds_read_b64_tr_b16 a[38:39], v112 offset:3072
    s_xor_b32 s34, s25, 2
    s_lshl_b32 s34, s34, 15
    s_add_u32 s34, s34, 32768
    v_add_u32 v112, s34, v110
    ds_read_b64_tr_b16 a[44:45], v112 offset:2048
    ds_read_b64_tr_b16 a[46:47], v112 offset:3072
    s_xor_b32 s34, s25, 3
    s_lshl_b32 s34, s34, 15
    s_add_u32 s34, s34, 32768
    v_add_u32 v112, s34, v109
    ds_read_b64_tr_b16 a[52:53], v112 offset:2048
    ds_read_b64_tr_b16 a[54:55], v112 offset:3072
    s_xor_b32 s34, s25, 3
    s_lshl_b32 s34, s34, 15
    s_add_u32 s34, s34, 32768
    v_add_u32 v112, s34, v110
    ds_read_b64_tr_b16 a[60:61], v112 offset:2048
    ds_read_b64_tr_b16 a[62:63], v112 offset:3072
    s_waitcnt lgkmcnt(0)
    s_barrier
    s_mov_b32 s12, s20
    s_mov_b32 s13, s21
    s_add_u32 m0, s37, 34816
    s_mov_b32 s34, 65536
    buffer_load_dwordx4 v105, s[12:15], s34 offen lds
    s_add_u32 m0, s37, 35840
    s_mov_b32 s34, 327680
    buffer_load_dwordx4 v105, s[12:15], s34 offen lds
    s_add_u32 m0, s37, 38912
    s_mov_b32 s34, 73728
    buffer_load_dwordx4 v106, s[12:15], s34 offen lds
    s_add_u32 m0, s37, 39936
    s_mov_b32 s34, 335872
    buffer_load_dwordx4 v106, s[12:15], s34 offen lds
    s_add_u32 m0, s37, 43008
    s_mov_b32 s34, 98304
    buffer_load_dwordx4 v105, s[12:15], s34 offen lds
    s_add_u32 m0, s37, 44032
    s_mov_b32 s34, 360448
    buffer_load_dwordx4 v105, s[12:15], s34 offen lds
    s_add_u32 m0, s37, 47104
    s_mov_b32 s34, 106496
    buffer_load_dwordx4 v106, s[12:15], s34 offen lds
    s_add_u32 m0, s37, 48128
    s_mov_b32 s34, 368640
    buffer_load_dwordx4 v106, s[12:15], s34 offen lds
    s_waitcnt vmcnt(29)
    s_barrier
    s_xor_b32 s34, s25, 0
    s_lshl_b32 s34, s34, 15
    s_add_u32 s34, s34, 49152
    v_add_u32 v112, s34, v109
    ds_read_b64_tr_b16 a[64:65], v112 offset:0
    ds_read_b64_tr_b16 a[66:67], v112 offset:1024
    s_xor_b32 s34, s25, 0
    s_lshl_b32 s34, s34, 15
    s_add_u32 s34, s34, 49152
    v_add_u32 v112, s34, v110
    ds_read_b64_tr_b16 a[72:73], v112 offset:0
    ds_read_b64_tr_b16 a[74:75], v112 offset:1024
    s_xor_b32 s34, s25, 1
    s_lshl_b32 s34, s34, 15
    s_add_u32 s34, s34, 49152
    v_add_u32 v112, s34, v109
    ds_read_b64_tr_b16 a[80:81], v112 offset:0
    ds_read_b64_tr_b16 a[82:83], v112 offset:1024
    s_xor_b32 s34, s25, 1
    s_lshl_b32 s34, s34, 15
    s_add_u32 s34, s34, 49152
    v_add_u32 v112, s34, v110
    ds_read_b64_tr_b16 a[88:89], v112 offset:0
    ds_read_b64_tr_b16 a[90:91], v112 offset:1024
    s_xor_b32 s34, s25, 2
    s_lshl_b32 s34, s34, 15
    s_add_u32 s34, s34, 49152
    v_add_u32 v112, s34, v109
    ds_read_b64_tr_b16 a[96:97], v112 offset:0
    ds_read_b64_tr_b16 a[98:99], v112 offset:1024
    s_xor_b32 s34, s25, 2
    s_lshl_b32 s34, s34, 15
    s_add_u32 s34, s34, 49152
    v_add_u32 v112, s34, v110
    ds_read_b64_tr_b16 a[104:105], v112 offset:0
    ds_read_b64_tr_b16 a[106:107], v112 offset:1024
    s_xor_b32 s34, s25, 3
    s_lshl_b32 s34, s34, 15
    s_add_u32 s34, s34, 49152
    v_add_u32 v112, s34, v109
    ds_read_b64_tr_b16 a[112:113], v112 offset:0
    ds_read_b64_tr_b16 a[114:115], v112 offset:1024
    s_xor_b32 s34, s25, 3
    s_lshl_b32 s34, s34, 15
    s_add_u32 s34, s34, 49152
    v_add_u32 v112, s34, v110
    ds_read_b64_tr_b16 a[120:121], v112 offset:0
    ds_read_b64_tr_b16 a[122:123], v112 offset:1024
    s_waitcnt lgkmcnt(0)
    s_barrier
    s_mov_b32 s12, s20
    s_mov_b32 s13, s21
    s_add_u32 m0, s37, 49152
    s_mov_b32 s34, 524288
    buffer_load_dwordx4 v105, s[12:15], s34 offen lds
    s_add_u32 m0, s37, 50176
    s_mov_b32 s34, 786432
    buffer_load_dwordx4 v105, s[12:15], s34 offen lds
    s_add_u32 m0, s37, 53248
    s_mov_b32 s34, 532480
    buffer_load_dwordx4 v106, s[12:15], s34 offen lds
    s_add_u32 m0, s37, 54272
    s_mov_b32 s34, 794624
    buffer_load_dwordx4 v106, s[12:15], s34 offen lds
    s_add_u32 m0, s37, 57344
    s_mov_b32 s34, 557056
    buffer_load_dwordx4 v105, s[12:15], s34 offen lds
    s_add_u32 m0, s37, 58368
    s_mov_b32 s34, 819200
    buffer_load_dwordx4 v105, s[12:15], s34 offen lds
    s_add_u32 m0, s37, 61440
    s_mov_b32 s34, 565248
    buffer_load_dwordx4 v106, s[12:15], s34 offen lds
    s_add_u32 m0, s37, 62464
    s_mov_b32 s34, 827392
    buffer_load_dwordx4 v106, s[12:15], s34 offen lds
    s_waitcnt vmcnt(24)
    s_barrier
    s_xor_b32 s34, s25, 0
    s_lshl_b32 s34, s34, 15
    s_add_u32 s34, s34, 49152
    v_add_u32 v112, s34, v109
    ds_read_b64_tr_b16 a[68:69], v112 offset:2048
    ds_read_b64_tr_b16 a[70:71], v112 offset:3072
    s_xor_b32 s34, s25, 0
    s_lshl_b32 s34, s34, 15
    s_add_u32 s34, s34, 49152
    v_add_u32 v112, s34, v110
    ds_read_b64_tr_b16 a[76:77], v112 offset:2048
    ds_read_b64_tr_b16 a[78:79], v112 offset:3072
    s_xor_b32 s34, s25, 1
    s_lshl_b32 s34, s34, 15
    s_add_u32 s34, s34, 49152
    v_add_u32 v112, s34, v109
    ds_read_b64_tr_b16 a[84:85], v112 offset:2048
    ds_read_b64_tr_b16 a[86:87], v112 offset:3072
    s_xor_b32 s34, s25, 1
    s_lshl_b32 s34, s34, 15
    s_add_u32 s34, s34, 49152
    v_add_u32 v112, s34, v110
    ds_read_b64_tr_b16 a[92:93], v112 offset:2048
    ds_read_b64_tr_b16 a[94:95], v112 offset:3072
    s_xor_b32 s34, s25, 2
    s_lshl_b32 s34, s34, 15
    s_add_u32 s34, s34, 49152
    v_add_u32 v112, s34, v109
    ds_read_b64_tr_b16 a[100:101], v112 offset:2048
    ds_read_b64_tr_b16 a[102:103], v112 offset:3072
    s_xor_b32 s34, s25, 2
    s_lshl_b32 s34, s34, 15
    s_add_u32 s34, s34, 49152
    v_add_u32 v112, s34, v110
    ds_read_b64_tr_b16 a[108:109], v112 offset:2048
    ds_read_b64_tr_b16 a[110:111], v112 offset:3072
    s_xor_b32 s34, s25, 3
    s_lshl_b32 s34, s34, 15
    s_add_u32 s34, s34, 49152
    v_add_u32 v112, s34, v109
    ds_read_b64_tr_b16 a[116:117], v112 offset:2048
    ds_read_b64_tr_b16 a[118:119], v112 offset:3072
    s_xor_b32 s34, s25, 3
    s_lshl_b32 s34, s34, 15
    s_add_u32 s34, s34, 49152
    v_add_u32 v112, s34, v110
    ds_read_b64_tr_b16 a[124:125], v112 offset:2048
    ds_read_b64_tr_b16 a[126:127], v112 offset:3072
    s_waitcnt lgkmcnt(0)
    s_barrier
    s_mov_b32 s12, s20
    s_mov_b32 s13, s21
    s_add_u32 m0, s37, 51200
    s_mov_b32 s34, 589824
    buffer_load_dwordx4 v105, s[12:15], s34 offen lds
    s_add_u32 m0, s37, 52224
    s_mov_b32 s34, 851968
    buffer_load_dwordx4 v105, s[12:15], s34 offen lds
    s_add_u32 m0, s37, 55296
    s_mov_b32 s34, 598016
    buffer_load_dwordx4 v106, s[12:15], s34 offen lds
    s_add_u32 m0, s37, 56320
    s_mov_b32 s34, 860160
    buffer_load_dwordx4 v106, s[12:15], s34 offen lds
    s_add_u32 m0, s37, 59392
    s_mov_b32 s34, 622592
    buffer_load_dwordx4 v105, s[12:15], s34 offen lds
    s_add_u32 m0, s37, 60416
    s_mov_b32 s34, 884736
    buffer_load_dwordx4 v105, s[12:15], s34 offen lds
    s_add_u32 m0, s37, 63488
    s_mov_b32 s34, 630784
    buffer_load_dwordx4 v106, s[12:15], s34 offen lds
    s_add_u32 m0, s37, 64512
    s_mov_b32 s34, 892928
    buffer_load_dwordx4 v106, s[12:15], s34 offen lds
    v_lshl_or_b32 v92, v93, 16, v92
    v_min_u32 v92, s43, v92
    s_mov_b32 s35, 87031808
    buffer_store_dword v92, v12, s[4:7], s35 offen sc1
    s_waitcnt vmcnt(24)
    s_barrier
    s_xor_b32 s34, s25, 0
    s_lshl_b32 s34, s34, 15
    s_add_u32 s34, s34, 32768
    v_add_u32 v112, s34, v109
    ds_read_b64_tr_b16 a[128:129], v112 offset:0
    ds_read_b64_tr_b16 a[130:131], v112 offset:1024
    s_xor_b32 s34, s25, 0
    s_lshl_b32 s34, s34, 15
    s_add_u32 s34, s34, 32768
    v_add_u32 v112, s34, v110
    ds_read_b64_tr_b16 a[136:137], v112 offset:0
    ds_read_b64_tr_b16 a[138:139], v112 offset:1024
    s_xor_b32 s34, s25, 1
    s_lshl_b32 s34, s34, 15
    s_add_u32 s34, s34, 32768
    v_add_u32 v112, s34, v109
    ds_read_b64_tr_b16 a[144:145], v112 offset:0
    ds_read_b64_tr_b16 a[146:147], v112 offset:1024
    s_xor_b32 s34, s25, 1
    s_lshl_b32 s34, s34, 15
    s_add_u32 s34, s34, 32768
    v_add_u32 v112, s34, v110
    ds_read_b64_tr_b16 a[152:153], v112 offset:0
    ds_read_b64_tr_b16 a[154:155], v112 offset:1024
    s_xor_b32 s34, s25, 2
    s_lshl_b32 s34, s34, 15
    s_add_u32 s34, s34, 32768
    v_add_u32 v112, s34, v109
    ds_read_b64_tr_b16 a[160:161], v112 offset:0
    ds_read_b64_tr_b16 a[162:163], v112 offset:1024
    s_xor_b32 s34, s25, 2
    s_lshl_b32 s34, s34, 15
    s_add_u32 s34, s34, 32768
    v_add_u32 v112, s34, v110
    ds_read_b64_tr_b16 a[168:169], v112 offset:0
    ds_read_b64_tr_b16 a[170:171], v112 offset:1024
    s_xor_b32 s34, s25, 3
    s_lshl_b32 s34, s34, 15
    s_add_u32 s34, s34, 32768
    v_add_u32 v112, s34, v109
    ds_read_b64_tr_b16 a[176:177], v112 offset:0
    ds_read_b64_tr_b16 a[178:179], v112 offset:1024
    s_xor_b32 s34, s25, 3
    s_lshl_b32 s34, s34, 15
    s_add_u32 s34, s34, 32768
    v_add_u32 v112, s34, v110
    ds_read_b64_tr_b16 a[184:185], v112 offset:0
    ds_read_b64_tr_b16 a[186:187], v112 offset:1024
    s_waitcnt lgkmcnt(0)
    s_barrier
    s_mov_b32 s12, s18
    s_mov_b32 s13, s19
    s_add_u32 m0, s37, 32768
    s_mov_b32 s34, 0
    buffer_load_dwordx4 v105, s[12:15], s34 offen lds
    s_add_u32 m0, s37, 33792
    s_mov_b32 s34, 262144
    buffer_load_dwordx4 v105, s[12:15], s34 offen lds
    s_add_u32 m0, s37, 36864
    s_mov_b32 s34, 8192
    buffer_load_dwordx4 v106, s[12:15], s34 offen lds
    s_add_u32 m0, s37, 37888
    s_mov_b32 s34, 270336
    buffer_load_dwordx4 v106, s[12:15], s34 offen lds
    s_add_u32 m0, s37, 40960
    s_mov_b32 s34, 32768
    buffer_load_dwordx4 v105, s[12:15], s34 offen lds
    s_add_u32 m0, s37, 41984
    s_mov_b32 s34, 294912
    buffer_load_dwordx4 v105, s[12:15], s34 offen lds
    s_add_u32 m0, s37, 45056
    s_mov_b32 s34, 40960
    buffer_load_dwordx4 v106, s[12:15], s34 offen lds
    s_add_u32 m0, s37, 46080
    s_mov_b32 s34, 303104
    buffer_load_dwordx4 v106, s[12:15], s34 offen lds
    s_waitcnt vmcnt(24)
    s_barrier
    s_xor_b32 s34, s25, 0
    s_lshl_b32 s34, s34, 15
    s_add_u32 s34, s34, 32768
    v_add_u32 v112, s34, v109
    ds_read_b64_tr_b16 a[132:133], v112 offset:2048
    ds_read_b64_tr_b16 a[134:135], v112 offset:3072
    s_xor_b32 s34, s25, 0
    s_lshl_b32 s34, s34, 15
    s_add_u32 s34, s34, 32768
    v_add_u32 v112, s34, v110
    ds_read_b64_tr_b16 a[140:141], v112 offset:2048
    ds_read_b64_tr_b16 a[142:143], v112 offset:3072
    s_xor_b32 s34, s25, 1
    s_lshl_b32 s34, s34, 15
    s_add_u32 s34, s34, 32768
    v_add_u32 v112, s34, v109
    ds_read_b64_tr_b16 a[148:149], v112 offset:2048
    ds_read_b64_tr_b16 a[150:151], v112 offset:3072
    s_xor_b32 s34, s25, 1
    s_lshl_b32 s34, s34, 15
    s_add_u32 s34, s34, 32768
    v_add_u32 v112, s34, v110
    ds_read_b64_tr_b16 a[156:157], v112 offset:2048
    ds_read_b64_tr_b16 a[158:159], v112 offset:3072
    s_xor_b32 s34, s25, 2
    s_lshl_b32 s34, s34, 15
    s_add_u32 s34, s34, 32768
    v_add_u32 v112, s34, v109
    ds_read_b64_tr_b16 a[164:165], v112 offset:2048
    ds_read_b64_tr_b16 a[166:167], v112 offset:3072
    s_xor_b32 s34, s25, 2
    s_lshl_b32 s34, s34, 15
    s_add_u32 s34, s34, 32768
    v_add_u32 v112, s34, v110
    ds_read_b64_tr_b16 a[172:173], v112 offset:2048
    ds_read_b64_tr_b16 a[174:175], v112 offset:3072
    s_xor_b32 s34, s25, 3
    s_lshl_b32 s34, s34, 15
    s_add_u32 s34, s34, 32768
    v_add_u32 v112, s34, v109
    ds_read_b64_tr_b16 a[180:181], v112 offset:2048
    ds_read_b64_tr_b16 a[182:183], v112 offset:3072
    s_xor_b32 s34, s25, 3
    s_lshl_b32 s34, s34, 15
    s_add_u32 s34, s34, 32768
    v_add_u32 v112, s34, v110
    ds_read_b64_tr_b16 a[188:189], v112 offset:2048
    ds_read_b64_tr_b16 a[190:191], v112 offset:3072
    s_waitcnt lgkmcnt(0)
    s_barrier
    s_mov_b32 s12, s18
    s_mov_b32 s13, s19
    s_add_u32 m0, s37, 34816
    s_mov_b32 s34, 65536
    buffer_load_dwordx4 v105, s[12:15], s34 offen lds
    s_add_u32 m0, s37, 35840
    s_mov_b32 s34, 327680
    buffer_load_dwordx4 v105, s[12:15], s34 offen lds
    s_add_u32 m0, s37, 38912
    s_mov_b32 s34, 73728
    buffer_load_dwordx4 v106, s[12:15], s34 offen lds
    s_add_u32 m0, s37, 39936
    s_mov_b32 s34, 335872
    buffer_load_dwordx4 v106, s[12:15], s34 offen lds
    s_add_u32 m0, s37, 43008
    s_mov_b32 s34, 98304
    buffer_load_dwordx4 v105, s[12:15], s34 offen lds
    s_add_u32 m0, s37, 44032
    s_mov_b32 s34, 360448
    buffer_load_dwordx4 v105, s[12:15], s34 offen lds
    s_add_u32 m0, s37, 47104
    s_mov_b32 s34, 106496
    buffer_load_dwordx4 v106, s[12:15], s34 offen lds
    s_add_u32 m0, s37, 48128
    s_mov_b32 s34, 368640
    buffer_load_dwordx4 v106, s[12:15], s34 offen lds
    s_waitcnt vmcnt(24)
    s_barrier
    s_xor_b32 s34, s25, 0
    s_lshl_b32 s34, s34, 15
    s_add_u32 s34, s34, 49152
    v_add_u32 v112, s34, v109
    ds_read_b64_tr_b16 a[192:193], v112 offset:0
    ds_read_b64_tr_b16 a[194:195], v112 offset:1024
    s_xor_b32 s34, s25, 0
    s_lshl_b32 s34, s34, 15
    s_add_u32 s34, s34, 49152
    v_add_u32 v112, s34, v110
    ds_read_b64_tr_b16 a[200:201], v112 offset:0
    ds_read_b64_tr_b16 a[202:203], v112 offset:1024
    s_xor_b32 s34, s25, 1
    s_lshl_b32 s34, s34, 15
    s_add_u32 s34, s34, 49152
    v_add_u32 v112, s34, v109
    ds_read_b64_tr_b16 a[208:209], v112 offset:0
    ds_read_b64_tr_b16 a[210:211], v112 offset:1024
    s_xor_b32 s34, s25, 1
    s_lshl_b32 s34, s34, 15
    s_add_u32 s34, s34, 49152
    v_add_u32 v112, s34, v110
    ds_read_b64_tr_b16 a[216:217], v112 offset:0
    ds_read_b64_tr_b16 a[218:219], v112 offset:1024
    s_xor_b32 s34, s25, 2
    s_lshl_b32 s34, s34, 15
    s_add_u32 s34, s34, 49152
    v_add_u32 v112, s34, v109
    ds_read_b64_tr_b16 a[224:225], v112 offset:0
    ds_read_b64_tr_b16 a[226:227], v112 offset:1024
    s_xor_b32 s34, s25, 2
    s_lshl_b32 s34, s34, 15
    s_add_u32 s34, s34, 49152
    v_add_u32 v112, s34, v110
    ds_read_b64_tr_b16 a[232:233], v112 offset:0
    ds_read_b64_tr_b16 a[234:235], v112 offset:1024
    s_xor_b32 s34, s25, 3
    s_lshl_b32 s34, s34, 15
    s_add_u32 s34, s34, 49152
    v_add_u32 v112, s34, v109
    ds_read_b64_tr_b16 a[240:241], v112 offset:0
    ds_read_b64_tr_b16 a[242:243], v112 offset:1024
    s_xor_b32 s34, s25, 3
    s_lshl_b32 s34, s34, 15
    s_add_u32 s34, s34, 49152
    v_add_u32 v112, s34, v110
    ds_read_b64_tr_b16 a[248:249], v112 offset:0
    ds_read_b64_tr_b16 a[250:251], v112 offset:1024
    s_waitcnt lgkmcnt(0)
    s_barrier
    s_mov_b32 s12, s22
    s_mov_b32 s13, s23
    s_add_u32 m0, s37, 49152
    s_mov_b32 s34, 0
    buffer_load_dwordx4 v107, s[12:15], s34 offen lds
    s_add_u32 m0, s37, 50176
    s_mov_b32 s34, 2048
    buffer_load_dwordx4 v107, s[12:15], s34 offen lds
    s_add_u32 m0, s37, 53248
    s_mov_b32 s34, 16384
    buffer_load_dwordx4 v108, s[12:15], s34 offen lds
    s_add_u32 m0, s37, 54272
    s_mov_b32 s34, 18432
    buffer_load_dwordx4 v108, s[12:15], s34 offen lds
    s_add_u32 m0, s37, 57344
    s_mov_b32 s34, 4096
    buffer_load_dwordx4 v107, s[12:15], s34 offen lds
    s_add_u32 m0, s37, 58368
    s_mov_b32 s34, 6144
    buffer_load_dwordx4 v107, s[12:15], s34 offen lds
    s_add_u32 m0, s37, 61440
    s_mov_b32 s34, 20480
    buffer_load_dwordx4 v108, s[12:15], s34 offen lds
    s_add_u32 m0, s37, 62464
    s_mov_b32 s34, 22528
    buffer_load_dwordx4 v108, s[12:15], s34 offen lds
    s_waitcnt vmcnt(24)
    s_barrier
    s_xor_b32 s34, s25, 0
    s_lshl_b32 s34, s34, 15
    s_add_u32 s34, s34, 49152
    v_add_u32 v112, s34, v109
    ds_read_b64_tr_b16 a[196:197], v112 offset:2048
    ds_read_b64_tr_b16 a[198:199], v112 offset:3072
    s_xor_b32 s34, s25, 0
    s_lshl_b32 s34, s34, 15
    s_add_u32 s34, s34, 49152
    v_add_u32 v112, s34, v110
    ds_read_b64_tr_b16 a[204:205], v112 offset:2048
    ds_read_b64_tr_b16 a[206:207], v112 offset:3072
    s_xor_b32 s34, s25, 1
    s_lshl_b32 s34, s34, 15
    s_add_u32 s34, s34, 49152
    v_add_u32 v112, s34, v109
    ds_read_b64_tr_b16 a[212:213], v112 offset:2048
    ds_read_b64_tr_b16 a[214:215], v112 offset:3072
    s_xor_b32 s34, s25, 1
    s_lshl_b32 s34, s34, 15
    s_add_u32 s34, s34, 49152
    v_add_u32 v112, s34, v110
    ds_read_b64_tr_b16 a[220:221], v112 offset:2048
    ds_read_b64_tr_b16 a[222:223], v112 offset:3072
    s_xor_b32 s34, s25, 2
    s_lshl_b32 s34, s34, 15
    s_add_u32 s34, s34, 49152
    v_add_u32 v112, s34, v109
    ds_read_b64_tr_b16 a[228:229], v112 offset:2048
    ds_read_b64_tr_b16 a[230:231], v112 offset:3072
    s_xor_b32 s34, s25, 2
    s_lshl_b32 s34, s34, 15
    s_add_u32 s34, s34, 49152
    v_add_u32 v112, s34, v110
    ds_read_b64_tr_b16 a[236:237], v112 offset:2048
    ds_read_b64_tr_b16 a[238:239], v112 offset:3072
    s_xor_b32 s34, s25, 3
    s_lshl_b32 s34, s34, 15
    s_add_u32 s34, s34, 49152
    v_add_u32 v112, s34, v109
    ds_read_b64_tr_b16 a[244:245], v112 offset:2048
    ds_read_b64_tr_b16 a[246:247], v112 offset:3072
    s_xor_b32 s34, s25, 3
    s_lshl_b32 s34, s34, 15
    s_add_u32 s34, s34, 49152
    v_add_u32 v112, s34, v110
    ds_read_b64_tr_b16 a[252:253], v112 offset:2048
    ds_read_b64_tr_b16 a[254:255], v112 offset:3072
    s_waitcnt lgkmcnt(0)
    s_barrier
    s_mov_b32 s12, s22
    s_mov_b32 s13, s23
    s_add_u32 m0, s37, 51200
    s_mov_b32 s34, 8192
    buffer_load_dwordx4 v107, s[12:15], s34 offen lds
    s_add_u32 m0, s37, 52224
    s_mov_b32 s34, 10240
    buffer_load_dwordx4 v107, s[12:15], s34 offen lds
    s_add_u32 m0, s37, 55296
    s_mov_b32 s34, 24576
    buffer_load_dwordx4 v108, s[12:15], s34 offen lds
    s_add_u32 m0, s37, 56320
    s_mov_b32 s34, 26624
    buffer_load_dwordx4 v108, s[12:15], s34 offen lds
    s_add_u32 m0, s37, 59392
    s_mov_b32 s34, 12288
    buffer_load_dwordx4 v107, s[12:15], s34 offen lds
    s_add_u32 m0, s37, 60416
    s_mov_b32 s34, 14336
    buffer_load_dwordx4 v107, s[12:15], s34 offen lds
    s_add_u32 m0, s37, 63488
    s_mov_b32 s34, 28672
    buffer_load_dwordx4 v108, s[12:15], s34 offen lds
    s_add_u32 m0, s37, 64512
    s_mov_b32 s34, 30720
    buffer_load_dwordx4 v108, s[12:15], s34 offen lds
    s_cmp_lg_u32 s25, 0
    s_cbranch_scc1 L_nori
    v_mov_b32 v92, 1
    v_mov_b32 v93, 0
    s_mov_b64 exec, 1
    buffer_atomic_add v92, v93, s[8:11], 0 offen offset:8
    s_mov_b64 exec, -1
L_nori:
    s_waitcnt vmcnt(24)
    s_barrier
    s_xor_b32 s34, s25, 0
    s_lshl_b32 s34, s34, 15
    s_add_u32 s34, s34, 32768
    v_add_u32 v112, s34, v109
    ds_read_b64_tr_b16 v[128:129], v112 offset:0
    ds_read_b64_tr_b16 v[130:131], v112 offset:1024
    s_xor_b32 s34, s25, 0
    s_lshl_b32 s34, s34, 15
    s_add_u32 s34, s34, 32768
    v_add_u32 v112, s34, v110
    ds_read_b64_tr_b16 v[136:137], v112 offset:0
    ds_read_b64_tr_b16 v[138:139], v112 offset:1024
    s_xor_b32 s34, s25, 1
    s_lshl_b32 s34, s34, 15
    s_add_u32 s34, s34, 32768
    v_add_u32 v112, s34, v109
    ds_read_b64_tr_b16 v[144:145], v112 offset:0
    ds_read_b64_tr_b16 v[146:147], v112 offset:1024
    s_xor_b32 s34, s25, 1
    s_lshl_b32 s34, s34, 15
    s_add_u32 s34, s34, 32768
    v_add_u32 v112, s34, v110
    ds_read_b64_tr_b16 v[152:153], v112 offset:0
    ds_read_b64_tr_b16 v[154:155], v112 offset:1024
    s_xor_b32 s34, s25, 2
    s_lshl_b32 s34, s34, 15
    s_add_u32 s34, s34, 32768
    v_add_u32 v112, s34, v109
    ds_read_b64_tr_b16 v[160:161], v112 offset:0
    ds_read_b64_tr_b16 v[162:163], v112 offset:1024
    s_xor_b32 s34, s25, 2
    s_lshl_b32 s34, s34, 15
    s_add_u32 s34, s34, 32768
    v_add_u32 v112, s34, v110
    ds_read_b64_tr_b16 v[168:169], v112 offset:0
    ds_read_b64_tr_b16 v[170:171], v112 offset:1024
    s_xor_b32 s34, s25, 3
    s_lshl_b32 s34, s34, 15
    s_add_u32 s34, s34, 32768
    v_add_u32 v112, s34, v109
    ds_read_b64_tr_b16 v[176:177], v112 offset:0
    ds_read_b64_tr_b16 v[178:179], v112 offset:1024
    s_xor_b32 s34, s25, 3
    s_lshl_b32 s34, s34, 15
    s_add_u32 s34, s34, 32768
    v_add_u32 v112, s34, v110
    ds_read_b64_tr_b16 v[184:185], v112 offset:0
    ds_read_b64_tr_b16 v[186:187], v112 offset:1024
    s_waitcnt lgkmcnt(0)
    s_barrier
    s_mov_b32 s12, s18
    s_mov_b32 s13, s19
    s_add_u32 m0, s37, 32768
    s_mov_b32 s34, 524288
    buffer_load_dwordx4 v105, s[12:15], s34 offen lds
    s_add_u32 m0, s37, 33792
    s_mov_b32 s34, 786432
    buffer_load_dwordx4 v105, s[12:15], s34 offen lds
    s_add_u32 m0, s37, 36864
    s_mov_b32 s34, 532480
    buffer_load_dwordx4 v106, s[12:15], s34 offen lds
    s_add_u32 m0, s37, 37888
    s_mov_b32 s34, 794624
    buffer_load_dwordx4 v106, s[12:15], s34 offen lds
    s_add_u32 m0, s37, 40960
    s_mov_b32 s34, 557056
    buffer_load_dwordx4 v105, s[12:15], s34 offen lds
    s_add_u32 m0, s37, 41984
    s_mov_b32 s34, 819200
    buffer_load_dwordx4 v105, s[12:15], s34 offen lds
    s_add_u32 m0, s37, 45056
    s_mov_b32 s34, 565248
    buffer_load_dwordx4 v106, s[12:15], s34 offen lds
    s_add_u32 m0, s37, 46080
    s_mov_b32 s34, 827392
    buffer_load_dwordx4 v106, s[12:15], s34 offen lds
    s_waitcnt vmcnt(24)
    s_barrier
    s_xor_b32 s34, s25, 0
    s_lshl_b32 s34, s34, 15
    s_add_u32 s34, s34, 32768
    v_add_u32 v112, s34, v109
    ds_read_b64_tr_b16 v[132:133], v112 offset:2048
    ds_read_b64_tr_b16 v[134:135], v112 offset:3072
    s_xor_b32 s34, s25, 0
    s_lshl_b32 s34, s34, 15
    s_add_u32 s34, s34, 32768
    v_add_u32 v112, s34, v110
    ds_read_b64_tr_b16 v[140:141], v112 offset:2048
    ds_read_b64_tr_b16 v[142:143], v112 offset:3072
    s_xor_b32 s34, s25, 1
    s_lshl_b32 s34, s34, 15
    s_add_u32 s34, s34, 32768
    v_add_u32 v112, s34, v109
    ds_read_b64_tr_b16 v[148:149], v112 offset:2048
    ds_read_b64_tr_b16 v[150:151], v112 offset:3072
    s_xor_b32 s34, s25, 1
    s_lshl_b32 s34, s34, 15
    s_add_u32 s34, s34, 32768
    v_add_u32 v112, s34, v110
    ds_read_b64_tr_b16 v[156:157], v112 offset:2048
    ds_read_b64_tr_b16 v[158:159], v112 offset:3072
    s_xor_b32 s34, s25, 2
    s_lshl_b32 s34, s34, 15
    s_add_u32 s34, s34, 32768
    v_add_u32 v112, s34, v109
    ds_read_b64_tr_b16 v[164:165], v112 offset:2048
    ds_read_b64_tr_b16 v[166:167], v112 offset:3072
    s_xor_b32 s34, s25, 2
    s_lshl_b32 s34, s34, 15
    s_add_u32 s34, s34, 32768
    v_add_u32 v112, s34, v110
    ds_read_b64_tr_b16 v[172:173], v112 offset:2048
    ds_read_b64_tr_b16 v[174:175], v112 offset:3072
    s_xor_b32 s34, s25, 3
    s_lshl_b32 s34, s34, 15
    s_add_u32 s34, s34, 32768
    v_add_u32 v112, s34, v109
    ds_read_b64_tr_b16 v[180:181], v112 offset:2048
    ds_read_b64_tr_b16 v[182:183], v112 offset:3072
    s_xor_b32 s34, s25, 3
    s_lshl_b32 s34, s34, 15
    s_add_u32 s34, s34, 32768
    v_add_u32 v112, s34, v110
    ds_read_b64_tr_b16 v[188:189], v112 offset:2048
    ds_read_b64_tr_b16 v[190:191], v112 offset:3072
    s_waitcnt lgkmcnt(0)
    s_barrier
    s_mov_b32 s12, s18
    s_mov_b32 s13, s19
    s_add_u32 m0, s37, 34816
    s_mov_b32 s34, 589824
    buffer_load_dwordx4 v105, s[12:15], s34 offen lds
    s_add_u32 m0, s37, 35840
    s_mov_b32 s34, 851968
    buffer_load_dwordx4 v105, s[12:15], s34 offen lds
    s_add_u32 m0, s37, 38912
    s_mov_b32 s34, 598016
    buffer_load_dwordx4 v106, s[12:15], s34 offen lds
    s_add_u32 m0, s37, 39936
    s_mov_b32 s34, 860160
    buffer_load_dwordx4 v106, s[12:15], s34 offen lds
    s_add_u32 m0, s37, 43008
    s_mov_b32 s34, 622592
    buffer_load_dwordx4 v105, s[12:15], s34 offen lds
    s_add_u32 m0, s37, 44032
    s_mov_b32 s34, 884736
    buffer_load_dwordx4 v105, s[12:15], s34 offen lds
    s_add_u32 m0, s37, 47104
    s_mov_b32 s34, 630784
    buffer_load_dwordx4 v106, s[12:15], s34 offen lds
    s_add_u32 m0, s37, 48128
    s_mov_b32 s34, 892928
    buffer_load_dwordx4 v106, s[12:15], s34 offen lds
    s_waitcnt vmcnt(24)
    s_barrier
    v_xor_b32 v112, 0, v103
    v_lshl_add_u32 v112, v112, 5, v111
    v_add_u32 v112, 49152, v112
    ds_read_b64_tr_b16 v[192:193], v112 offset:0
    ds_read_b64_tr_b16 v[194:195], v112 offset:1024
    v_xor_b32 v112, 1, v103
    v_lshl_add_u32 v112, v112, 5, v111
    v_add_u32 v112, 49152, v112
    ds_read_b64_tr_b16 v[200:201], v112 offset:0
    ds_read_b64_tr_b16 v[202:203], v112 offset:1024
    v_xor_b32 v112, 2, v103
    v_lshl_add_u32 v112, v112, 5, v111
    v_add_u32 v112, 49152, v112
    ds_read_b64_tr_b16 v[208:209], v112 offset:0
    ds_read_b64_tr_b16 v[210:211], v112 offset:1024
    v_xor_b32 v112, 3, v103
    v_lshl_add_u32 v112, v112, 5, v111
    v_add_u32 v112, 49152, v112
    ds_read_b64_tr_b16 v[216:217], v112 offset:0
    ds_read_b64_tr_b16 v[218:219], v112 offset:1024
    v_xor_b32 v112, 4, v103
    v_lshl_add_u32 v112, v112, 5, v111
    v_add_u32 v112, 49152, v112
    ds_read_b64_tr_b16 v[224:225], v112 offset:0
    ds_read_b64_tr_b16 v[226:227], v112 offset:1024
    v_xor_b32 v112, 5, v103
    v_lshl_add_u32 v112, v112, 5, v111
    v_add_u32 v112, 49152, v112
    ds_read_b64_tr_b16 v[232:233], v112 offset:0
    ds_read_b64_tr_b16 v[234:235], v112 offset:1024
    v_xor_b32 v112, 6, v103
    v_lshl_add_u32 v112, v112, 5, v111
    v_add_u32 v112, 49152, v112
    ds_read_b64_tr_b16 v[240:241], v112 offset:0
    ds_read_b64_tr_b16 v[242:243], v112 offset:1024
    v_xor_b32 v112, 7, v103
    v_lshl_add_u32 v112, v112, 5, v111
    v_add_u32 v112, 49152, v112
    ds_read_b64_tr_b16 v[248:249], v112 offset:0
    ds_read_b64_tr_b16 v[250:251], v112 offset:1024
    s_waitcnt lgkmcnt(0)
    s_barrier
    s_mov_b32 s12, s22
    s_mov_b32 s13, s23
    s_add_u32 m0, s37, 49152
    s_mov_b32 s34, 65536
    buffer_load_dwordx4 v107, s[12:15], s34 offen lds
    s_add_u32 m0, s37, 50176
    s_mov_b32 s34, 67584
    buffer_load_dwordx4 v107, s[12:15], s34 offen lds
    s_add_u32 m0, s37, 53248
    s_mov_b32 s34, 81920
    buffer_load_dwordx4 v108, s[12:15], s34 offen lds
    s_add_u32 m0, s37, 54272
    s_mov_b32 s34, 83968
    buffer_load_dwordx4 v108, s[12:15], s34 offen lds
    s_add_u32 m0, s37, 57344
    s_mov_b32 s34, 69632
    buffer_load_dwordx4 v107, s[12:15], s34 offen lds
    s_add_u32 m0, s37, 58368
    s_mov_b32 s34, 71680
    buffer_load_dwordx4 v107, s[12:15], s34 offen lds
    s_add_u32 m0, s37, 61440
    s_mov_b32 s34, 86016
    buffer_load_dwordx4 v108, s[12:15], s34 offen lds
    s_add_u32 m0, s37, 62464
    s_mov_b32 s34, 88064
    buffer_load_dwordx4 v108, s[12:15], s34 offen lds
    s_waitcnt vmcnt(24)
    s_barrier
    v_xor_b32 v112, 0, v103
    v_lshl_add_u32 v112, v112, 5, v111
    v_add_u32 v112, 49152, v112
    ds_read_b64_tr_b16 v[196:197], v112 offset:2048
    ds_read_b64_tr_b16 v[198:199], v112 offset:3072
    v_xor_b32 v112, 1, v103
    v_lshl_add_u32 v112, v112, 5, v111
    v_add_u32 v112, 49152, v112
    ds_read_b64_tr_b16 v[204:205], v112 offset:2048
    ds_read_b64_tr_b16 v[206:207], v112 offset:3072
    v_xor_b32 v112, 2, v103
    v_lshl_add_u32 v112, v112, 5, v111
    v_add_u32 v112, 49152, v112
    ds_read_b64_tr_b16 v[212:213], v112 offset:2048
    ds_read_b64_tr_b16 v[214:215], v112 offset:3072
    v_xor_b32 v112, 3, v103
    v_lshl_add_u32 v112, v112, 5, v111
    v_add_u32 v112, 49152, v112
    ds_read_b64_tr_b16 v[220:221], v112 offset:2048
    ds_read_b64_tr_b16 v[222:223], v112 offset:3072
    v_xor_b32 v112, 4, v103
    v_lshl_add_u32 v112, v112, 5, v111
    v_add_u32 v112, 49152, v112
    ds_read_b64_tr_b16 v[228:229], v112 offset:2048
    ds_read_b64_tr_b16 v[230:231], v112 offset:3072
    v_xor_b32 v112, 5, v103
    v_lshl_add_u32 v112, v112, 5, v111
    v_add_u32 v112, 49152, v112
    ds_read_b64_tr_b16 v[236:237], v112 offset:2048
    ds_read_b64_tr_b16 v[238:239], v112 offset:3072
    v_xor_b32 v112, 6, v103
    v_lshl_add_u32 v112, v112, 5, v111
    v_add_u32 v112, 49152, v112
    ds_read_b64_tr_b16 v[244:245], v112 offset:2048
    ds_read_b64_tr_b16 v[246:247], v112 offset:3072
    v_xor_b32 v112, 7, v103
    v_lshl_add_u32 v112, v112, 5, v111
    v_add_u32 v112, 49152, v112
    ds_read_b64_tr_b16 v[252:253], v112 offset:2048
    ds_read_b64_tr_b16 v[254:255], v112 offset:3072
    s_waitcnt lgkmcnt(0)
    s_barrier
    s_mov_b32 s12, s22
    s_mov_b32 s13, s23
    s_add_u32 m0, s37, 51200
    s_mov_b32 s34, 73728
    buffer_load_dwordx4 v107, s[12:15], s34 offen lds
    s_add_u32 m0, s37, 52224
    s_mov_b32 s34, 75776
    buffer_load_dwordx4 v107, s[12:15], s34 offen lds
    s_add_u32 m0, s37, 55296
    s_mov_b32 s34, 90112
    buffer_load_dwordx4 v108, s[12:15], s34 offen lds
    s_add_u32 m0, s37, 56320
    s_mov_b32 s34, 92160
    buffer_load_dwordx4 v108, s[12:15], s34 offen lds
    s_add_u32 m0, s37, 59392
    s_mov_b32 s34, 77824
    buffer_load_dwordx4 v107, s[12:15], s34 offen lds
    s_add_u32 m0, s37, 60416
    s_mov_b32 s34, 79872
    buffer_load_dwordx4 v107, s[12:15], s34 offen lds
    s_add_u32 m0, s37, 63488
    s_mov_b32 s34, 94208
    buffer_load_dwordx4 v108, s[12:15], s34 offen lds
    s_add_u32 m0, s37, 64512
    s_mov_b32 s34, 96256
    buffer_load_dwordx4 v108, s[12:15], s34 offen lds
    s_waitcnt vmcnt(24)
    s_barrier
    s_xor_b32 s34, s25, 0
    s_lshl_b32 s34, s34, 15
    s_add_u32 s34, s34, 32768
    v_add_u32 v112, s34, v109
    ds_read_b64_tr_b16 v[28:29], v112 offset:0
    ds_read_b64_tr_b16 v[30:31], v112 offset:1024
    s_xor_b32 s34, s25, 0
    s_lshl_b32 s34, s34, 15
    s_add_u32 s34, s34, 32768
    v_add_u32 v112, s34, v110
    ds_read_b64_tr_b16 v[36:37], v112 offset:0
    ds_read_b64_tr_b16 v[38:39], v112 offset:1024
    s_xor_b32 s34, s25, 1
    s_lshl_b32 s34, s34, 15
    s_add_u32 s34, s34, 32768
    v_add_u32 v112, s34, v109
    ds_read_b64_tr_b16 v[44:45], v112 offset:0
    ds_read_b64_tr_b16 v[46:47], v112 offset:1024
    s_xor_b32 s34, s25, 1
    s_lshl_b32 s34, s34, 15
    s_add_u32 s34, s34, 32768
    v_add_u32 v112, s34, v110
    ds_read_b64_tr_b16 v[52:53], v112 offset:0
    ds_read_b64_tr_b16 v[54:55], v112 offset:1024
    s_xor_b32 s34, s25, 2
    s_lshl_b32 s34, s34, 15
    s_add_u32 s34, s34, 32768
    v_add_u32 v112, s34, v109
    ds_read_b64_tr_b16 v[60:61], v112 offset:0
    ds_read_b64_tr_b16 v[62:63], v112 offset:1024
    s_xor_b32 s34, s25, 2
    s_lshl_b32 s34, s34, 15
    s_add_u32 s34, s34, 32768
    v_add_u32 v112, s34, v110
    ds_read_b64_tr_b16 v[68:69], v112 offset:0
    ds_read_b64_tr_b16 v[70:71], v112 offset:1024
    s_xor_b32 s34, s25, 3
    s_lshl_b32 s34, s34, 15
    s_add_u32 s34, s34, 32768
    v_add_u32 v112, s34, v109
    ds_read_b64_tr_b16 v[76:77], v112 offset:0
    ds_read_b64_tr_b16 v[78:79], v112 offset:1024
    s_xor_b32 s34, s25, 3
    s_lshl_b32 s34, s34, 15
    s_add_u32 s34, s34, 32768
    v_add_u32 v112, s34, v110
    ds_read_b64_tr_b16 v[84:85], v112 offset:0
    ds_read_b64_tr_b16 v[86:87], v112 offset:1024
    s_waitcnt lgkmcnt(0)
    s_barrier
    s_waitcnt vmcnt(16)
    s_barrier
    s_xor_b32 s34, s25, 0
    s_lshl_b32 s34, s34, 15
    s_add_u32 s34, s34, 32768
    v_add_u32 v112, s34, v109
    ds_read_b64_tr_b16 v[32:33], v112 offset:2048
    ds_read_b64_tr_b16 v[34:35], v112 offset:3072
    s_xor_b32 s34, s25, 0
    s_lshl_b32 s34, s34, 15
    s_add_u32 s34, s34, 32768
    v_add_u32 v112, s34, v110
    ds_read_b64_tr_b16 v[40:41], v112 offset:2048
    ds_read_b64_tr_b16 v[42:43], v112 offset:3072
    s_xor_b32 s34, s25, 1
    s_lshl_b32 s34, s34, 15
    s_add_u32 s34, s34, 32768
    v_add_u32 v112, s34, v109
    ds_read_b64_tr_b16 v[48:49], v112 offset:2048
    ds_read_b64_tr_b16 v[50:51], v112 offset:3072
    s_xor_b32 s34, s25, 1
    s_lshl_b32 s34, s34, 15
    s_add_u32 s34, s34, 32768
    v_add_u32 v112, s34, v110
    ds_read_b64_tr_b16 v[56:57], v112 offset:2048
    ds_read_b64_tr_b16 v[58:59], v112 offset:3072
    s_xor_b32 s34, s25, 2
    s_lshl_b32 s34, s34, 15
    s_add_u32 s34, s34, 32768
    v_add_u32 v112, s34, v109
    ds_read_b64_tr_b16 v[64:65], v112 offset:2048
    ds_read_b64_tr_b16 v[66:67], v112 offset:3072
    s_xor_b32 s34, s25, 2
    s_lshl_b32 s34, s34, 15
    s_add_u32 s34, s34, 32768
    v_add_u32 v112, s34, v110
    ds_read_b64_tr_b16 v[72:73], v112 offset:2048
    ds_read_b64_tr_b16 v[74:75], v112 offset:3072
    s_xor_b32 s34, s25, 3
    s_lshl_b32 s34, s34, 15
    s_add_u32 s34, s34, 32768
    v_add_u32 v112, s34, v109
    ds_read_b64_tr_b16 v[80:81], v112 offset:2048
    ds_read_b64_tr_b16 v[82:83], v112 offset:3072
    s_xor_b32 s34, s25, 3
    s_lshl_b32 s34, s34, 15
    s_add_u32 s34, s34, 32768
    v_add_u32 v112, s34, v110
    ds_read_b64_tr_b16 v[88:89], v112 offset:2048
    ds_read_b64_tr_b16 v[90:91], v112 offset:3072
    s_waitcnt lgkmcnt(0)
    s_barrier
    ds_write_b128 v2, v[28:31] offset:0
    ds_write_b128 v2, v[32:35] offset:1024
    ds_write_b128 v2, v[36:39] offset:2048
    ds_write_b128 v2, v[40:43] offset:3072
    ds_write_b128 v2, v[44:47] offset:4096
    ds_write_b128 v2, v[48:51] offset:5120
    ds_write_b128 v2, v[52:55] offset:6144
    ds_write_b128 v2, v[56:59] offset:7168
    ds_write_b128 v2, v[60:63] offset:8192
    ds_write_b128 v2, v[64:67] offset:9216
    ds_write_b128 v2, v[68:71] offset:10240
    ds_write_b128 v2, v[72:75] offset:11264
    ds_write_b128 v2, v[76:79] offset:12288
    ds_write_b128 v2, v[80:83] offset:13312
    ds_write_b128 v2, v[84:87] offset:14336
    ds_write_b128 v2, v[88:91] offset:15360
    s_waitcnt lgkmcnt(0)
    s_waitcnt vmcnt(8)
    s_barrier
    v_xor_b32 v112, 0, v103
    v_lshl_add_u32 v112, v112, 5, v111
    v_add_u32 v112, 49152, v112
    ds_read_b64_tr_b16 v[28:29], v112 offset:0
    ds_read_b64_tr_b16 v[30:31], v112 offset:1024
    v_xor_b32 v112, 1, v103
    v_lshl_add_u32 v112, v112, 5, v111
    v_add_u32 v112, 49152, v112
    ds_read_b64_tr_b16 v[36:37], v112 offset:0
    ds_read_b64_tr_b16 v[38:39], v112 offset:1024
    v_xor_b32 v112, 2, v103
    v_lshl_add_u32 v112, v112, 5, v111
    v_add_u32 v112, 49152, v112
    ds_read_b64_tr_b16 v[44:45], v112 offset:0
    ds_read_b64_tr_b16 v[46:47], v112 offset:1024
    v_xor_b32 v112, 3, v103
    v_lshl_add_u32 v112, v112, 5, v111
    v_add_u32 v112, 49152, v112
    ds_read_b64_tr_b16 v[52:53], v112 offset:0
    ds_read_b64_tr_b16 v[54:55], v112 offset:1024
    v_xor_b32 v112, 4, v103
    v_lshl_add_u32 v112, v112, 5, v111
    v_add_u32 v112, 49152, v112
    ds_read_b64_tr_b16 v[60:61], v112 offset:0
    ds_read_b64_tr_b16 v[62:63], v112 offset:1024
    v_xor_b32 v112, 5, v103
    v_lshl_add_u32 v112, v112, 5, v111
    v_add_u32 v112, 49152, v112
    ds_read_b64_tr_b16 v[68:69], v112 offset:0
    ds_read_b64_tr_b16 v[70:71], v112 offset:1024
    v_xor_b32 v112, 6, v103
    v_lshl_add_u32 v112, v112, 5, v111
    v_add_u32 v112, 49152, v112
    ds_read_b64_tr_b16 v[76:77], v112 offset:0
    ds_read_b64_tr_b16 v[78:79], v112 offset:1024
    v_xor_b32 v112, 7, v103
    v_lshl_add_u32 v112, v112, 5, v111
    v_add_u32 v112, 49152, v112
    ds_read_b64_tr_b16 v[84:85], v112 offset:0
    ds_read_b64_tr_b16 v[86:87], v112 offset:1024
    s_waitcnt lgkmcnt(0)
    s_barrier
    s_waitcnt vmcnt(0)
    s_barrier
    v_xor_b32 v112, 0, v103
    v_lshl_add_u32 v112, v112, 5, v111
    v_add_u32 v112, 49152, v112
    ds_read_b64_tr_b16 v[32:33], v112 offset:2048
    ds_read_b64_tr_b16 v[34:35], v112 offset:3072
    v_xor_b32 v112, 1, v103
    v_lshl_add_u32 v112, v112, 5, v111
    v_add_u32 v112, 49152, v112
    ds_read_b64_tr_b16 v[40:41], v112 offset:2048
    ds_read_b64_tr_b16 v[42:43], v112 offset:3072
    v_xor_b32 v112, 2, v103
    v_lshl_add_u32 v112, v112, 5, v111
    v_add_u32 v112, 49152, v112
    ds_read_b64_tr_b16 v[48:49], v112 offset:2048
    ds_read_b64_tr_b16 v[50:51], v112 offset:3072
    v_xor_b32 v112, 3, v103
    v_lshl_add_u32 v112, v112, 5, v111
    v_add_u32 v112, 49152, v112
    ds_read_b64_tr_b16 v[56:57], v112 offset:2048
    ds_read_b64_tr_b16 v[58:59], v112 offset:3072
    v_xor_b32 v112, 4, v103
    v_lshl_add_u32 v112, v112, 5, v111
    v_add_u32 v112, 49152, v112
    ds_read_b64_tr_b16 v[64:65], v112 offset:2048
    ds_read_b64_tr_b16 v[66:67], v112 offset:3072
    v_xor_b32 v112, 5, v103
    v_lshl_add_u32 v112, v112, 5, v111
    v_add_u32 v112, 49152, v112
    ds_read_b64_tr_b16 v[72:73], v112 offset:2048
    ds_read_b64_tr_b16 v[74:75], v112 offset:3072
    v_xor_b32 v112, 6, v103
    v_lshl_add_u32 v112, v112, 5, v111
    v_add_u32 v112, 49152, v112
    ds_read_b64_tr_b16 v[80:81], v112 offset:2048
    ds_read_b64_tr_b16 v[82:83], v112 offset:3072
    v_xor_b32 v112, 7, v103
    v_lshl_add_u32 v112, v112, 5, v111
    v_add_u32 v112, 49152, v112
    ds_read_b64_tr_b16 v[88:89], v112 offset:2048
    ds_read_b64_tr_b16 v[90:91], v112 offset:3072
    s_waitcnt lgkmcnt(0)
    s_barrier
    ds_write_b128 v2, v[28:31] offset:16384
    ds_write_b128 v2, v[32:35] offset:17408
    ds_write_b128 v2, v[36:39] offset:18432
    ds_write_b128 v2, v[40:43] offset:19456
    ds_write_b128 v2, v[44:47] offset:20480
    ds_write_b128 v2, v[48:51] offset:21504
    ds_write_b128 v2, v[52:55] offset:22528
    ds_write_b128 v2, v[56:59] offset:23552
    ds_write_b128 v2, v[60:63] offset:24576
    ds_write_b128 v2, v[64:67] offset:25600
    ds_write_b128 v2, v[68:71] offset:26624
    ds_write_b128 v2, v[72:75] offset:27648
    ds_write_b128 v2, v[76:79] offset:28672
    ds_write_b128 v2, v[80:83] offset:29696
    ds_write_b128 v2, v[84:87] offset:30720
    ds_write_b128 v2, v[88:91] offset:31744
    s_waitcnt lgkmcnt(0)
    s_mov_b32 s26, 0
    s_mov_b32 s42, 0
    s_mov_b32 s40, 0
    s_mov_b32 s41, 0x10000
    s_mov_b32 s28, 87031808
    s_mov_b32 s29, 87035904
    s_mov_b32 s30, 87040000
    s_lshl_b32 s31, s24, 12
    s_add_u32 s33, s31, 77594624
    s_add_u32 s31, s31, 18874368
    s_mov_b32 s32, 0
    s_lshl_b32 s49, s25, 10
    s_add_u32 s49, s49, 8192
    s_mov_b32 s38, 0
    s_lshr_b32 s39, s24, 1
    s_lshl_b32 s39, s39, 6
    s_add_u32 s39, s39, 87097344
    s_lshl_b32 s27, s24, 7
    s_add_u32 s27, s27, 87105536
    s_cmp_eq_u32 s25, 0
    s_cselect_b32 s27, s27, 0x7ffffff0
    s_lshl_b32 s100, s24, 2
    s_add_u32 s100, s100, 87109632
    s_cmp_eq_u32 s25, 0
    s_cselect_b32 s100, s100, 0x7ffffff0
    s_lshl_b32 s101, s24, 7
    s_add_u32 s101, s101, 87109632
    s_mov_b32 s101, 4096
    v_mov_b32 v24, 0
    s_mov_b32 s46, 0
L_ri_poll:
    buffer_load_dwordx3 v[36:38], v24, s[8:11], 0 offen offset:0 sc0 sc1
    buffer_load_dword v39, v24, s[8:11], 0 offen offset:128 sc0 sc1
    s_add_u32 s46, s46, 1
    s_cmp_lt_u32 s46, 262144
    s_cbranch_scc0 L_rec_exit
    s_waitcnt vmcnt(0)
    v_readfirstlane_b32 s34, v38
    v_readfirstlane_b32 s35, v39
    v_readfirstlane_b32 s48, v37
    s_cmp_lt_u32 s34, 32
    s_cbranch_scc1 L_ri_poll
    s_cmp_lt_u32 s35, 1
    s_cbranch_scc1 L_ri_poll
    s_mov_b32 s35, 0
    s_mov_b32 s36, 0
L_ens_p:
    s_cmp_lt_u32 s35, s38
    s_cbranch_scc1 L_ensd_p
    v_mbcnt_lo_u32_b32 v24, -1, 0
    v_mbcnt_hi_u32_b32 v24, -1, v24
    v_and_b32 v24, 15, v24
    v_lshlrev_b32 v24, 2, v24
    buffer_load_dword v25, v24, s[4:7], s39 offen sc0 sc1
    s_add_u32 s36, s36, 1
    s_cmp_lt_u32 s36, 262144
    s_cbranch_scc0 L_rec_exit
    s_waitcnt vmcnt(0)
    v_and_b32 v25, 255, v25
    v_cmp_ne_u32 vcc, 2, v25
    s_nop 0
    s_or_b32 s34, vcc_lo, 0x10000
    s_ff1_i32_b32 s38, s34
    s_branch L_ens_p
L_ensd_p:
    s_mov_b32 m0, s49
    s_add_u32 s34, s31, 131072
    buffer_load_dwordx4 v1, s[4:7], s31 offen sc1 lds
    s_add_u32 m0, s49, 4096
    s_nop 0
    buffer_load_dwordx4 v1, s[4:7], s34 offen sc1 lds
    s_add_u32 s31, s31, 262144
    s_xor_b32 s49, s49, 24576
    s_cmp_lg_u32 s48, 0
    s_cbranch_scc1 L_rec_slow_entry
    ds_read_b128 v[92:95], v2 offset:0
    ds_read_b128 v[96:99], v2 offset:1024
    ds_read_b128 v[100:103], v2 offset:2048
    ds_read_b128 v[104:107], v2 offset:3072
    ds_read_b128 v[108:111], v2 offset:4096
    ds_read_b128 v[112:115], v2 offset:5120
    ds_read_b128 v[116:119], v2 offset:6144
    ds_read_b128 v[120:123], v2 offset:7168
    v_mov_b64 v[68:69], 0
    v_mov_b64 v[70:71], 0
    v_mov_b64 v[72:73], 0
    v_mov_b64 v[74:75], 0
    v_mov_b64 v[76:77], 0
    v_mov_b64 v[78:79], 0
    v_mov_b64 v[80:81], 0
    v_mov_b64 v[82:83], 0
    v_mov_b64 v[84:85], 0
    v_mov_b64 v[86:87], 0
    v_mov_b64 v[88:89], 0
    v_mov_b64 v[90:91], 0
    s_mov_b32 s46, 0
    buffer_load_dwordx4 v[36:39], v1, s[4:7], s28 offen sc1
    buffer_load_dwordx4 v[28:31], v1, s[4:7], s28 offen sc1
.p2align 3
L_loop_f:
    s_waitcnt vmcnt(1)
    v_cmp_lt_u32 vcc, s43, v36
    ds_write_b128 v1, v[36:39]
    s_cbranch_vccnz L_af0_f
L_aok_f:
    buffer_load_dwordx4 v[52:55], v1, s[4:7], s29 offen sc1
    v_smfmac_f32_16x16x64_bf16 v[68:71], v[36:39], a[0:7], v0
    v_xor_b32 v27, 3072, v1
    v_smfmac_f32_16x16x64_bf16 v[72:75], v[36:39], v[128:135], v0
    v_smfmac_f32_16x16x64_bf16 v[76:79], v[36:39], a[8:15], v0
    v_smfmac_f32_16x16x64_bf16 v[80:83], v[36:39], v[136:143], v0
    s_waitcnt lgkmcnt(0)
    s_barrier
    ds_read_b128 v[40:43], v14 offset:0
    ds_read_b128 v[44:47], v15 offset:0
    ds_read_b128 v[48:51], v27 offset:0
    v_smfmac_f32_16x16x64_bf16 v[84:87], v[36:39], a[128:135], v0
    v_smfmac_f32_16x16x64_bf16 v[88:91], v[36:39], a[136:143], v0
    s_waitcnt lgkmcnt(2)
    v_smfmac_f32_16x16x64_bf16 v[68:71], v[40:43], a[16:23], v0
    v_smfmac_f32_16x16x64_bf16 v[72:75], v[40:43], v[144:151], v0
    v_smfmac_f32_16x16x64_bf16 v[76:79], v[40:43], a[24:31], v0
    v_smfmac_f32_16x16x64_bf16 v[80:83], v[40:43], v[152:159], v0
    s_waitcnt lgkmcnt(1)
    v_smfmac_f32_16x16x64_bf16 v[68:71], v[44:47], a[32:39], v0
    v_smfmac_f32_16x16x64_bf16 v[72:75], v[44:47], v[160:167], v0
    v_smfmac_f32_16x16x64_bf16 v[76:79], v[44:47], a[40:47], v0
    v_smfmac_f32_16x16x64_bf16 v[80:83], v[44:47], v[168:175], v0
    s_waitcnt lgkmcnt(0)
    v_smfmac_f32_16x16x64_bf16 v[68:71], v[48:51], a[48:55], v0
    s_waitcnt vmcnt(0)
    v_cmp_lt_u32 vcc, s43, v52
    ds_write_b128 v1, v[52:55] offset:4096
    s_cbranch_vccnz L_bf0_f
L_bok_f:
    v_smfmac_f32_16x16x64_bf16 v[72:75], v[48:51], v[176:183], v0
    v_smfmac_f32_16x16x64_bf16 v[76:79], v[48:51], a[56:63], v0
    v_smfmac_f32_16x16x64_bf16 v[80:83], v[48:51], v[184:191], v0
    v_smfmac_f32_16x16x64_bf16 v[68:71], v[52:55], a[64:71], v0
    s_waitcnt lgkmcnt(0)
    s_barrier
    ds_read_b128 v[56:59], v14 offset:4096
    ds_read_b128 v[60:63], v15 offset:4096
    ds_read_b128 v[64:67], v27 offset:4096
    v_smfmac_f32_16x16x64_bf16 v[72:75], v[52:55], v[92:99], v0
    ds_read_b128 v[92:95], v2 offset:8192
    v_smfmac_f32_16x16x64_bf16 v[76:79], v[52:55], a[72:79], v0
    ds_read_b128 v[96:99], v2 offset:9216
    v_smfmac_f32_16x16x64_bf16 v[80:83], v[52:55], v[100:107], v0
    ds_read_b128 v[100:103], v2 offset:10240
    ds_read_b128 v[104:107], v2 offset:11264
    buffer_store_dword v0, v12, s[4:7], s30 offen
    s_waitcnt lgkmcnt(6)
    v_smfmac_f32_16x16x64_bf16 v[72:75], v[56:59], v[108:115], v0
    ds_read_b128 v[108:111], v2 offset:12288
    v_smfmac_f32_16x16x64_bf16 v[80:83], v[56:59], v[116:123], v0
    ds_read_b128 v[112:115], v2 offset:13312
    v_smfmac_f32_16x16x64_bf16 v[68:71], v[56:59], a[80:87], v0
    ds_read_b128 v[116:119], v2 offset:14336
    v_smfmac_f32_16x16x64_bf16 v[76:79], v[56:59], a[88:95], v0
    ds_read_b128 v[120:123], v2 offset:15360
    buffer_load_dwordx4 v[28:31], v7, s[4:7], s32 offen sc1
    s_waitcnt lgkmcnt(4)
    v_smfmac_f32_16x16x64_bf16 v[72:75], v[60:63], v[92:99], v0
    ds_read_b128 v[92:95], v6 offset:0
    v_smfmac_f32_16x16x64_bf16 v[80:83], v[60:63], v[100:107], v0
    ds_read_b128 v[96:99], v6 offset:1024
    v_smfmac_f32_16x16x64_bf16 v[68:71], v[60:63], a[96:103], v0
    ds_read_b128 v[100:103], v6 offset:2048
    s_waitcnt lgkmcnt(3)
    v_smfmac_f32_16x16x64_bf16 v[72:75], v[64:67], v[108:115], v0
    ds_read_b128 v[104:107], v6 offset:3072
    v_smfmac_f32_16x16x64_bf16 v[80:83], v[64:67], v[116:123], v0
    ds_read_b128 v[108:111], v6 offset:4096
    v_smfmac_f32_16x16x64_bf16 v[68:71], v[64:67], a[112:119], v0
    ds_read_b128 v[112:115], v6 offset:5120
    buffer_load_dwordx4 v[32:35], v7, s[4:7], s32 offen offset:1024 sc1
    v_smfmac_f32_16x16x64_bf16 v[76:79], v[60:63], a[104:111], v0
    ds_read_b128 v[116:119], v6 offset:6144
    v_add_f32_e64 v72, v72, v73
    v_smfmac_f32_16x16x64_bf16 v[76:79], v[64:67], a[120:127], v0
    ds_read_b128 v[120:123], v6 offset:7168
    v_add_f32 v73, v74, v75
    v_add_f32 v80, v80, v81
    v_add_f32 v81, v82, v83
    v_add_f32 v68, v68, v69
    v_add_f32_e64 v69, v70, v71
    v_cvt_pk_bf16_f32 v125, v72, v80
    v_cvt_pk_bf16_f32 v127, v73, v81
    v_add_f32 v76, v76, v77
    v_add_f32 v77, v78, v79
    v_cvt_pk_bf16_f32 v24, v68, v76
    v_cvt_pk_bf16_f32 v25, v69, v77
    ds_write2_b32 v3, v24, v25 offset0:0 offset1:136
    ds_write2_b32 v3, v125, v127 offset0:68 offset1:204
    v_smfmac_f32_16x16x64_bf16 v[84:87], v[40:43], a[144:151], v0
    v_smfmac_f32_16x16x64_bf16 v[88:91], v[40:43], a[152:159], v0
    v_smfmac_f32_16x16x64_bf16 v[84:87], v[44:47], a[160:167], v0
    v_smfmac_f32_16x16x64_bf16 v[88:91], v[44:47], a[168:175], v0
    s_waitcnt lgkmcnt(0)
    s_barrier
    ds_read_b128 v[68:71], v4 offset:0
    ds_read_b128 v[72:75], v4 offset:64
    v_smfmac_f32_16x16x64_bf16 v[84:87], v[48:51], a[176:183], v0
    ds_read_b128 v[76:79], v4 offset:128
    v_smfmac_f32_16x16x64_bf16 v[88:91], v[48:51], a[184:191], v0
    ds_read_b128 v[80:83], v4 offset:192
    v_smfmac_f32_16x16x64_bf16 v[84:87], v[52:55], a[192:199], v0
    ds_read_b128 v[36:39], v5 offset:0
    v_smfmac_f32_16x16x64_bf16 v[88:91], v[52:55], a[200:207], v0
    ds_read_b128 v[40:43], v5 offset:64
    v_smfmac_f32_16x16x64_bf16 v[84:87], v[56:59], a[208:215], v0
    ds_read_b128 v[44:47], v5 offset:128
    v_smfmac_f32_16x16x64_bf16 v[88:91], v[56:59], a[216:223], v0
    ds_read_b128 v[48:51], v5 offset:192
    v_smfmac_f32_16x16x64_bf16 v[84:87], v[60:63], a[224:231], v0
    s_mov_b32 m0, s49
    v_smfmac_f32_16x16x64_bf16 v[88:91], v[60:63], a[232:239], v0
    v_smfmac_f32_16x16x64_bf16 v[84:87], v[64:67], a[240:247], v0
    v_smfmac_f32_16x16x64_bf16 v[88:91], v[64:67], a[248:255], v0
    s_waitcnt lgkmcnt(4)
    v_mfma_f32_16x16x32_bf16 v[52:55], v[92:95], v[68:71], 0
    buffer_load_dwordx4 v1, s[4:7], s31 offen sc1 lds
    v_mfma_f32_16x16x32_bf16 v[56:59], v[108:111], v[68:71], 0
    s_add_u32 m0, s49, 4096
    s_add_u32 s34, s31, 131072
    v_mfma_f32_16x16x32_bf16 v[52:55], v[96:99], v[72:75], v[52:55]
    buffer_load_dwordx4 v1, s[4:7], s34 offen sc1 lds
    v_mfma_f32_16x16x32_bf16 v[56:59], v[112:115], v[72:75], v[56:59]
    v_mov_b32_e64 v24, s26
    v_mfma_f32_16x16x32_bf16 v[52:55], v[100:103], v[76:79], v[52:55]
    v_add_f32 v84, v84, v85
    v_add_f32 v85, v86, v87
    v_mfma_f32_16x16x32_bf16 v[56:59], v[116:119], v[76:79], v[56:59]
    v_add_f32 v88, v88, v89
    v_add_f32 v89, v90, v91
    v_mfma_f32_16x16x32_bf16 v[52:55], v[104:107], v[80:83], v[52:55]
    v_cvt_pk_bf16_f32 v124, v84, v85
    v_cvt_pk_bf16_f32 v126, v88, v89
    v_mfma_f32_16x16x32_bf16 v[56:59], v[120:123], v[80:83], v[56:59]
    s_waitcnt lgkmcnt(0)
    v_mfma_f32_16x16x32_bf16 v[60:63], v[36:39], v[68:71], 0
    buffer_store_dwordx4 v[124:127], v1, s[4:7], s33 offen sc1
    v_mfma_f32_16x16x32_bf16 v[60:63], v[40:43], v[72:75], v[60:63]
    buffer_store_dword v24, off, s[4:7], s27 sc1
    s_cmp_eq_u32 s26, 63
    v_mfma_f32_16x16x32_bf16 v[60:63], v[44:47], v[76:79], v[60:63]
    v_max3_f32 v26, v52, v53, v54
    v_max3_f32 v27, v55, v56, v57
    v_mfma_f32_16x16x32_bf16 v[60:63], v[48:51], v[80:83], v[60:63]
    s_cbranch_scc1 L_rec_fin
    v_max3_f32 v26, v26, v58, v59
    v_max_f32 v26, v26, v27
    ds_read_b128 v[36:39], v2 offset:16384
    ds_read_b128 v[40:43], v2 offset:17408
    ds_read_b128 v[44:47], v2 offset:18432
    ds_read_b128 v[48:51], v2 offset:19456
    s_nop 0
    v_max3_f32 v27, v26, v60, v61
    v_max3_f32 v26, v26, v60, v61
    v_mov_b32 v69, 0
    s_nop 0
    v_permlane32_swap_b32 v26, v27
    v_max_f32 v24, v26, v27
    v_max_f32 v25, v26, v27
    s_nop 1
    v_permlane16_swap_b32 v24, v25
    v_max_f32 v26, v24, v25
    v_mul_f32 v26, s44, v26
    v_pk_fma_f32 v[60:61], v[60:61], s[44:45], v[26:27] op_sel_hi:[1,1,0] neg_lo:[0,0,1] neg_hi:[0,0,1]
    v_pk_fma_f32 v[52:53], v[52:53], s[44:45], v[26:27] op_sel_hi:[1,1,0] neg_lo:[0,0,1] neg_hi:[0,0,1]
    v_pk_fma_f32 v[54:55], v[54:55], s[44:45], v[26:27] op_sel_hi:[1,1,0] neg_lo:[0,0,1] neg_hi:[0,0,1]
    v_pk_fma_f32 v[56:57], v[56:57], s[44:45], v[26:27] op_sel_hi:[1,1,0] neg_lo:[0,0,1] neg_hi:[0,0,1]
    v_pk_fma_f32 v[58:59], v[58:59], s[44:45], v[26:27] op_sel_hi:[1,1,0] neg_lo:[0,0,1] neg_hi:[0,0,1]
    v_exp_f32 v60, v60
    v_exp_f32 v61, v61
    v_exp_f32_e64 v52, v52
    v_cvt_pk_bf16_f32 v68, v60, v61
    v_exp_f32 v53, v53
    v_exp_f32 v54, v54
    v_mfma_f32_16x16x16_bf16 v[76:79], v[20:21], v[68:69], 0
    v_exp_f32_e64 v55, v55
    v_cvt_pk_bf16_f32 v72, v52, v53
    v_mfma_f32_16x16x16_bf16 v[84:87], v[124:125], v[68:69], 0
    v_exp_f32_e64 v56, v56
    v_cvt_pk_bf16_f32 v73, v54, v55
    v_mfma_f32_16x16x16_bf16 v[88:91], v[126:127], v[68:69], 0
    v_exp_f32 v57, v57
    v_exp_f32 v58, v58
    v_exp_f32_e64 v59, v59
    v_cvt_pk_bf16_f32 v74, v56, v57
    v_cvt_pk_bf16_f32 v75, v58, v59
    s_waitcnt vmcnt(4)
    s_nop 0
    v_mfma_f32_16x16x32_bf16 v[76:79], v[20:23], v[72:75], v[76:79]
    ds_read_b128 v[52:55], v2 offset:20480
    ds_read_b128 v[56:59], v2 offset:21504
    v_mfma_f32_16x16x32_bf16 v[84:87], v[28:31], v[72:75], v[84:87]
    ds_read_b128 v[60:63], v2 offset:22528
    ds_read_b128 v[64:67], v2 offset:23552
    v_mfma_f32_16x16x32_bf16 v[88:91], v[32:35], v[72:75], v[88:91]
    v_rcp_f32 v26, v76
    v_mov_b64 v[92:93], 0
    s_nop 1
    v_mul_f32 v84, v26, v84
    v_mul_f32 v85, v26, v85
    v_mul_f32 v86, v26, v86
    v_mul_f32_e64 v87, v26, v87
    v_cvt_pk_bf16_f32 v80, v84, v85
    v_cvt_pk_bf16_f32 v81, v86, v87
    v_mul_f32 v88, v26, v88
    v_mul_f32 v89, v26, v89
    v_mul_f32 v90, v26, v90
    v_mul_f32 v91, v26, v91
    v_cvt_pk_bf16_f32 v82, v88, v89
    v_cvt_pk_bf16_f32 v83, v90, v91
    ds_write_b128 v8, v[80:83]
    v_mov_b64 v[94:95], 0
    v_mov_b64 v[96:97], 0
    v_mov_b64 v[98:99], 0
    v_mov_b64 v[100:101], 0
    v_mov_b64 v[102:103], 0
    v_mov_b64 v[104:105], 0
    v_mov_b64 v[106:107], 0
    v_mov_b64 v[108:109], 0
    v_mov_b64 v[110:111], 0
    v_mov_b64 v[112:113], 0
    v_mov_b64 v[114:115], 0
    v_mov_b64 v[116:117], 0
    v_mov_b64 v[118:119], 0
    v_mov_b64 v[120:121], 0
    v_mov_b64 v[122:123], 0
    s_waitcnt lgkmcnt(0)
    s_barrier
    s_nop 0
    ds_read_b128 v[84:87], v9
    ds_read_b128 v[88:91], v9 offset:128
    s_add_u32 s31, s31, 262144
    s_xor_b32 s49, s49, 24576
    s_add_u32 s32, s32, 262144
    s_add_u32 s33, s33, 131072
    v_xor_b32 v6, 24576, v6
    s_waitcnt lgkmcnt(1)
    v_smfmac_f32_16x16x64_bf16 v[92:95], v[84:87], v[192:199], v0
    s_waitcnt lgkmcnt(0)
    v_smfmac_f32_16x16x64_bf16 v[92:95], v[88:91], v[36:43], v0
    ds_read_b128 v[36:39], v2 offset:24576
    ds_read_b128 v[40:43], v2 offset:25600
    v_smfmac_f32_16x16x64_bf16 v[96:99], v[84:87], v[200:207], v0
    v_smfmac_f32_16x16x64_bf16 v[96:99], v[88:91], v[44:51], v0
    ds_read_b128 v[44:47], v2 offset:26624
    ds_read_b128 v[48:51], v2 offset:27648
    v_smfmac_f32_16x16x64_bf16 v[100:103], v[84:87], v[208:215], v0
    v_add_f32_e64 v68, v92, v93
    v_smfmac_f32_16x16x64_bf16 v[100:103], v[88:91], v[52:59], v0
    ds_read_b128 v[52:55], v2 offset:28672
    ds_read_b128 v[56:59], v2 offset:29696
    v_add_f32 v69, v94, v95
    v_add_u32 v68, s41, v68
    v_and_or_b32 v68, v68, v13, s40
    v_smfmac_f32_16x16x64_bf16 v[104:107], v[84:87], v[216:223], v0
    v_add_f32_e64 v70, v96, v97
    v_smfmac_f32_16x16x64_bf16 v[104:107], v[88:91], v[60:67], v0
    ds_read_b128 v[60:63], v2 offset:30720
    ds_read_b128 v[64:67], v2 offset:31744
    v_add_f32_e64 v71, v98, v99
    v_cvt_pk_bf16_f32 v28, v68, v70
    v_cvt_pk_bf16_f32 v30, v69, v71
    v_smfmac_f32_16x16x64_bf16 v[108:111], v[84:87], v[224:231], v0
    v_add_f32 v72, v100, v101
    s_waitcnt lgkmcnt(6)
    v_smfmac_f32_16x16x64_bf16 v[108:111], v[88:91], v[36:43], v0
    v_add_f32_e64 v73, v102, v103
    v_smfmac_f32_16x16x64_bf16 v[112:115], v[84:87], v[232:239], v0
    v_add_f32 v74, v104, v105
    s_waitcnt lgkmcnt(4)
    v_smfmac_f32_16x16x64_bf16 v[112:115], v[88:91], v[44:51], v0
    v_add_f32_e64 v75, v106, v107
    v_cvt_pk_bf16_f32 v29, v72, v74
    v_cvt_pk_bf16_f32 v31, v73, v75
    buffer_store_dwordx4 v[28:31], v10, s[4:7], 0 offen
    v_smfmac_f32_16x16x64_bf16 v[116:119], v[84:87], v[240:247], v0
    v_add_f32 v76, v108, v109
    s_waitcnt lgkmcnt(2)
    v_smfmac_f32_16x16x64_bf16 v[116:119], v[88:91], v[52:59], v0
    v_add_f32 v77, v110, v111
    v_add_u32 v76, s41, v76
    v_and_or_b32 v76, v76, v13, s40
    v_smfmac_f32_16x16x64_bf16 v[120:123], v[84:87], v[248:255], v0
    v_add_f32 v78, v112, v113
    s_waitcnt lgkmcnt(0)
    v_smfmac_f32_16x16x64_bf16 v[120:123], v[88:91], v[60:67], v0
    v_add_f32_e64 v79, v114, v115
    v_cvt_pk_bf16_f32 v32, v76, v78
    v_cvt_pk_bf16_f32 v34, v77, v79
    v_add_f32 v80, v116, v117
    v_add_f32 v81, v118, v119
    s_nop 2
    v_add_f32 v82, v120, v121
    v_add_f32_e64 v83, v122, v123
    v_cvt_pk_bf16_f32 v33, v80, v82
    v_cvt_pk_bf16_f32 v35, v81, v83
    buffer_store_dwordx4 v[32:35], v10, s[4:7], s101 offen
    s_mov_b32 s46, 0
    s_add_u32 s35, s26, 2
    s_lshr_b32 s35, s35, 2
    s_cmp_eq_u32 s26, 16
    s_cselect_b32 s35, 15, s35
    s_min_u32 s35, s35, 15
    s_cmp_lt_u32 s35, s38
    s_cbranch_scc0 L_need_f
L_have_f:
L_h1_f:
    s_nop 15
    s_nop 13
    s_cmp_lt_u32 s25, 2
    s_cbranch_scc1 L_wd1_f
    s_nop 15
    s_nop 15
    s_nop 7
    s_nop 0
L_wd1_f:
    buffer_load_dwordx4 v[56:59], v11, s[4:7], 0 offen offset:0 sc1
    buffer_load_dwordx4 v[60:63], v11, s[4:7], 0 offen offset:1024 sc1
    ds_read_b128 v[92:95], v2 offset:0
    ds_read_b128 v[96:99], v2 offset:1024
    ds_read_b128 v[100:103], v2 offset:2048
    ds_read_b128 v[104:107], v2 offset:3072
    ds_read_b128 v[108:111], v2 offset:4096
    ds_read_b128 v[112:115], v2 offset:5120
    ds_read_b128 v[116:119], v2 offset:6144
    ds_read_b128 v[120:123], v2 offset:7168
    v_mov_b64 v[68:69], 0
    v_mov_b64 v[70:71], 0
    v_mov_b64 v[72:73], 0
    v_mov_b64 v[74:75], 0
    v_mov_b64 v[76:77], 0
    v_mov_b64 v[78:79], 0
    v_mov_b64 v[80:81], 0
    v_mov_b64 v[82:83], 0
    v_mov_b64 v[84:85], 0
    v_mov_b64 v[86:87], 0
    v_mov_b64 v[88:89], 0
    v_mov_b64 v[90:91], 0
    s_nop 9
    buffer_load_dwordx4 v[40:43], v11, s[4:7], 0 offen offset:0 sc1
    buffer_load_dwordx4 v[44:47], v11, s[4:7], 0 offen offset:1024 sc1
    s_waitcnt vmcnt(2)
    v_bitop3_b32 v64, v56, v60, s42 bitop3:0x7e
    v_mfma_f32_16x16x32_bf16 v[24:27], v[56:59], v[16:19], 0
    v_and_b32 v64, 1, v64
    v_cmp_ne_u32 vcc, 0, v64
    v_mfma_f32_16x16x32_bf16 v[24:27], v[60:63], v[16:19], v[24:27]
    s_cbranch_vccnz L_rf0_f
L_rok_f:
    s_nop 6
    v_permlane32_swap_b32 v24, v26
    v_permlane32_swap_b32 v25, v27
    v_add_f32 v24, v24, v26
    v_add_f32 v25, v25, v27
    s_nop 1
    v_permlane16_swap_b32 v24, v25
    v_add_f32 v24, v24, v25
    s_nop 1
    v_mov_b32_dpp v25, v24 quad_perm:[1,0,3,2] row_mask:0xf bank_mask:0xf
    v_cvt_pk_bf16_f32 v24, v24, v25
    v_min_u32_e64 v24, s43, v24
    buffer_store_dword v24, v12, s[4:7], s30 offen
    s_xor_b32 s28, s28, 8192
    s_xor_b32 s29, s29, 8192
    s_xor_b32 s30, s30, 8192
    s_xor_b32 s42, s42, 1
    s_xor_b32 s40, s40, 0x10000
    s_xor_b32 s41, s41, 0x10000
    s_add_u32 s26, s26, 1
    s_mov_b32 s46, 0
    s_nop 15
    s_nop 3
    s_cmp_lt_u32 s25, 2
    s_cbranch_scc0 L_wd2_f
    s_nop 15
    s_nop 15
    s_nop 7
L_wd2_f:
    buffer_load_dwordx4 v[36:39], v1, s[4:7], s28 offen sc1
    s_nop 15
    s_nop 13
    buffer_load_dwordx4 v[28:31], v1, s[4:7], s28 offen sc1
    s_branch L_loop_f
L_need_f:
    s_mov_b32 s36, 0
L_ens_f:
    s_cmp_lt_u32 s35, s38
    s_cbranch_scc1 L_ensd_f
    v_mbcnt_lo_u32_b32 v24, -1, 0
    v_mbcnt_hi_u32_b32 v24, -1, v24
    v_and_b32 v24, 15, v24
    v_lshlrev_b32 v24, 2, v24
    buffer_load_dword v25, v24, s[4:7], s39 offen sc0 sc1
    s_add_u32 s36, s36, 1
    s_cmp_lt_u32 s36, 262144
    s_cbranch_scc0 L_rec_exit
    s_waitcnt vmcnt(0)
    v_and_b32 v25, 255, v25
    v_cmp_ne_u32 vcc, 2, v25
    s_nop 0
    s_or_b32 s34, vcc_lo, 0x10000
    s_ff1_i32_b32 s38, s34
    s_branch L_ens_f
L_ensd_f:
    s_branch L_have_f
L_hf_f:
    buffer_load_dword v25, v27, s[4:7], s101 offen sc1
L_hl_f:
    s_waitcnt vmcnt(1)
    v_cmp_gt_u32 vcc, s3, v24
    s_cbranch_vccz L_hd_f
    buffer_load_dword v24, v27, s[4:7], s101 offen sc1
    s_waitcnt vmcnt(1)
    v_cmp_gt_u32 vcc, s3, v25
    s_cbranch_vccz L_hd_f
    buffer_load_dword v25, v27, s[4:7], s101 offen sc1
    s_add_u32 s46, s46, 1
    s_cmp_lt_u32 s46, 262144
    s_cbranch_scc1 L_hl_f
    s_endpgm
L_hd_f:
    s_nop 15
    s_nop 13
    s_branch L_h1_f
L_af0_f:
    s_mov_b64 exec, vcc
    s_mov_b64 s[50:51], vcc
    buffer_load_dwordx4 v[32:35], v1, s[4:7], s28 offen sc1
L_al_f:
    s_add_u32 s46, s46, 1
    s_waitcnt vmcnt(1)
    v_cmp_lt_u32 vcc, s43, v28
    s_nop 0
    s_andn2_b64 exec, s[50:51], vcc
    v_mov_b64 v[36:37], v[28:29]
    v_mov_b64 v[38:39], v[30:31]
    s_and_b64 s[50:51], s[50:51], vcc
    s_cbranch_scc0 L_ad_f
    s_mov_b64 exec, s[50:51]
    buffer_load_dwordx4 v[28:31], v1, s[4:7], s28 offen sc1
    s_add_u32 s46, s46, 1
    s_waitcnt vmcnt(1)
    v_cmp_lt_u32 vcc, s43, v32
    s_nop 0
    s_andn2_b64 exec, s[50:51], vcc
    v_mov_b64 v[36:37], v[32:33]
    v_mov_b64 v[38:39], v[34:35]
    s_and_b64 s[50:51], s[50:51], vcc
    s_cbranch_scc0 L_ad_f
    s_mov_b64 exec, s[50:51]
    buffer_load_dwordx4 v[32:35], v1, s[4:7], s28 offen sc1
    s_cmp_lt_u32 s46, 262144
    s_cbranch_scc1 L_al_f
    s_endpgm
L_ad_f:
    s_mov_b64 exec, -1
    ds_write_b128 v1, v[36:39]
    s_branch L_aok_f
L_bf0_f:
    s_mov_b64 exec, vcc
    s_mov_b64 s[50:51], vcc
    buffer_load_dwordx4 v[28:31], v1, s[4:7], s29 offen sc1
    s_nop 15
    s_nop 3
    buffer_load_dwordx4 v[32:35], v1, s[4:7], s29 offen sc1
L_bl_f:
    s_add_u32 s46, s46, 1
    s_waitcnt vmcnt(1)
    v_cmp_lt_u32 vcc, s43, v28
    s_nop 0
    s_andn2_b64 exec, s[50:51], vcc
    v_mov_b64 v[52:53], v[28:29]
    v_mov_b64 v[54:55], v[30:31]
    s_and_b64 s[50:51], s[50:51], vcc
    s_cbranch_scc0 L_bd_f
    s_mov_b64 exec, s[50:51]
    buffer_load_dwordx4 v[28:31], v1, s[4:7], s29 offen sc1
    s_add_u32 s46, s46, 1
    s_waitcnt vmcnt(1)
    v_cmp_lt_u32 vcc, s43, v32
    s_nop 0
    s_andn2_b64 exec, s[50:51], vcc
    v_mov_b64 v[52:53], v[32:33]
    v_mov_b64 v[54:55], v[34:35]
    s_and_b64 s[50:51], s[50:51], vcc
    s_cbranch_scc0 L_bd_f
    s_mov_b64 exec, s[50:51]
    buffer_load_dwordx4 v[32:35], v1, s[4:7], s29 offen sc1
    s_cmp_lt_u32 s46, 262144
    s_cbranch_scc1 L_bl_f
    s_endpgm
L_bd_f:
    s_mov_b64 exec, -1
    ds_write_b128 v1, v[52:55] offset:4096
    s_branch L_bok_f
L_rf0_f:
    s_mov_b64 exec, vcc
    s_mov_b64 s[50:51], vcc
    buffer_load_dwordx4 v[48:51], v11, s[4:7], 0 offen offset:0 sc1
    buffer_load_dwordx4 v[52:55], v11, s[4:7], 0 offen offset:1024 sc1
L_rl_f:
    s_add_u32 s46, s46, 1
    s_waitcnt vmcnt(2)
    v_bitop3_b32 v64, v40, v44, s42 bitop3:0x7e
    v_and_b32 v64, 1, v64
    v_cmp_ne_u32 vcc, 0, v64
    s_nop 0
    s_andn2_b64 exec, s[50:51], vcc
    v_mov_b64 v[56:57], v[40:41]
    v_mov_b64 v[58:59], v[42:43]
    v_mov_b64 v[60:61], v[44:45]
    v_mov_b64 v[62:63], v[46:47]
    s_and_b64 s[50:51], s[50:51], vcc
    s_cbranch_scc0 L_rd_f
    s_mov_b64 exec, s[50:51]
    buffer_load_dwordx4 v[40:43], v11, s[4:7], 0 offen offset:0 sc1
    buffer_load_dwordx4 v[44:47], v11, s[4:7], 0 offen offset:1024 sc1
    s_add_u32 s46, s46, 1
    s_waitcnt vmcnt(2)
    v_bitop3_b32 v64, v48, v52, s42 bitop3:0x7e
    v_and_b32 v64, 1, v64
    v_cmp_ne_u32 vcc, 0, v64
    s_nop 0
    s_andn2_b64 exec, s[50:51], vcc
    v_mov_b64 v[56:57], v[48:49]
    v_mov_b64 v[58:59], v[50:51]
    v_mov_b64 v[60:61], v[52:53]
    v_mov_b64 v[62:63], v[54:55]
    s_and_b64 s[50:51], s[50:51], vcc
    s_cbranch_scc0 L_rd_f
    s_mov_b64 exec, s[50:51]
    buffer_load_dwordx4 v[48:51], v11, s[4:7], 0 offen offset:0 sc1
    buffer_load_dwordx4 v[52:55], v11, s[4:7], 0 offen offset:1024 sc1
    s_cmp_lt_u32 s46, 262144
    s_cbranch_scc1 L_rl_f
    s_endpgm
L_rd_f:
    s_mov_b64 exec, -1
    v_mfma_f32_16x16x32_bf16 v[24:27], v[56:59], v[16:19], 0
    v_mfma_f32_16x16x32_bf16 v[24:27], v[60:63], v[16:19], v[24:27]
    s_branch L_rok_f
L_rec_slow_entry:
    ds_read_b128 v[92:95], v2 offset:0
    ds_read_b128 v[96:99], v2 offset:1024
    ds_read_b128 v[100:103], v2 offset:2048
    ds_read_b128 v[104:107], v2 offset:3072
    ds_read_b128 v[108:111], v2 offset:4096
    ds_read_b128 v[112:115], v2 offset:5120
    ds_read_b128 v[116:119], v2 offset:6144
    ds_read_b128 v[120:123], v2 offset:7168
    v_mov_b64 v[68:69], 0
    v_mov_b64 v[70:71], 0
    v_mov_b64 v[72:73], 0
    v_mov_b64 v[74:75], 0
    v_mov_b64 v[76:77], 0
    v_mov_b64 v[78:79], 0
    v_mov_b64 v[80:81], 0
    v_mov_b64 v[82:83], 0
    v_mov_b64 v[84:85], 0
    v_mov_b64 v[86:87], 0
    v_mov_b64 v[88:89], 0
    v_mov_b64 v[90:91], 0
    s_mov_b32 s46, 0
    buffer_load_dwordx4 v[36:39], v1, s[4:7], s28 offen sc1
    buffer_load_dwordx4 v[28:31], v1, s[4:7], s28 offen sc1
L_loop_s:
    s_waitcnt vmcnt(1)
    v_cmp_lt_u32 vcc, s43, v36
    ds_write_b128 v1, v[36:39]
    s_cbranch_vccnz L_af0_s
L_aok_s:
    buffer_load_dwordx4 v[52:55], v1, s[4:7], s29 offen sc1
    v_smfmac_f32_16x16x64_bf16 v[68:71], v[36:39], a[0:7], v0
    v_xor_b32 v27, 3072, v1
    v_smfmac_f32_16x16x64_bf16 v[72:75], v[36:39], v[128:135], v0
    v_smfmac_f32_16x16x64_bf16 v[76:79], v[36:39], a[8:15], v0
    v_smfmac_f32_16x16x64_bf16 v[80:83], v[36:39], v[136:143], v0
    s_waitcnt lgkmcnt(0)
    s_barrier
    ds_read_b128 v[40:43], v14 offset:0
    ds_read_b128 v[44:47], v15 offset:0
    ds_read_b128 v[48:51], v27 offset:0
    v_smfmac_f32_16x16x64_bf16 v[84:87], v[36:39], a[128:135], v0
    v_smfmac_f32_16x16x64_bf16 v[88:91], v[36:39], a[136:143], v0
    s_waitcnt lgkmcnt(2)
    v_smfmac_f32_16x16x64_bf16 v[68:71], v[40:43], a[16:23], v0
    v_smfmac_f32_16x16x64_bf16 v[72:75], v[40:43], v[144:151], v0
    v_smfmac_f32_16x16x64_bf16 v[76:79], v[40:43], a[24:31], v0
    v_smfmac_f32_16x16x64_bf16 v[80:83], v[40:43], v[152:159], v0
    s_waitcnt lgkmcnt(1)
    v_smfmac_f32_16x16x64_bf16 v[68:71], v[44:47], a[32:39], v0
    v_smfmac_f32_16x16x64_bf16 v[72:75], v[44:47], v[160:167], v0
    v_smfmac_f32_16x16x64_bf16 v[76:79], v[44:47], a[40:47], v0
    v_smfmac_f32_16x16x64_bf16 v[80:83], v[44:47], v[168:175], v0
    s_waitcnt lgkmcnt(0)
    v_smfmac_f32_16x16x64_bf16 v[68:71], v[48:51], a[48:55], v0
    s_waitcnt vmcnt(0)
    v_cmp_lt_u32 vcc, s43, v52
    ds_write_b128 v1, v[52:55] offset:4096
    s_cbranch_vccnz L_bf0_s
L_bok_s:
    v_smfmac_f32_16x16x64_bf16 v[72:75], v[48:51], v[176:183], v0
    v_smfmac_f32_16x16x64_bf16 v[76:79], v[48:51], a[56:63], v0
    v_smfmac_f32_16x16x64_bf16 v[80:83], v[48:51], v[184:191], v0
    v_smfmac_f32_16x16x64_bf16 v[68:71], v[52:55], a[64:71], v0
    s_waitcnt lgkmcnt(0)
    s_barrier
    ds_read_b128 v[56:59], v14 offset:4096
    ds_read_b128 v[60:63], v15 offset:4096
    ds_read_b128 v[64:67], v27 offset:4096
    v_smfmac_f32_16x16x64_bf16 v[72:75], v[52:55], v[92:99], v0
    ds_read_b128 v[92:95], v2 offset:8192
    v_smfmac_f32_16x16x64_bf16 v[76:79], v[52:55], a[72:79], v0
    ds_read_b128 v[96:99], v2 offset:9216
    v_smfmac_f32_16x16x64_bf16 v[80:83], v[52:55], v[100:107], v0
    ds_read_b128 v[100:103], v2 offset:10240
    ds_read_b128 v[104:107], v2 offset:11264
    buffer_store_dword v0, v12, s[4:7], s30 offen sc1
    s_waitcnt lgkmcnt(6)
    v_smfmac_f32_16x16x64_bf16 v[72:75], v[56:59], v[108:115], v0
    ds_read_b128 v[108:111], v2 offset:12288
    v_smfmac_f32_16x16x64_bf16 v[80:83], v[56:59], v[116:123], v0
    ds_read_b128 v[112:115], v2 offset:13312
    v_smfmac_f32_16x16x64_bf16 v[68:71], v[56:59], a[80:87], v0
    ds_read_b128 v[116:119], v2 offset:14336
    v_smfmac_f32_16x16x64_bf16 v[76:79], v[56:59], a[88:95], v0
    ds_read_b128 v[120:123], v2 offset:15360
    buffer_load_dwordx4 v[28:31], v7, s[4:7], s32 offen sc1
    s_waitcnt lgkmcnt(4)
    v_smfmac_f32_16x16x64_bf16 v[72:75], v[60:63], v[92:99], v0
    ds_read_b128 v[92:95], v6 offset:0
    v_smfmac_f32_16x16x64_bf16 v[80:83], v[60:63], v[100:107], v0
    ds_read_b128 v[96:99], v6 offset:1024
    v_smfmac_f32_16x16x64_bf16 v[68:71], v[60:63], a[96:103], v0
    ds_read_b128 v[100:103], v6 offset:2048
    s_waitcnt lgkmcnt(3)
    v_smfmac_f32_16x16x64_bf16 v[72:75], v[64:67], v[108:115], v0
    ds_read_b128 v[104:107], v6 offset:3072
    v_smfmac_f32_16x16x64_bf16 v[80:83], v[64:67], v[116:123], v0
    ds_read_b128 v[108:111], v6 offset:4096
    v_smfmac_f32_16x16x64_bf16 v[68:71], v[64:67], a[112:119], v0
    ds_read_b128 v[112:115], v6 offset:5120
    buffer_load_dwordx4 v[32:35], v7, s[4:7], s32 offen offset:1024 sc1
    v_smfmac_f32_16x16x64_bf16 v[76:79], v[60:63], a[104:111], v0
    ds_read_b128 v[116:119], v6 offset:6144
    v_add_f32 v72, v72, v73
    v_smfmac_f32_16x16x64_bf16 v[76:79], v[64:67], a[120:127], v0
    ds_read_b128 v[120:123], v6 offset:7168
    v_add_f32 v73, v74, v75
    v_add_f32 v80, v80, v81
    v_add_f32 v81, v82, v83
    v_add_f32 v68, v68, v69
    v_add_f32 v69, v70, v71
    v_cvt_pk_bf16_f32 v125, v72, v80
    v_cvt_pk_bf16_f32 v127, v73, v81
    v_add_f32 v76, v76, v77
    v_add_f32 v77, v78, v79
    v_cvt_pk_bf16_f32 v24, v68, v76
    v_cvt_pk_bf16_f32 v25, v69, v77
    ds_write2_b32 v3, v24, v25 offset0:0 offset1:136
    ds_write2_b32 v3, v125, v127 offset0:68 offset1:204
    v_smfmac_f32_16x16x64_bf16 v[84:87], v[40:43], a[144:151], v0
    v_smfmac_f32_16x16x64_bf16 v[88:91], v[40:43], a[152:159], v0
    v_smfmac_f32_16x16x64_bf16 v[84:87], v[44:47], a[160:167], v0
    v_smfmac_f32_16x16x64_bf16 v[88:91], v[44:47], a[168:175], v0
    s_waitcnt lgkmcnt(0)
    s_barrier
    ds_read_b128 v[68:71], v4 offset:0
    ds_read_b128 v[72:75], v4 offset:64
    v_smfmac_f32_16x16x64_bf16 v[84:87], v[48:51], a[176:183], v0
    ds_read_b128 v[76:79], v4 offset:128
    v_smfmac_f32_16x16x64_bf16 v[88:91], v[48:51], a[184:191], v0
    ds_read_b128 v[80:83], v4 offset:192
    v_smfmac_f32_16x16x64_bf16 v[84:87], v[52:55], a[192:199], v0
    ds_read_b128 v[36:39], v5 offset:0
    v_smfmac_f32_16x16x64_bf16 v[88:91], v[52:55], a[200:207], v0
    ds_read_b128 v[40:43], v5 offset:64
    v_smfmac_f32_16x16x64_bf16 v[84:87], v[56:59], a[208:215], v0
    ds_read_b128 v[44:47], v5 offset:128
    v_smfmac_f32_16x16x64_bf16 v[88:91], v[56:59], a[216:223], v0
    ds_read_b128 v[48:51], v5 offset:192
    v_smfmac_f32_16x16x64_bf16 v[84:87], v[60:63], a[224:231], v0
    s_mov_b32 m0, s49
    v_smfmac_f32_16x16x64_bf16 v[88:91], v[60:63], a[232:239], v0
    v_smfmac_f32_16x16x64_bf16 v[84:87], v[64:67], a[240:247], v0
    v_smfmac_f32_16x16x64_bf16 v[88:91], v[64:67], a[248:255], v0
    s_waitcnt lgkmcnt(4)
    v_mfma_f32_16x16x32_bf16 v[52:55], v[92:95], v[68:71], 0
    buffer_load_dwordx4 v1, s[4:7], s31 offen sc1 lds
    v_mfma_f32_16x16x32_bf16 v[56:59], v[108:111], v[68:71], 0
    s_add_u32 m0, s49, 4096
    s_add_u32 s34, s31, 131072
    v_mfma_f32_16x16x32_bf16 v[52:55], v[96:99], v[72:75], v[52:55]
    buffer_load_dwordx4 v1, s[4:7], s34 offen sc1 lds
    v_mfma_f32_16x16x32_bf16 v[56:59], v[112:115], v[72:75], v[56:59]
    v_mov_b32 v24, s26
    v_mfma_f32_16x16x32_bf16 v[52:55], v[100:103], v[76:79], v[52:55]
    v_add_f32 v84, v84, v85
    v_add_f32 v85, v86, v87
    v_mfma_f32_16x16x32_bf16 v[56:59], v[116:119], v[76:79], v[56:59]
    v_add_f32 v88, v88, v89
    v_add_f32 v89, v90, v91
    v_mfma_f32_16x16x32_bf16 v[52:55], v[104:107], v[80:83], v[52:55]
    v_cvt_pk_bf16_f32 v124, v84, v85
    v_cvt_pk_bf16_f32 v126, v88, v89
    v_mfma_f32_16x16x32_bf16 v[56:59], v[120:123], v[80:83], v[56:59]
    s_waitcnt lgkmcnt(0)
    v_mfma_f32_16x16x32_bf16 v[60:63], v[36:39], v[68:71], 0
    buffer_store_dwordx4 v[124:127], v1, s[4:7], s33 offen sc1
    v_mfma_f32_16x16x32_bf16 v[60:63], v[40:43], v[72:75], v[60:63]
    buffer_store_dword v24, off, s[4:7], s27 sc1
    s_cmp_eq_u32 s26, 63
    v_mfma_f32_16x16x32_bf16 v[60:63], v[44:47], v[76:79], v[60:63]
    v_max3_f32 v26, v52, v53, v54
    v_max3_f32 v27, v55, v56, v57
    v_mfma_f32_16x16x32_bf16 v[60:63], v[48:51], v[80:83], v[60:63]
    s_cbranch_scc1 L_rec_fin
    v_max3_f32 v26, v26, v58, v59
    v_max_f32 v26, v26, v27
    ds_read_b128 v[36:39], v2 offset:16384
    ds_read_b128 v[40:43], v2 offset:17408
    ds_read_b128 v[44:47], v2 offset:18432
    ds_read_b128 v[48:51], v2 offset:19456
    s_nop 0
    v_max3_f32 v27, v26, v60, v61
    v_max3_f32 v26, v26, v60, v61
    v_mov_b32 v69, 0
    s_nop 0
    v_permlane32_swap_b32 v26, v27
    v_max_f32 v24, v26, v27
    v_max_f32 v25, v26, v27
    s_nop 1
    v_permlane16_swap_b32 v24, v25
    v_max_f32 v26, v24, v25
    v_mul_f32 v26, s44, v26
    v_pk_fma_f32 v[60:61], v[60:61], s[44:45], v[26:27] op_sel_hi:[1,1,0] neg_lo:[0,0,1] neg_hi:[0,0,1]
    v_pk_fma_f32 v[52:53], v[52:53], s[44:45], v[26:27] op_sel_hi:[1,1,0] neg_lo:[0,0,1] neg_hi:[0,0,1]
    v_pk_fma_f32 v[54:55], v[54:55], s[44:45], v[26:27] op_sel_hi:[1,1,0] neg_lo:[0,0,1] neg_hi:[0,0,1]
    v_pk_fma_f32 v[56:57], v[56:57], s[44:45], v[26:27] op_sel_hi:[1,1,0] neg_lo:[0,0,1] neg_hi:[0,0,1]
    v_pk_fma_f32 v[58:59], v[58:59], s[44:45], v[26:27] op_sel_hi:[1,1,0] neg_lo:[0,0,1] neg_hi:[0,0,1]
    v_exp_f32 v60, v60
    v_exp_f32 v61, v61
    v_exp_f32 v52, v52
    v_cvt_pk_bf16_f32 v68, v60, v61
    v_exp_f32 v53, v53
    v_exp_f32 v54, v54
    v_mfma_f32_16x16x16_bf16 v[76:79], v[20:21], v[68:69], 0
    v_exp_f32 v55, v55
    v_cvt_pk_bf16_f32 v72, v52, v53
    v_mfma_f32_16x16x16_bf16 v[84:87], v[124:125], v[68:69], 0
    v_exp_f32 v56, v56
    v_cvt_pk_bf16_f32 v73, v54, v55
    v_mfma_f32_16x16x16_bf16 v[88:91], v[126:127], v[68:69], 0
    v_exp_f32 v57, v57
    v_exp_f32 v58, v58
    v_exp_f32 v59, v59
    v_cvt_pk_bf16_f32 v74, v56, v57
    v_cvt_pk_bf16_f32 v75, v58, v59
    s_waitcnt vmcnt(4)
    s_nop 0
    v_mfma_f32_16x16x32_bf16 v[76:79], v[20:23], v[72:75], v[76:79]
    ds_read_b128 v[52:55], v2 offset:20480
    ds_read_b128 v[56:59], v2 offset:21504
    v_mfma_f32_16x16x32_bf16 v[84:87], v[28:31], v[72:75], v[84:87]
    ds_read_b128 v[60:63], v2 offset:22528
    ds_read_b128 v[64:67], v2 offset:23552
    v_mfma_f32_16x16x32_bf16 v[88:91], v[32:35], v[72:75], v[88:91]
    v_rcp_f32 v26, v76
    v_mov_b64 v[92:93], 0
    s_nop 1
    v_mul_f32 v84, v26, v84
    v_mul_f32 v85, v26, v85
    v_mul_f32 v86, v26, v86
    v_mul_f32 v87, v26, v87
    v_cvt_pk_bf16_f32 v80, v84, v85
    v_cvt_pk_bf16_f32 v81, v86, v87
    v_mul_f32 v88, v26, v88
    v_mul_f32 v89, v26, v89
    v_mul_f32 v90, v26, v90
    v_mul_f32 v91, v26, v91
    v_cvt_pk_bf16_f32 v82, v88, v89
    v_cvt_pk_bf16_f32 v83, v90, v91
    ds_write_b128 v8, v[80:83]
    v_mov_b64 v[94:95], 0
    v_mov_b64 v[96:97], 0
    v_mov_b64 v[98:99], 0
    v_mov_b64 v[100:101], 0
    v_mov_b64 v[102:103], 0
    v_mov_b64 v[104:105], 0
    v_mov_b64 v[106:107], 0
    v_mov_b64 v[108:109], 0
    v_mov_b64 v[110:111], 0
    v_mov_b64 v[112:113], 0
    v_mov_b64 v[114:115], 0
    v_mov_b64 v[116:117], 0
    v_mov_b64 v[118:119], 0
    v_mov_b64 v[120:121], 0
    v_mov_b64 v[122:123], 0
    s_waitcnt lgkmcnt(0)
    s_barrier
    ds_read_b128 v[84:87], v9
    ds_read_b128 v[88:91], v9 offset:128
    s_add_u32 s31, s31, 262144
    s_xor_b32 s49, s49, 24576
    s_add_u32 s32, s32, 262144
    s_add_u32 s33, s33, 131072
    v_xor_b32 v6, 24576, v6
    s_waitcnt lgkmcnt(1)
    v_smfmac_f32_16x16x64_bf16 v[92:95], v[84:87], v[192:199], v0
    s_waitcnt lgkmcnt(0)
    v_smfmac_f32_16x16x64_bf16 v[92:95], v[88:91], v[36:43], v0
    ds_read_b128 v[36:39], v2 offset:24576
    ds_read_b128 v[40:43], v2 offset:25600
    v_smfmac_f32_16x16x64_bf16 v[96:99], v[84:87], v[200:207], v0
    v_smfmac_f32_16x16x64_bf16 v[96:99], v[88:91], v[44:51], v0
    ds_read_b128 v[44:47], v2 offset:26624
    ds_read_b128 v[48:51], v2 offset:27648
    v_smfmac_f32_16x16x64_bf16 v[100:103], v[84:87], v[208:215], v0
    v_add_f32 v68, v92, v93
    v_smfmac_f32_16x16x64_bf16 v[100:103], v[88:91], v[52:59], v0
    ds_read_b128 v[52:55], v2 offset:28672
    ds_read_b128 v[56:59], v2 offset:29696
    v_add_f32 v69, v94, v95
    v_add_u32 v68, s41, v68
    v_and_or_b32 v68, v68, v13, s40
    v_smfmac_f32_16x16x64_bf16 v[104:107], v[84:87], v[216:223], v0
    v_add_f32 v70, v96, v97
    v_smfmac_f32_16x16x64_bf16 v[104:107], v[88:91], v[60:67], v0
    ds_read_b128 v[60:63], v2 offset:30720
    ds_read_b128 v[64:67], v2 offset:31744
    v_add_f32 v71, v98, v99
    v_cvt_pk_bf16_f32 v28, v68, v70
    v_cvt_pk_bf16_f32 v30, v69, v71
    v_smfmac_f32_16x16x64_bf16 v[108:111], v[84:87], v[224:231], v0
    v_add_f32 v72, v100, v101
    s_waitcnt lgkmcnt(6)
    v_smfmac_f32_16x16x64_bf16 v[108:111], v[88:91], v[36:43], v0
    v_add_f32 v73, v102, v103
    v_smfmac_f32_16x16x64_bf16 v[112:115], v[84:87], v[232:239], v0
    v_add_f32 v74, v104, v105
    s_waitcnt lgkmcnt(4)
    v_smfmac_f32_16x16x64_bf16 v[112:115], v[88:91], v[44:51], v0
    v_add_f32 v75, v106, v107
    v_cvt_pk_bf16_f32 v29, v72, v74
    v_cvt_pk_bf16_f32 v31, v73, v75
    buffer_store_dwordx4 v[28:31], v10, s[4:7], 0 offen sc1
    v_smfmac_f32_16x16x64_bf16 v[116:119], v[84:87], v[240:247], v0
    v_add_f32 v76, v108, v109
    s_waitcnt lgkmcnt(2)
    v_smfmac_f32_16x16x64_bf16 v[116:119], v[88:91], v[52:59], v0
    v_add_f32 v77, v110, v111
    v_add_u32 v76, s41, v76
    v_and_or_b32 v76, v76, v13, s40
    v_smfmac_f32_16x16x64_bf16 v[120:123], v[84:87], v[248:255], v0
    v_add_f32 v78, v112, v113
    s_waitcnt lgkmcnt(0)
    v_smfmac_f32_16x16x64_bf16 v[120:123], v[88:91], v[60:67], v0
    v_add_f32 v79, v114, v115
    v_cvt_pk_bf16_f32 v32, v76, v78
    v_cvt_pk_bf16_f32 v34, v77, v79
    v_add_f32 v80, v116, v117
    v_add_f32 v81, v118, v119
    s_nop 2
    v_add_f32 v82, v120, v121
    v_add_f32 v83, v122, v123
    v_cvt_pk_bf16_f32 v33, v80, v82
    v_cvt_pk_bf16_f32 v35, v81, v83
    buffer_store_dwordx4 v[32:35], v10, s[4:7], s101 offen sc1
    s_mov_b32 s46, 0
    s_add_u32 s35, s26, 2
    s_lshr_b32 s35, s35, 2
    s_cmp_eq_u32 s26, 16
    s_cselect_b32 s35, 15, s35
    s_min_u32 s35, s35, 15
    s_cmp_lt_u32 s35, s38
    s_cbranch_scc0 L_need_s
L_have_s:
L_h1_s:
    s_nop 15
    s_nop 13
    s_cmp_lt_u32 s25, 2
    s_cbranch_scc1 L_wd1_s
    s_nop 15
    s_nop 15
    s_nop 7
L_wd1_s:
    buffer_load_dwordx4 v[56:59], v11, s[4:7], 0 offen offset:0 sc1
    buffer_load_dwordx4 v[60:63], v11, s[4:7], 0 offen offset:1024 sc1
    ds_read_b128 v[92:95], v2 offset:0
    ds_read_b128 v[96:99], v2 offset:1024
    ds_read_b128 v[100:103], v2 offset:2048
    ds_read_b128 v[104:107], v2 offset:3072
    ds_read_b128 v[108:111], v2 offset:4096
    ds_read_b128 v[112:115], v2 offset:5120
    ds_read_b128 v[116:119], v2 offset:6144
    ds_read_b128 v[120:123], v2 offset:7168
    v_mov_b64 v[68:69], 0
    v_mov_b64 v[70:71], 0
    v_mov_b64 v[72:73], 0
    v_mov_b64 v[74:75], 0
    v_mov_b64 v[76:77], 0
    v_mov_b64 v[78:79], 0
    v_mov_b64 v[80:81], 0
    v_mov_b64 v[82:83], 0
    v_mov_b64 v[84:85], 0
    v_mov_b64 v[86:87], 0
    v_mov_b64 v[88:89], 0
    v_mov_b64 v[90:91], 0
    s_nop 9
    buffer_load_dwordx4 v[40:43], v11, s[4:7], 0 offen offset:0 sc1
    buffer_load_dwordx4 v[44:47], v11, s[4:7], 0 offen offset:1024 sc1
    s_waitcnt vmcnt(2)
    v_bitop3_b32 v64, v56, v60, s42 bitop3:0x7e
    v_mfma_f32_16x16x32_bf16 v[24:27], v[56:59], v[16:19], 0
    v_and_b32 v64, 1, v64
    v_cmp_ne_u32 vcc, 0, v64
    v_mfma_f32_16x16x32_bf16 v[24:27], v[60:63], v[16:19], v[24:27]
    s_cbranch_vccnz L_rf0_s
L_rok_s:
    s_nop 6
    v_permlane32_swap_b32 v24, v26
    v_permlane32_swap_b32 v25, v27
    v_add_f32 v24, v24, v26
    v_add_f32 v25, v25, v27
    s_nop 1
    v_permlane16_swap_b32 v24, v25
    v_add_f32 v24, v24, v25
    s_nop 1
    v_mov_b32_dpp v25, v24 quad_perm:[1,0,3,2] row_mask:0xf bank_mask:0xf
    v_cvt_pk_bf16_f32 v24, v24, v25
    v_min_u32 v24, s43, v24
    buffer_store_dword v24, v12, s[4:7], s30 offen sc1
    s_xor_b32 s28, s28, 8192
    s_xor_b32 s29, s29, 8192
    s_xor_b32 s30, s30, 8192
    s_xor_b32 s42, s42, 1
    s_xor_b32 s40, s40, 0x10000
    s_xor_b32 s41, s41, 0x10000
    s_add_u32 s26, s26, 1
    s_mov_b32 s46, 0
    s_nop 15
    s_nop 3
    s_cmp_lt_u32 s25, 2
    s_cbranch_scc0 L_wd2_s
    s_nop 15
    s_nop 15
    s_nop 7
L_wd2_s:
    buffer_load_dwordx4 v[36:39], v1, s[4:7], s28 offen sc1
    s_nop 15
    s_nop 13
    buffer_load_dwordx4 v[28:31], v1, s[4:7], s28 offen sc1
    s_branch L_loop_s
L_need_s:
    s_mov_b32 s36, 0
L_ens_s:
    s_cmp_lt_u32 s35, s38
    s_cbranch_scc1 L_ensd_s
    v_mbcnt_lo_u32_b32 v24, -1, 0
    v_mbcnt_hi_u32_b32 v24, -1, v24
    v_and_b32 v24, 15, v24
    v_lshlrev_b32 v24, 2, v24
    buffer_load_dword v25, v24, s[4:7], s39 offen sc0 sc1
    s_add_u32 s36, s36, 1
    s_cmp_lt_u32 s36, 262144
    s_cbranch_scc0 L_rec_exit
    s_waitcnt vmcnt(0)
    v_and_b32 v25, 255, v25
    v_cmp_ne_u32 vcc, 2, v25
    s_nop 0
    s_or_b32 s34, vcc_lo, 0x10000
    s_ff1_i32_b32 s38, s34
    s_branch L_ens_s
L_ensd_s:
    s_branch L_have_s
L_hf_s:
    buffer_load_dword v25, v27, s[4:7], s101 offen sc1
L_hl_s:
    s_waitcnt vmcnt(1)
    v_cmp_gt_u32 vcc, s3, v24
    s_cbranch_vccz L_hd_s
    buffer_load_dword v24, v27, s[4:7], s101 offen sc1
    s_waitcnt vmcnt(1)
    v_cmp_gt_u32 vcc, s3, v25
    s_cbranch_vccz L_hd_s
    buffer_load_dword v25, v27, s[4:7], s101 offen sc1
    s_add_u32 s46, s46, 1
    s_cmp_lt_u32 s46, 262144
    s_cbranch_scc1 L_hl_s
    s_endpgm
L_hd_s:
    s_nop 15
    s_nop 13
    s_branch L_h1_s
L_af0_s:
    s_mov_b64 exec, vcc
    s_mov_b64 s[50:51], vcc
    buffer_load_dwordx4 v[32:35], v1, s[4:7], s28 offen sc1
L_al_s:
    s_add_u32 s46, s46, 1
    s_waitcnt vmcnt(1)
    v_cmp_lt_u32 vcc, s43, v28
    s_nop 0
    s_andn2_b64 exec, s[50:51], vcc
    v_mov_b64 v[36:37], v[28:29]
    v_mov_b64 v[38:39], v[30:31]
    s_and_b64 s[50:51], s[50:51], vcc
    s_cbranch_scc0 L_ad_s
    s_mov_b64 exec, s[50:51]
    buffer_load_dwordx4 v[28:31], v1, s[4:7], s28 offen sc1
    s_add_u32 s46, s46, 1
    s_waitcnt vmcnt(1)
    v_cmp_lt_u32 vcc, s43, v32
    s_nop 0
    s_andn2_b64 exec, s[50:51], vcc
    v_mov_b64 v[36:37], v[32:33]
    v_mov_b64 v[38:39], v[34:35]
    s_and_b64 s[50:51], s[50:51], vcc
    s_cbranch_scc0 L_ad_s
    s_mov_b64 exec, s[50:51]
    buffer_load_dwordx4 v[32:35], v1, s[4:7], s28 offen sc1
    s_cmp_lt_u32 s46, 262144
    s_cbranch_scc1 L_al_s
    s_endpgm
L_ad_s:
    s_mov_b64 exec, -1
    ds_write_b128 v1, v[36:39]
    s_branch L_aok_s
L_bf0_s:
    s_mov_b64 exec, vcc
    s_mov_b64 s[50:51], vcc
    buffer_load_dwordx4 v[28:31], v1, s[4:7], s29 offen sc1
    s_nop 15
    s_nop 3
    buffer_load_dwordx4 v[32:35], v1, s[4:7], s29 offen sc1
L_bl_s:
    s_add_u32 s46, s46, 1
    s_waitcnt vmcnt(1)
    v_cmp_lt_u32 vcc, s43, v28
    s_nop 0
    s_andn2_b64 exec, s[50:51], vcc
    v_mov_b64 v[52:53], v[28:29]
    v_mov_b64 v[54:55], v[30:31]
    s_and_b64 s[50:51], s[50:51], vcc
    s_cbranch_scc0 L_bd_s
    s_mov_b64 exec, s[50:51]
    buffer_load_dwordx4 v[28:31], v1, s[4:7], s29 offen sc1
    s_add_u32 s46, s46, 1
    s_waitcnt vmcnt(1)
    v_cmp_lt_u32 vcc, s43, v32
    s_nop 0
    s_andn2_b64 exec, s[50:51], vcc
    v_mov_b64 v[52:53], v[32:33]
    v_mov_b64 v[54:55], v[34:35]
    s_and_b64 s[50:51], s[50:51], vcc
    s_cbranch_scc0 L_bd_s
    s_mov_b64 exec, s[50:51]
    buffer_load_dwordx4 v[32:35], v1, s[4:7], s29 offen sc1
    s_cmp_lt_u32 s46, 262144
    s_cbranch_scc1 L_bl_s
    s_endpgm
L_bd_s:
    s_mov_b64 exec, -1
    ds_write_b128 v1, v[52:55] offset:4096
    s_branch L_bok_s
L_rf0_s:
    s_mov_b64 exec, vcc
    s_mov_b64 s[50:51], vcc
    buffer_load_dwordx4 v[48:51], v11, s[4:7], 0 offen offset:0 sc1
    buffer_load_dwordx4 v[52:55], v11, s[4:7], 0 offen offset:1024 sc1
L_rl_s:
    s_add_u32 s46, s46, 1
    s_waitcnt vmcnt(2)
    v_bitop3_b32 v64, v40, v44, s42 bitop3:0x7e
    v_and_b32 v64, 1, v64
    v_cmp_ne_u32 vcc, 0, v64
    s_nop 0
    s_andn2_b64 exec, s[50:51], vcc
    v_mov_b64 v[56:57], v[40:41]
    v_mov_b64 v[58:59], v[42:43]
    v_mov_b64 v[60:61], v[44:45]
    v_mov_b64 v[62:63], v[46:47]
    s_and_b64 s[50:51], s[50:51], vcc
    s_cbranch_scc0 L_rd_s
    s_mov_b64 exec, s[50:51]
    buffer_load_dwordx4 v[40:43], v11, s[4:7], 0 offen offset:0 sc1
    buffer_load_dwordx4 v[44:47], v11, s[4:7], 0 offen offset:1024 sc1
    s_add_u32 s46, s46, 1
    s_waitcnt vmcnt(2)
    v_bitop3_b32 v64, v48, v52, s42 bitop3:0x7e
    v_and_b32 v64, 1, v64
    v_cmp_ne_u32 vcc, 0, v64
    s_nop 0
    s_andn2_b64 exec, s[50:51], vcc
    v_mov_b64 v[56:57], v[48:49]
    v_mov_b64 v[58:59], v[50:51]
    v_mov_b64 v[60:61], v[52:53]
    v_mov_b64 v[62:63], v[54:55]
    s_and_b64 s[50:51], s[50:51], vcc
    s_cbranch_scc0 L_rd_s
    s_mov_b64 exec, s[50:51]
    buffer_load_dwordx4 v[48:51], v11, s[4:7], 0 offen offset:0 sc1
    buffer_load_dwordx4 v[52:55], v11, s[4:7], 0 offen offset:1024 sc1
    s_cmp_lt_u32 s46, 262144
    s_cbranch_scc1 L_rl_s
    s_endpgm
L_rd_s:
    s_mov_b64 exec, -1
    v_mfma_f32_16x16x32_bf16 v[24:27], v[56:59], v[16:19], 0
    v_mfma_f32_16x16x32_bf16 v[24:27], v[60:63], v[16:19], v[24:27]
    s_branch L_rok_s
L_rec_fin:
    v_mov_b32 v24, 64
    s_waitcnt vmcnt(0)
    s_barrier
    buffer_store_dword v24, off, s[4:7], s27 sc1
L_rec_exit:
    s_endpgm
L_pf:
    s_cmp_eq_u32 s47, 0
    s_cbranch_scc1 L_sig
    s_bfe_u32 s34, s2, 0x20005
    s_mov_b32 s12, s16
    s_mov_b32 s13, s17
    s_cmp_eq_u32 s34, 1
    s_cselect_b32 s12, s18, s12
    s_cselect_b32 s13, s19, s13
    s_cmp_eq_u32 s34, 2
    s_cselect_b32 s12, s20, s12
    s_cselect_b32 s13, s21, s13
    s_cmp_eq_u32 s34, 3
    s_cselect_b32 s12, s22, s12
    s_cselect_b32 s13, s23, s13
    s_mov_b32 s14, 0x400000
    s_and_b32 s34, s2, 31
    s_lshl_b32 s34, s34, 17
    v_lshlrev_b32 v5, 4, v0
    buffer_load_dwordx4 v[8:11], v5, s[12:15], s34 offen
    s_add_u32 s34, s34, 4096
    buffer_load_dwordx4 v[12:15], v5, s[12:15], s34 offen
    s_add_u32 s34, s34, 4096
    buffer_load_dwordx4 v[16:19], v5, s[12:15], s34 offen
    s_add_u32 s34, s34, 4096
    buffer_load_dwordx4 v[20:23], v5, s[12:15], s34 offen
    s_add_u32 s34, s34, 4096
    buffer_load_dwordx4 v[24:27], v5, s[12:15], s34 offen
    s_add_u32 s34, s34, 4096
    buffer_load_dwordx4 v[28:31], v5, s[12:15], s34 offen
    s_add_u32 s34, s34, 4096
    buffer_load_dwordx4 v[32:35], v5, s[12:15], s34 offen
    s_add_u32 s34, s34, 4096
    buffer_load_dwordx4 v[36:39], v5, s[12:15], s34 offen
    s_add_u32 s34, s34, 4096
    buffer_load_dwordx4 v[8:11], v5, s[12:15], s34 offen
    s_add_u32 s34, s34, 4096
    buffer_load_dwordx4 v[12:15], v5, s[12:15], s34 offen
    s_add_u32 s34, s34, 4096
    buffer_load_dwordx4 v[16:19], v5, s[12:15], s34 offen
    s_add_u32 s34, s34, 4096
    buffer_load_dwordx4 v[20:23], v5, s[12:15], s34 offen
    s_add_u32 s34, s34, 4096
    buffer_load_dwordx4 v[24:27], v5, s[12:15], s34 offen
    s_add_u32 s34, s34, 4096
    buffer_load_dwordx4 v[28:31], v5, s[12:15], s34 offen
    s_add_u32 s34, s34, 4096
    buffer_load_dwordx4 v[32:35], v5, s[12:15], s34 offen
    s_add_u32 s34, s34, 4096
    buffer_load_dwordx4 v[36:39], v5, s[12:15], s34 offen
    s_add_u32 s34, s34, 4096
    buffer_load_dwordx4 v[8:11], v5, s[12:15], s34 offen
    s_add_u32 s34, s34, 4096
    buffer_load_dwordx4 v[12:15], v5, s[12:15], s34 offen
    s_add_u32 s34, s34, 4096
    buffer_load_dwordx4 v[16:19], v5, s[12:15], s34 offen
    s_add_u32 s34, s34, 4096
    buffer_load_dwordx4 v[20:23], v5, s[12:15], s34 offen
    s_add_u32 s34, s34, 4096
    buffer_load_dwordx4 v[24:27], v5, s[12:15], s34 offen
    s_add_u32 s34, s34, 4096
    buffer_load_dwordx4 v[28:31], v5, s[12:15], s34 offen
    s_add_u32 s34, s34, 4096
    buffer_load_dwordx4 v[32:35], v5, s[12:15], s34 offen
    s_add_u32 s34, s34, 4096
    buffer_load_dwordx4 v[36:39], v5, s[12:15], s34 offen
    s_add_u32 s34, s34, 4096
    buffer_load_dwordx4 v[8:11], v5, s[12:15], s34 offen
    s_add_u32 s34, s34, 4096
    buffer_load_dwordx4 v[12:15], v5, s[12:15], s34 offen
    s_add_u32 s34, s34, 4096
    buffer_load_dwordx4 v[16:19], v5, s[12:15], s34 offen
    s_add_u32 s34, s34, 4096
    buffer_load_dwordx4 v[20:23], v5, s[12:15], s34 offen
    s_add_u32 s34, s34, 4096
    buffer_load_dwordx4 v[24:27], v5, s[12:15], s34 offen
    s_add_u32 s34, s34, 4096
    buffer_load_dwordx4 v[28:31], v5, s[12:15], s34 offen
    s_add_u32 s34, s34, 4096
    buffer_load_dwordx4 v[32:35], v5, s[12:15], s34 offen
    s_add_u32 s34, s34, 4096
    buffer_load_dwordx4 v[36:39], v5, s[12:15], s34 offen
    s_add_u32 s34, s34, 4096
L_wk_entry:
    s_waitcnt vmcnt(0)
    s_barrier
    s_cmp_lg_u32 s25, 1
    s_cbranch_scc1 L_nosig_w
    s_cmp_eq_u32 s75, 0x7ffffff0
    s_cbranch_scc1 L_nosig_w
    s_mov_b32 s46, 0
    s_branch L_sigc_w
L_sigp_w:
    buffer_load_dword v96, off, s[8:11], 0 offset:128 sc0 sc1
    s_add_u32 s46, s46, 1
    s_cmp_lt_u32 s46, 262144
    s_cbranch_scc0 L_rec_exit
    s_waitcnt vmcnt(0)
L_sigc_w:
    v_readfirstlane_b32 s34, v96
    s_nop 0
    s_cmp_eq_u32 s34, 0
    s_cbranch_scc1 L_sigp_w
    s_mov_b64 exec, 1
    buffer_atomic_add v96, v98, s[4:7], s75 offen
    s_mov_b64 exec, -1
L_nosig_w:
    s_mov_b32 s75, 0x7ffffff0
L_worker:
    s_mov_b32 s60, s25
    v_and_b32 v0, 63, v0
    v_lshlrev_b32 v1, 4, v0
    s_lshr_b32 s68, s60, 1
    s_and_b32 s67, s60, 1
    s_lshl_b32 s69, s68, 12
    v_add_u32 v3, s69, v1
    s_lshl_b32 s70, s60, 11
    s_lshl_b32 s69, s60, 15
    s_add_u32 s69, s69, 0
    v_add_u32 v1, s69, v1
    s_lshl_b32 s69, s68, 2
    s_add_u32 s69, s69, s67
    s_lshl_b32 s71, s69, 10
    s_add_u32 s71, s71, 16384
    v_lshrrev_b32 v8, 4, v0
    v_bfe_u32 v9, v0, 2, 2
    v_and_b32 v10, 1, v8
    v_lshl_or_b32 v10, v10, 2, v9
    v_lshl_add_u32 v9, v8, 3, v9
    v_lshlrev_b32 v9, 9, v9
    v_and_b32 v11, 3, v0
    v_lshl_add_u32 v9, v11, 3, v9
    v_lshl_add_u32 v9, v10, 5, v9
    s_lshl_b32 s69, s67, 8
    s_add_u32 s69, s69, 16384
    v_add_u32 v9, s69, v9
    v_xor_b32 v144, 0, v9
    v_xor_b32 v145, 32, v9
    v_xor_b32 v146, 64, v9
    v_xor_b32 v147, 96, v9
    v_xor_b32 v148, 128, v9
    v_xor_b32 v149, 160, v9
    v_xor_b32 v150, 192, v9
    v_xor_b32 v151, 224, v9
    v_add_u32 v4, 65536, v3
    v_add_u32 v152, 65536, v144
    v_add_u32 v153, 65536, v145
    v_add_u32 v154, 65536, v146
    v_add_u32 v155, 65536, v147
    v_add_u32 v156, 65536, v148
    v_add_u32 v157, 65536, v149
    v_add_u32 v158, 65536, v150
    v_add_u32 v159, 65536, v151
    v_mov_b32 v12, 0
    v_mov_b32 v13, 160000
    s_add_u32 s86, s47, 6
    s_cmp_ge_u32 s86, 14
    s_cselect_b32 s81, 14, 0
    s_sub_u32 s86, s86, s81
    s_cmp_ge_u32 s86, 7
    s_cselect_b32 s81, 7, 0
    s_sub_u32 s86, s86, s81
    s_mov_b32 s87, 0
    s_mov_b32 s90, 0
    s_mov_b32 s59, 0
    s_mov_b32 s81, 128
    s_cmp_lg_u32 s60, 0
    s_cbranch_scc1 L_wfd_fi
    s_mov_b32 s75, 0
L_wf_fi:
    buffer_load_dword v14, v12, s[8:11], s81 offen sc0 sc1
    s_add_u32 s75, s75, 1
    s_cmp_lt_u32 s75, 65536
    s_cbranch_scc0 L_rec_exit
    s_waitcnt vmcnt(0)
    v_readfirstlane_b32 s84, v14
    s_nop 0
    s_cmp_ge_u32 s84, 1
    s_cbranch_scc1 L_wfd_fi
    s_sleep 2
    s_branch L_wf_fi
L_wfd_fi:
L_wk_next:
    s_lshl_b32 s89, s86, 7
    s_add_u32 s89, s89, 87111680
    s_cmp_lg_u32 s60, 0
    s_cbranch_scc1 L_tk_bar_q
    v_mov_b32 v14, 1
    s_mov_b64 exec, 1
    buffer_atomic_add v14, v12, s[4:7], s89 offen sc0
    s_waitcnt vmcnt(0)
    ds_write_b32 v13, v14
    s_mov_b64 exec, -1
    s_waitcnt lgkmcnt(0)
L_tk_bar_q:
    s_barrier
    ds_read_b32 v14, v13
    s_waitcnt lgkmcnt(0)
    v_readfirstlane_b32 s74, v14
    s_barrier
    s_cmp_lt_u32 s86, 4
    s_cselect_b32 s88, 5, 4
    s_mov_b32 s82, 16384
    s_cselect_b32 s82, 13108, s82
    s_lshl_b32 s81, s88, 4
    s_mov_b32 s83, 16
    s_cmp_lt_u32 s74, s81
    s_cbranch_scc1 L_wk_dec
    s_sub_u32 s74, s74, s81
    s_cmp_lt_u32 s86, 2
    s_cselect_b32 s88, 4, 3
    s_mov_b32 s82, 16384
    s_cselect_b32 s82, s82, 21846
    s_lshl_b32 s81, s88, 4
    s_mov_b32 s83, 0
    s_cmp_lt_u32 s74, s81
    s_cbranch_scc1 L_wk_dec
    s_add_u32 s86, s86, 1
    s_cmp_eq_u32 s86, 7
    s_cselect_b32 s86, 0, s86
    s_add_u32 s87, s87, 1
    s_cmp_lt_u32 s87, 7
    s_cbranch_scc1 L_wk_next
    s_mov_b32 s89, 87112704
    s_cmp_lg_u32 s60, 0
    s_cbranch_scc1 L_tk_bar_r
    v_mov_b32 v14, 1
    s_mov_b64 exec, 1
    buffer_atomic_add v14, v12, s[4:7], s89 offen sc0
    s_waitcnt vmcnt(0)
    ds_write_b32 v13, v14
    s_mov_b64 exec, -1
    s_waitcnt lgkmcnt(0)
L_tk_bar_r:
    s_barrier
    ds_read_b32 v14, v13
    s_waitcnt lgkmcnt(0)
    v_readfirstlane_b32 s74, v14
    s_barrier
    s_cmp_ge_u32 s74, 224
    s_cbranch_scc1 L_forced
    s_mov_b32 s87, 0
L_role_g2:
    s_lshl_b32 s89, s86, 7
    s_add_u32 s89, s89, 87099392
    s_cmp_lg_u32 s60, 0
    s_cbranch_scc1 L_tk_bar_g
    v_mov_b32 v14, 1
    s_mov_b64 exec, 1
    buffer_atomic_add v14, v12, s[4:7], s89 offen sc0
    s_waitcnt vmcnt(0)
    ds_write_b32 v13, v14
    s_mov_b64 exec, -1
    s_waitcnt lgkmcnt(0)
L_tk_bar_g:
    s_barrier
    ds_read_b32 v14, v13
    s_waitcnt lgkmcnt(0)
    v_readfirstlane_b32 s74, v14
    s_barrier
    s_lshl_b32 s81, s86, 4
    s_add_u32 s81, s81, s74
    s_cmp_lt_u32 s74, 16
    s_cselect_b32 s74, s81, s74
    s_cbranch_scc1 L_g2
    s_cmp_lg_u32 s87, 0
    s_cbranch_scc1 L_role_nx
    s_mov_b32 s89, 87100416
    s_cmp_lg_u32 s60, 0
    s_cbranch_scc1 L_tk_bar_a
    v_mov_b32 v14, 1
    s_mov_b64 exec, 1
    buffer_atomic_add v14, v12, s[4:7], s89 offen sc0
    s_waitcnt vmcnt(0)
    ds_write_b32 v13, v14
    s_mov_b64 exec, -1
    s_waitcnt lgkmcnt(0)
L_tk_bar_a:
    s_barrier
    ds_read_b32 v14, v13
    s_waitcnt lgkmcnt(0)
    v_readfirstlane_b32 s74, v14
    s_barrier
    s_cmp_lt_u32 s74, 112
    s_cbranch_scc1 L_att
L_role_nx:
    s_add_u32 s86, s86, 1
    s_cmp_eq_u32 s86, 7
    s_cselect_b32 s86, 0, s86
    s_add_u32 s87, s87, 1
    s_cmp_lt_u32 s87, 7
    s_cbranch_scc1 L_role_g2
    s_endpgm
L_forced:
    s_mov_b32 s89, 4
    s_cmp_lg_u32 s60, 0
    s_cbranch_scc1 L_tk_bar_s
    v_mov_b32 v14, 1
    s_mov_b64 exec, 1
    buffer_atomic_add v14, v12, s[8:11], s89 offen sc0
    s_waitcnt vmcnt(0)
    ds_write_b32 v13, v14
    s_mov_b64 exec, -1
    s_waitcnt lgkmcnt(0)
L_tk_bar_s:
    s_barrier
    ds_read_b32 v14, v13
    s_waitcnt lgkmcnt(0)
    v_readfirstlane_b32 s74, v14
    s_barrier
    s_mov_b32 s89, 0
    s_cmp_lg_u32 s60, 0
    s_cbranch_scc1 L_tk_bar_c
    v_mov_b32 v14, 1
    s_mov_b64 exec, 1
    buffer_atomic_add v14, v12, s[8:11], s89 offen sc0
    s_waitcnt vmcnt(0)
    ds_write_b32 v13, v14
    s_mov_b64 exec, -1
    s_waitcnt lgkmcnt(0)
L_tk_bar_c:
    s_barrier
    ds_read_b32 v14, v13
    s_waitcnt lgkmcnt(0)
    v_readfirstlane_b32 s74, v14
    s_barrier
    s_mov_b32 s48, s74
    v_mov_b32 v99, v0
    s_mov_b32 s14, 0x400000
    s_mov_b32 s75, 0x7ffffff0
    s_cmp_lt_u32 s48, 32
    s_cbranch_scc1 L_rec_start
    s_endpgm
L_wk_dec:
    s_mul_i32 s61, s74, s82
    s_lshr_b32 s61, s61, 16
    s_mul_i32 s81, s61, s88
    s_sub_u32 s81, s74, s81
    s_mul_i32 s81, s81, 7
    s_add_u32 s81, s81, s86
    s_add_u32 s62, s81, s83
    s_add_u32 s82, s81, 32
    s_cmp_ge_u32 s81, 16
    s_cselect_b32 s82, s82, s81
    s_cmp_eq_u32 s83, 0
    s_cselect_b32 s62, s82, s62
    s_mov_b32 s75, 0
    v_and_b32 v15, 15, v0
    v_lshlrev_b32 v15, 7, v15
    s_mov_b32 s81, 87109632
L_ln_w:
    s_bitcmp1_b32 s59, s61
    s_cbranch_scc1 L_ln_ok
    buffer_load_dword v14, v15, s[4:7], s81 offen sc0 sc1
    s_add_u32 s75, s75, 1
    s_cmp_lt_u32 s75, 65536
    s_cbranch_scc0 L_rec_exit
    s_waitcnt vmcnt(0)
    v_cmp_le_u32 vcc, 8, v14
    s_nop 0
    s_mov_b32 s59, vcc_lo
    s_sleep 1
    s_branch L_ln_w
L_ln_ok:
    s_add_u32 s90, s90, 1
    s_lshr_b32 s72, s62, 4
    s_and_b32 s67, s62, 15
    s_lshl_b32 s65, s67, 9
    s_mov_b32 s66, 8192
    s_mov_b32 s14, 0x400000
    s_mov_b32 s12, s16
    s_mov_b32 s13, s17
    s_cmp_eq_u32 s72, 1
    s_cselect_b32 s12, s18, s12
    s_cselect_b32 s13, s19, s13
    s_cmp_eq_u32 s72, 2
    s_cselect_b32 s12, s20, s12
    s_cselect_b32 s13, s21, s13
    s_cmp_eq_u32 s72, 3
    s_cselect_b32 s12, s50, s12
    s_cselect_b32 s13, s51, s13
    s_cselect_b32 s66, 3584, s66
    s_cselect_b32 s14, 1835008, s14
    s_lshl_b32 s64, s61, 17
    s_lshl_b32 s76, s66, 2
    s_lshl_b32 s77, s66, 4
    s_add_u32 s78, s76, s77
    s_lshl_b32 s79, s66, 5
    v_lshrrev_b32 v8, 5, v0
    s_lshl_b32 s67, s60, 1
    v_or_b32 v9, s67, v8
    v_lshlrev_b32 v9, 1, v9
    v_and_b32 v10, 31, v0
    v_xor_b32 v9, v9, v10
    v_lshlrev_b32 v9, 4, v9
    s_sub_u32 s67, s71, 16384
    s_lshr_b32 s67, s67, 9
    v_add_u32 v8, s67, v8
    v_mul_lo_u32 v8, v8, s66
    v_add_u32 v2, v8, v9
    s_add_u32 m0, s70, 0
    s_add_u32 s67, s64, 0
    buffer_load_dwordx4 v1, s[4:7], s67 offen sc1 lds
    s_add_u32 m0, s70, 1024
    s_add_u32 s67, s64, 16384
    buffer_load_dwordx4 v1, s[4:7], s67 offen sc1 lds
    s_add_u32 m0, s71, 0
    s_mov_b32 s67, s65
    buffer_load_dwordx4 v2, s[12:15], s67 offen lds
    s_add_u32 m0, s71, 2048
    s_add_u32 s67, s65, s76
    buffer_load_dwordx4 v2, s[12:15], s67 offen lds
    s_add_u32 m0, s71, 8192
    s_add_u32 s67, s65, s77
    buffer_load_dwordx4 v2, s[12:15], s67 offen lds
    s_add_u32 m0, s71, 10240
    s_add_u32 s67, s65, s78
    buffer_load_dwordx4 v2, s[12:15], s67 offen lds
    s_add_u32 s64, s64, 1024
    s_add_u32 s65, s65, s79
    s_add_u32 m0, s70, 32768
    s_add_u32 s67, s64, 0
    buffer_load_dwordx4 v1, s[4:7], s67 offen sc1 lds
    s_add_u32 m0, s70, 33792
    s_add_u32 s67, s64, 16384
    buffer_load_dwordx4 v1, s[4:7], s67 offen sc1 lds
    s_add_u32 m0, s71, 32768
    s_mov_b32 s67, s65
    buffer_load_dwordx4 v2, s[12:15], s67 offen lds
    s_add_u32 m0, s71, 34816
    s_add_u32 s67, s65, s76
    buffer_load_dwordx4 v2, s[12:15], s67 offen lds
    s_add_u32 m0, s71, 40960
    s_add_u32 s67, s65, s77
    buffer_load_dwordx4 v2, s[12:15], s67 offen lds
    s_add_u32 m0, s71, 43008
    s_add_u32 s67, s65, s78
    buffer_load_dwordx4 v2, s[12:15], s67 offen lds
    s_add_u32 s64, s64, 1024
    s_add_u32 s65, s65, s79
    s_add_u32 m0, s70, 65536
    s_add_u32 s67, s64, 0
    buffer_load_dwordx4 v1, s[4:7], s67 offen sc1 lds
    s_add_u32 m0, s70, 66560
    s_add_u32 s67, s64, 16384
    buffer_load_dwordx4 v1, s[4:7], s67 offen sc1 lds
    s_add_u32 m0, s71, 65536
    s_mov_b32 s67, s65
    buffer_load_dwordx4 v2, s[12:15], s67 offen lds
    s_add_u32 m0, s71, 67584
    s_add_u32 s67, s65, s76
    buffer_load_dwordx4 v2, s[12:15], s67 offen lds
    s_add_u32 m0, s71, 73728
    s_add_u32 s67, s65, s77
    buffer_load_dwordx4 v2, s[12:15], s67 offen lds
    s_add_u32 m0, s71, 75776
    s_add_u32 s67, s65, s78
    buffer_load_dwordx4 v2, s[12:15], s67 offen lds
    s_add_u32 s64, s64, 1024
    s_add_u32 s65, s65, s79
    v_accvgpr_write_b32 a0, 0
    v_accvgpr_write_b32 a1, 0
    v_accvgpr_write_b32 a2, 0
    v_accvgpr_write_b32 a3, 0
    v_accvgpr_write_b32 a4, 0
    v_accvgpr_write_b32 a5, 0
    v_accvgpr_write_b32 a6, 0
    v_accvgpr_write_b32 a7, 0
    v_accvgpr_write_b32 a8, 0
    v_accvgpr_write_b32 a9, 0
    v_accvgpr_write_b32 a10, 0
    v_accvgpr_write_b32 a11, 0
    v_accvgpr_write_b32 a12, 0
    v_accvgpr_write_b32 a13, 0
    v_accvgpr_write_b32 a14, 0
    v_accvgpr_write_b32 a15, 0
    v_accvgpr_write_b32 a16, 0
    v_accvgpr_write_b32 a17, 0
    v_accvgpr_write_b32 a18, 0
    v_accvgpr_write_b32 a19, 0
    v_accvgpr_write_b32 a20, 0
    v_accvgpr_write_b32 a21, 0
    v_accvgpr_write_b32 a22, 0
    v_accvgpr_write_b32 a23, 0
    v_accvgpr_write_b32 a24, 0
    v_accvgpr_write_b32 a25, 0
    v_accvgpr_write_b32 a26, 0
    v_accvgpr_write_b32 a27, 0
    v_accvgpr_write_b32 a28, 0
    v_accvgpr_write_b32 a29, 0
    v_accvgpr_write_b32 a30, 0
    v_accvgpr_write_b32 a31, 0
    v_accvgpr_write_b32 a32, 0
    v_accvgpr_write_b32 a33, 0
    v_accvgpr_write_b32 a34, 0
    v_accvgpr_write_b32 a35, 0
    v_accvgpr_write_b32 a36, 0
    v_accvgpr_write_b32 a37, 0
    v_accvgpr_write_b32 a38, 0
    v_accvgpr_write_b32 a39, 0
    v_accvgpr_write_b32 a40, 0
    v_accvgpr_write_b32 a41, 0
    v_accvgpr_write_b32 a42, 0
    v_accvgpr_write_b32 a43, 0
    v_accvgpr_write_b32 a44, 0
    v_accvgpr_write_b32 a45, 0
    v_accvgpr_write_b32 a46, 0
    v_accvgpr_write_b32 a47, 0
    v_accvgpr_write_b32 a48, 0
    v_accvgpr_write_b32 a49, 0
    v_accvgpr_write_b32 a50, 0
    v_accvgpr_write_b32 a51, 0
    v_accvgpr_write_b32 a52, 0
    v_accvgpr_write_b32 a53, 0
    v_accvgpr_write_b32 a54, 0
    v_accvgpr_write_b32 a55, 0
    v_accvgpr_write_b32 a56, 0
    v_accvgpr_write_b32 a57, 0
    v_accvgpr_write_b32 a58, 0
    v_accvgpr_write_b32 a59, 0
    v_accvgpr_write_b32 a60, 0
    v_accvgpr_write_b32 a61, 0
    v_accvgpr_write_b32 a62, 0
    v_accvgpr_write_b32 a63, 0
    v_accvgpr_write_b32 a64, 0
    v_accvgpr_write_b32 a65, 0
    v_accvgpr_write_b32 a66, 0
    v_accvgpr_write_b32 a67, 0
    v_accvgpr_write_b32 a68, 0
    v_accvgpr_write_b32 a69, 0
    v_accvgpr_write_b32 a70, 0
    v_accvgpr_write_b32 a71, 0
    v_accvgpr_write_b32 a72, 0
    v_accvgpr_write_b32 a73, 0
    v_accvgpr_write_b32 a74, 0
    v_accvgpr_write_b32 a75, 0
    v_accvgpr_write_b32 a76, 0
    v_accvgpr_write_b32 a77, 0
    v_accvgpr_write_b32 a78, 0
    v_accvgpr_write_b32 a79, 0
    v_accvgpr_write_b32 a80, 0
    v_accvgpr_write_b32 a81, 0
    v_accvgpr_write_b32 a82, 0
    v_accvgpr_write_b32 a83, 0
    v_accvgpr_write_b32 a84, 0
    v_accvgpr_write_b32 a85, 0
    v_accvgpr_write_b32 a86, 0
    v_accvgpr_write_b32 a87, 0
    v_accvgpr_write_b32 a88, 0
    v_accvgpr_write_b32 a89, 0
    v_accvgpr_write_b32 a90, 0
    v_accvgpr_write_b32 a91, 0
    v_accvgpr_write_b32 a92, 0
    v_accvgpr_write_b32 a93, 0
    v_accvgpr_write_b32 a94, 0
    v_accvgpr_write_b32 a95, 0
    v_accvgpr_write_b32 a96, 0
    v_accvgpr_write_b32 a97, 0
    v_accvgpr_write_b32 a98, 0
    v_accvgpr_write_b32 a99, 0
    v_accvgpr_write_b32 a100, 0
    v_accvgpr_write_b32 a101, 0
    v_accvgpr_write_b32 a102, 0
    v_accvgpr_write_b32 a103, 0
    v_accvgpr_write_b32 a104, 0
    v_accvgpr_write_b32 a105, 0
    v_accvgpr_write_b32 a106, 0
    v_accvgpr_write_b32 a107, 0
    v_accvgpr_write_b32 a108, 0
    v_accvgpr_write_b32 a109, 0
    v_accvgpr_write_b32 a110, 0
    v_accvgpr_write_b32 a111, 0
    v_accvgpr_write_b32 a112, 0
    v_accvgpr_write_b32 a113, 0
    v_accvgpr_write_b32 a114, 0
    v_accvgpr_write_b32 a115, 0
    v_accvgpr_write_b32 a116, 0
    v_accvgpr_write_b32 a117, 0
    v_accvgpr_write_b32 a118, 0
    v_accvgpr_write_b32 a119, 0
    v_accvgpr_write_b32 a120, 0
    v_accvgpr_write_b32 a121, 0
    v_accvgpr_write_b32 a122, 0
    v_accvgpr_write_b32 a123, 0
    v_accvgpr_write_b32 a124, 0
    v_accvgpr_write_b32 a125, 0
    v_accvgpr_write_b32 a126, 0
    v_accvgpr_write_b32 a127, 0
    s_waitcnt vmcnt(12)
    s_barrier
    ds_read_b128 v[16:19], v3 offset:0
    ds_read_b64_tr_b16 v[80:81], v144 offset:0
    ds_read_b64_tr_b16 v[82:83], v144 offset:2048
    ds_read_b128 v[20:23], v3 offset:1024
    ds_read_b64_tr_b16 v[84:85], v145 offset:0
    ds_read_b64_tr_b16 v[86:87], v145 offset:2048
    ds_read_b128 v[24:27], v3 offset:2048
    ds_read_b64_tr_b16 v[88:89], v146 offset:0
    ds_read_b64_tr_b16 v[90:91], v146 offset:2048
    ds_read_b128 v[28:31], v3 offset:3072
    ds_read_b64_tr_b16 v[92:93], v147 offset:0
    ds_read_b64_tr_b16 v[94:95], v147 offset:2048
    ds_read_b64_tr_b16 v[96:97], v148 offset:0
    ds_read_b64_tr_b16 v[98:99], v148 offset:2048
    ds_read_b64_tr_b16 v[100:101], v149 offset:0
    ds_read_b64_tr_b16 v[102:103], v149 offset:2048
    ds_read_b64_tr_b16 v[104:105], v150 offset:0
    ds_read_b64_tr_b16 v[106:107], v150 offset:2048
    ds_read_b64_tr_b16 v[108:109], v151 offset:0
    ds_read_b64_tr_b16 v[110:111], v151 offset:2048
    s_cmp_eq_u32 s72, 2
    s_cbranch_scc1 L_wk_v
    s_mov_b32 s63, 0
L_wk_k0:
    s_waitcnt vmcnt(6) lgkmcnt(0)
    s_barrier
    v_mfma_f32_16x16x32_bf16 a[0:3], v[80:83], v[16:19], a[0:3]
    ds_read_b128 v[48:51], v3 offset:32768
    v_mfma_f32_16x16x32_bf16 a[4:7], v[80:83], v[20:23], a[4:7]
    ds_read_b64_tr_b16 v[112:113], v144 offset:32768
    v_mfma_f32_16x16x32_bf16 a[8:11], v[80:83], v[24:27], a[8:11]
    ds_read_b64_tr_b16 v[114:115], v144 offset:34816
    s_add_u32 m0, s70, 98304
    s_add_u32 s67, s64, 0
    buffer_load_dwordx4 v1, s[4:7], s67 offen sc1 lds
    v_mfma_f32_16x16x32_bf16 a[12:15], v[80:83], v[28:31], a[12:15]
    ds_read_b128 v[52:55], v3 offset:33792
    v_mfma_f32_16x16x32_bf16 a[16:19], v[84:87], v[16:19], a[16:19]
    ds_read_b64_tr_b16 v[116:117], v145 offset:32768
    v_mfma_f32_16x16x32_bf16 a[20:23], v[84:87], v[20:23], a[20:23]
    ds_read_b64_tr_b16 v[118:119], v145 offset:34816
    v_mfma_f32_16x16x32_bf16 a[24:27], v[84:87], v[24:27], a[24:27]
    ds_read_b128 v[56:59], v3 offset:34816
    v_mfma_f32_16x16x32_bf16 a[28:31], v[84:87], v[28:31], a[28:31]
    ds_read_b64_tr_b16 v[120:121], v146 offset:32768
    s_add_u32 m0, s70, 99328
    s_add_u32 s67, s64, 16384
    buffer_load_dwordx4 v1, s[4:7], s67 offen sc1 lds
    v_mfma_f32_16x16x32_bf16 a[32:35], v[88:91], v[16:19], a[32:35]
    ds_read_b64_tr_b16 v[122:123], v146 offset:34816
    v_mfma_f32_16x16x32_bf16 a[36:39], v[88:91], v[20:23], a[36:39]
    ds_read_b128 v[60:63], v3 offset:35840
    v_mfma_f32_16x16x32_bf16 a[40:43], v[88:91], v[24:27], a[40:43]
    ds_read_b64_tr_b16 v[124:125], v147 offset:32768
    v_mfma_f32_16x16x32_bf16 a[44:47], v[88:91], v[28:31], a[44:47]
    ds_read_b64_tr_b16 v[126:127], v147 offset:34816
    v_mfma_f32_16x16x32_bf16 a[48:51], v[92:95], v[16:19], a[48:51]
    ds_read_b64_tr_b16 v[128:129], v148 offset:32768
    s_add_u32 m0, s71, 98304
    s_mov_b32 s67, s65
    buffer_load_dwordx4 v2, s[12:15], s67 offen lds
    v_mfma_f32_16x16x32_bf16 a[52:55], v[92:95], v[20:23], a[52:55]
    ds_read_b64_tr_b16 v[130:131], v148 offset:34816
    v_mfma_f32_16x16x32_bf16 a[56:59], v[92:95], v[24:27], a[56:59]
    ds_read_b64_tr_b16 v[132:133], v149 offset:32768
    v_mfma_f32_16x16x32_bf16 a[60:63], v[92:95], v[28:31], a[60:63]
    ds_read_b64_tr_b16 v[134:135], v149 offset:34816
    v_mfma_f32_16x16x32_bf16 a[64:67], v[96:99], v[16:19], a[64:67]
    ds_read_b64_tr_b16 v[136:137], v150 offset:32768
    v_mfma_f32_16x16x32_bf16 a[68:71], v[96:99], v[20:23], a[68:71]
    ds_read_b64_tr_b16 v[138:139], v150 offset:34816
    s_add_u32 m0, s71, 100352
    s_add_u32 s67, s65, s76
    buffer_load_dwordx4 v2, s[12:15], s67 offen lds
    v_mfma_f32_16x16x32_bf16 a[72:75], v[96:99], v[24:27], a[72:75]
    ds_read_b64_tr_b16 v[140:141], v151 offset:32768
    v_mfma_f32_16x16x32_bf16 a[76:79], v[96:99], v[28:31], a[76:79]
    ds_read_b64_tr_b16 v[142:143], v151 offset:34816
    v_mfma_f32_16x16x32_bf16 a[80:83], v[100:103], v[16:19], a[80:83]
    v_mfma_f32_16x16x32_bf16 a[84:87], v[100:103], v[20:23], a[84:87]
    v_mfma_f32_16x16x32_bf16 a[88:91], v[100:103], v[24:27], a[88:91]
    s_add_u32 m0, s71, 106496
    s_add_u32 s67, s65, s77
    buffer_load_dwordx4 v2, s[12:15], s67 offen lds
    v_mfma_f32_16x16x32_bf16 a[92:95], v[100:103], v[28:31], a[92:95]
    v_mfma_f32_16x16x32_bf16 a[96:99], v[104:107], v[16:19], a[96:99]
    v_mfma_f32_16x16x32_bf16 a[100:103], v[104:107], v[20:23], a[100:103]
    v_mfma_f32_16x16x32_bf16 a[104:107], v[104:107], v[24:27], a[104:107]
    v_mfma_f32_16x16x32_bf16 a[108:111], v[104:107], v[28:31], a[108:111]
    s_add_u32 m0, s71, 108544
    s_add_u32 s67, s65, s78
    buffer_load_dwordx4 v2, s[12:15], s67 offen lds
    s_add_u32 s64, s64, 1024
    s_add_u32 s65, s65, s79
    v_mfma_f32_16x16x32_bf16 a[112:115], v[108:111], v[16:19], a[112:115]
    v_mfma_f32_16x16x32_bf16 a[116:119], v[108:111], v[20:23], a[116:119]
    v_mfma_f32_16x16x32_bf16 a[120:123], v[108:111], v[24:27], a[120:123]
    v_mfma_f32_16x16x32_bf16 a[124:127], v[108:111], v[28:31], a[124:127]
    s_waitcnt vmcnt(6) lgkmcnt(0)
    s_barrier
    v_mfma_f32_16x16x32_bf16 a[0:3], v[112:115], v[48:51], a[0:3]
    ds_read_b128 v[16:19], v4 offset:0
    v_mfma_f32_16x16x32_bf16 a[4:7], v[112:115], v[52:55], a[4:7]
    ds_read_b64_tr_b16 v[80:81], v152 offset:0
    v_mfma_f32_16x16x32_bf16 a[8:11], v[112:115], v[56:59], a[8:11]
    ds_read_b64_tr_b16 v[82:83], v152 offset:2048
    s_add_u32 m0, s70, 0
    s_add_u32 s67, s64, 0
    buffer_load_dwordx4 v1, s[4:7], s67 offen sc1 lds
    v_mfma_f32_16x16x32_bf16 a[12:15], v[112:115], v[60:63], a[12:15]
    ds_read_b128 v[20:23], v4 offset:1024
    v_mfma_f32_16x16x32_bf16 a[16:19], v[116:119], v[48:51], a[16:19]
    ds_read_b64_tr_b16 v[84:85], v153 offset:0
    v_mfma_f32_16x16x32_bf16 a[20:23], v[116:119], v[52:55], a[20:23]
    ds_read_b64_tr_b16 v[86:87], v153 offset:2048
    v_mfma_f32_16x16x32_bf16 a[24:27], v[116:119], v[56:59], a[24:27]
    ds_read_b128 v[24:27], v4 offset:2048
    v_mfma_f32_16x16x32_bf16 a[28:31], v[116:119], v[60:63], a[28:31]
    ds_read_b64_tr_b16 v[88:89], v154 offset:0
    s_add_u32 m0, s70, 1024
    s_add_u32 s67, s64, 16384
    buffer_load_dwordx4 v1, s[4:7], s67 offen sc1 lds
    v_mfma_f32_16x16x32_bf16 a[32:35], v[120:123], v[48:51], a[32:35]
    ds_read_b64_tr_b16 v[90:91], v154 offset:2048
    v_mfma_f32_16x16x32_bf16 a[36:39], v[120:123], v[52:55], a[36:39]
    ds_read_b128 v[28:31], v4 offset:3072
    v_mfma_f32_16x16x32_bf16 a[40:43], v[120:123], v[56:59], a[40:43]
    ds_read_b64_tr_b16 v[92:93], v155 offset:0
    v_mfma_f32_16x16x32_bf16 a[44:47], v[120:123], v[60:63], a[44:47]
    ds_read_b64_tr_b16 v[94:95], v155 offset:2048
    v_mfma_f32_16x16x32_bf16 a[48:51], v[124:127], v[48:51], a[48:51]
    ds_read_b64_tr_b16 v[96:97], v156 offset:0
    s_add_u32 m0, s71, 0
    s_mov_b32 s67, s65
    buffer_load_dwordx4 v2, s[12:15], s67 offen lds
    v_mfma_f32_16x16x32_bf16 a[52:55], v[124:127], v[52:55], a[52:55]
    ds_read_b64_tr_b16 v[98:99], v156 offset:2048
    v_mfma_f32_16x16x32_bf16 a[56:59], v[124:127], v[56:59], a[56:59]
    ds_read_b64_tr_b16 v[100:101], v157 offset:0
    v_mfma_f32_16x16x32_bf16 a[60:63], v[124:127], v[60:63], a[60:63]
    ds_read_b64_tr_b16 v[102:103], v157 offset:2048
    v_mfma_f32_16x16x32_bf16 a[64:67], v[128:131], v[48:51], a[64:67]
    ds_read_b64_tr_b16 v[104:105], v158 offset:0
    v_mfma_f32_16x16x32_bf16 a[68:71], v[128:131], v[52:55], a[68:71]
    ds_read_b64_tr_b16 v[106:107], v158 offset:2048
    s_add_u32 m0, s71, 2048
    s_add_u32 s67, s65, s76
    buffer_load_dwordx4 v2, s[12:15], s67 offen lds
    v_mfma_f32_16x16x32_bf16 a[72:75], v[128:131], v[56:59], a[72:75]
    ds_read_b64_tr_b16 v[108:109], v159 offset:0
    v_mfma_f32_16x16x32_bf16 a[76:79], v[128:131], v[60:63], a[76:79]
    ds_read_b64_tr_b16 v[110:111], v159 offset:2048
    v_mfma_f32_16x16x32_bf16 a[80:83], v[132:135], v[48:51], a[80:83]
    v_mfma_f32_16x16x32_bf16 a[84:87], v[132:135], v[52:55], a[84:87]
    v_mfma_f32_16x16x32_bf16 a[88:91], v[132:135], v[56:59], a[88:91]
    s_add_u32 m0, s71, 8192
    s_add_u32 s67, s65, s77
    buffer_load_dwordx4 v2, s[12:15], s67 offen lds
    v_mfma_f32_16x16x32_bf16 a[92:95], v[132:135], v[60:63], a[92:95]
    v_mfma_f32_16x16x32_bf16 a[96:99], v[136:139], v[48:51], a[96:99]
    v_mfma_f32_16x16x32_bf16 a[100:103], v[136:139], v[52:55], a[100:103]
    v_mfma_f32_16x16x32_bf16 a[104:107], v[136:139], v[56:59], a[104:107]
    v_mfma_f32_16x16x32_bf16 a[108:111], v[136:139], v[60:63], a[108:111]
    s_add_u32 m0, s71, 10240
    s_add_u32 s67, s65, s78
    buffer_load_dwordx4 v2, s[12:15], s67 offen lds
    s_add_u32 s64, s64, 1024
    s_add_u32 s65, s65, s79
    v_mfma_f32_16x16x32_bf16 a[112:115], v[140:143], v[48:51], a[112:115]
    v_mfma_f32_16x16x32_bf16 a[116:119], v[140:143], v[52:55], a[116:119]
    v_mfma_f32_16x16x32_bf16 a[120:123], v[140:143], v[56:59], a[120:123]
    v_mfma_f32_16x16x32_bf16 a[124:127], v[140:143], v[60:63], a[124:127]
    s_waitcnt vmcnt(6) lgkmcnt(0)
    s_barrier
    v_mfma_f32_16x16x32_bf16 a[0:3], v[80:83], v[16:19], a[0:3]
    ds_read_b128 v[48:51], v4 offset:32768
    v_mfma_f32_16x16x32_bf16 a[4:7], v[80:83], v[20:23], a[4:7]
    ds_read_b64_tr_b16 v[112:113], v152 offset:32768
    v_mfma_f32_16x16x32_bf16 a[8:11], v[80:83], v[24:27], a[8:11]
    ds_read_b64_tr_b16 v[114:115], v152 offset:34816
    s_add_u32 m0, s70, 32768
    s_add_u32 s67, s64, 0
    buffer_load_dwordx4 v1, s[4:7], s67 offen sc1 lds
    v_mfma_f32_16x16x32_bf16 a[12:15], v[80:83], v[28:31], a[12:15]
    ds_read_b128 v[52:55], v4 offset:33792
    v_mfma_f32_16x16x32_bf16 a[16:19], v[84:87], v[16:19], a[16:19]
    ds_read_b64_tr_b16 v[116:117], v153 offset:32768
    v_mfma_f32_16x16x32_bf16 a[20:23], v[84:87], v[20:23], a[20:23]
    ds_read_b64_tr_b16 v[118:119], v153 offset:34816
    v_mfma_f32_16x16x32_bf16 a[24:27], v[84:87], v[24:27], a[24:27]
    ds_read_b128 v[56:59], v4 offset:34816
    v_mfma_f32_16x16x32_bf16 a[28:31], v[84:87], v[28:31], a[28:31]
    ds_read_b64_tr_b16 v[120:121], v154 offset:32768
    s_add_u32 m0, s70, 33792
    s_add_u32 s67, s64, 16384
    buffer_load_dwordx4 v1, s[4:7], s67 offen sc1 lds
    v_mfma_f32_16x16x32_bf16 a[32:35], v[88:91], v[16:19], a[32:35]
    ds_read_b64_tr_b16 v[122:123], v154 offset:34816
    v_mfma_f32_16x16x32_bf16 a[36:39], v[88:91], v[20:23], a[36:39]
    ds_read_b128 v[60:63], v4 offset:35840
    v_mfma_f32_16x16x32_bf16 a[40:43], v[88:91], v[24:27], a[40:43]
    ds_read_b64_tr_b16 v[124:125], v155 offset:32768
    v_mfma_f32_16x16x32_bf16 a[44:47], v[88:91], v[28:31], a[44:47]
    ds_read_b64_tr_b16 v[126:127], v155 offset:34816
    v_mfma_f32_16x16x32_bf16 a[48:51], v[92:95], v[16:19], a[48:51]
    ds_read_b64_tr_b16 v[128:129], v156 offset:32768
    s_add_u32 m0, s71, 32768
    s_mov_b32 s67, s65
    buffer_load_dwordx4 v2, s[12:15], s67 offen lds
    v_mfma_f32_16x16x32_bf16 a[52:55], v[92:95], v[20:23], a[52:55]
    ds_read_b64_tr_b16 v[130:131], v156 offset:34816
    v_mfma_f32_16x16x32_bf16 a[56:59], v[92:95], v[24:27], a[56:59]
    ds_read_b64_tr_b16 v[132:133], v157 offset:32768
    v_mfma_f32_16x16x32_bf16 a[60:63], v[92:95], v[28:31], a[60:63]
    ds_read_b64_tr_b16 v[134:135], v157 offset:34816
    v_mfma_f32_16x16x32_bf16 a[64:67], v[96:99], v[16:19], a[64:67]
    ds_read_b64_tr_b16 v[136:137], v158 offset:32768
    v_mfma_f32_16x16x32_bf16 a[68:71], v[96:99], v[20:23], a[68:71]
    ds_read_b64_tr_b16 v[138:139], v158 offset:34816
    s_add_u32 m0, s71, 34816
    s_add_u32 s67, s65, s76
    buffer_load_dwordx4 v2, s[12:15], s67 offen lds
    v_mfma_f32_16x16x32_bf16 a[72:75], v[96:99], v[24:27], a[72:75]
    ds_read_b64_tr_b16 v[140:141], v159 offset:32768
    v_mfma_f32_16x16x32_bf16 a[76:79], v[96:99], v[28:31], a[76:79]
    ds_read_b64_tr_b16 v[142:143], v159 offset:34816
    v_mfma_f32_16x16x32_bf16 a[80:83], v[100:103], v[16:19], a[80:83]
    v_mfma_f32_16x16x32_bf16 a[84:87], v[100:103], v[20:23], a[84:87]
    v_mfma_f32_16x16x32_bf16 a[88:91], v[100:103], v[24:27], a[88:91]
    s_add_u32 m0, s71, 40960
    s_add_u32 s67, s65, s77
    buffer_load_dwordx4 v2, s[12:15], s67 offen lds
    v_mfma_f32_16x16x32_bf16 a[92:95], v[100:103], v[28:31], a[92:95]
    v_mfma_f32_16x16x32_bf16 a[96:99], v[104:107], v[16:19], a[96:99]
    v_mfma_f32_16x16x32_bf16 a[100:103], v[104:107], v[20:23], a[100:103]
    v_mfma_f32_16x16x32_bf16 a[104:107], v[104:107], v[24:27], a[104:107]
    v_mfma_f32_16x16x32_bf16 a[108:111], v[104:107], v[28:31], a[108:111]
    s_add_u32 m0, s71, 43008
    s_add_u32 s67, s65, s78
    buffer_load_dwordx4 v2, s[12:15], s67 offen lds
    s_add_u32 s64, s64, 1024
    s_add_u32 s65, s65, s79
    v_mfma_f32_16x16x32_bf16 a[112:115], v[108:111], v[16:19], a[112:115]
    v_mfma_f32_16x16x32_bf16 a[116:119], v[108:111], v[20:23], a[116:119]
    v_mfma_f32_16x16x32_bf16 a[120:123], v[108:111], v[24:27], a[120:123]
    v_mfma_f32_16x16x32_bf16 a[124:127], v[108:111], v[28:31], a[124:127]
    s_waitcnt vmcnt(6) lgkmcnt(0)
    s_barrier
    v_mfma_f32_16x16x32_bf16 a[0:3], v[112:115], v[48:51], a[0:3]
    ds_read_b128 v[16:19], v3 offset:0
    v_mfma_f32_16x16x32_bf16 a[4:7], v[112:115], v[52:55], a[4:7]
    ds_read_b64_tr_b16 v[80:81], v144 offset:0
    v_mfma_f32_16x16x32_bf16 a[8:11], v[112:115], v[56:59], a[8:11]
    ds_read_b64_tr_b16 v[82:83], v144 offset:2048
    s_add_u32 m0, s70, 65536
    s_add_u32 s67, s64, 0
    buffer_load_dwordx4 v1, s[4:7], s67 offen sc1 lds
    v_mfma_f32_16x16x32_bf16 a[12:15], v[112:115], v[60:63], a[12:15]
    ds_read_b128 v[20:23], v3 offset:1024
    v_mfma_f32_16x16x32_bf16 a[16:19], v[116:119], v[48:51], a[16:19]
    ds_read_b64_tr_b16 v[84:85], v145 offset:0
    v_mfma_f32_16x16x32_bf16 a[20:23], v[116:119], v[52:55], a[20:23]
    ds_read_b64_tr_b16 v[86:87], v145 offset:2048
    v_mfma_f32_16x16x32_bf16 a[24:27], v[116:119], v[56:59], a[24:27]
    ds_read_b128 v[24:27], v3 offset:2048
    v_mfma_f32_16x16x32_bf16 a[28:31], v[116:119], v[60:63], a[28:31]
    ds_read_b64_tr_b16 v[88:89], v146 offset:0
    s_add_u32 m0, s70, 66560
    s_add_u32 s67, s64, 16384
    buffer_load_dwordx4 v1, s[4:7], s67 offen sc1 lds
    v_mfma_f32_16x16x32_bf16 a[32:35], v[120:123], v[48:51], a[32:35]
    ds_read_b64_tr_b16 v[90:91], v146 offset:2048
    v_mfma_f32_16x16x32_bf16 a[36:39], v[120:123], v[52:55], a[36:39]
    ds_read_b128 v[28:31], v3 offset:3072
    v_mfma_f32_16x16x32_bf16 a[40:43], v[120:123], v[56:59], a[40:43]
    ds_read_b64_tr_b16 v[92:93], v147 offset:0
    v_mfma_f32_16x16x32_bf16 a[44:47], v[120:123], v[60:63], a[44:47]
    ds_read_b64_tr_b16 v[94:95], v147 offset:2048
    v_mfma_f32_16x16x32_bf16 a[48:51], v[124:127], v[48:51], a[48:51]
    ds_read_b64_tr_b16 v[96:97], v148 offset:0
    s_add_u32 m0, s71, 65536
    s_mov_b32 s67, s65
    buffer_load_dwordx4 v2, s[12:15], s67 offen lds
    v_mfma_f32_16x16x32_bf16 a[52:55], v[124:127], v[52:55], a[52:55]
    ds_read_b64_tr_b16 v[98:99], v148 offset:2048
    v_mfma_f32_16x16x32_bf16 a[56:59], v[124:127], v[56:59], a[56:59]
    ds_read_b64_tr_b16 v[100:101], v149 offset:0
    v_mfma_f32_16x16x32_bf16 a[60:63], v[124:127], v[60:63], a[60:63]
    ds_read_b64_tr_b16 v[102:103], v149 offset:2048
    v_mfma_f32_16x16x32_bf16 a[64:67], v[128:131], v[48:51], a[64:67]
    ds_read_b64_tr_b16 v[104:105], v150 offset:0
    v_mfma_f32_16x16x32_bf16 a[68:71], v[128:131], v[52:55], a[68:71]
    ds_read_b64_tr_b16 v[106:107], v150 offset:2048
    s_add_u32 m0, s71, 67584
    s_add_u32 s67, s65, s76
    buffer_load_dwordx4 v2, s[12:15], s67 offen lds
    v_mfma_f32_16x16x32_bf16 a[72:75], v[128:131], v[56:59], a[72:75]
    ds_read_b64_tr_b16 v[108:109], v151 offset:0
    v_mfma_f32_16x16x32_bf16 a[76:79], v[128:131], v[60:63], a[76:79]
    ds_read_b64_tr_b16 v[110:111], v151 offset:2048
    v_mfma_f32_16x16x32_bf16 a[80:83], v[132:135], v[48:51], a[80:83]
    v_mfma_f32_16x16x32_bf16 a[84:87], v[132:135], v[52:55], a[84:87]
    v_mfma_f32_16x16x32_bf16 a[88:91], v[132:135], v[56:59], a[88:91]
    s_add_u32 m0, s71, 73728
    s_add_u32 s67, s65, s77
    buffer_load_dwordx4 v2, s[12:15], s67 offen lds
    v_mfma_f32_16x16x32_bf16 a[92:95], v[132:135], v[60:63], a[92:95]
    v_mfma_f32_16x16x32_bf16 a[96:99], v[136:139], v[48:51], a[96:99]
    v_mfma_f32_16x16x32_bf16 a[100:103], v[136:139], v[52:55], a[100:103]
    v_mfma_f32_16x16x32_bf16 a[104:107], v[136:139], v[56:59], a[104:107]
    v_mfma_f32_16x16x32_bf16 a[108:111], v[136:139], v[60:63], a[108:111]
    s_add_u32 m0, s71, 75776
    s_add_u32 s67, s65, s78
    buffer_load_dwordx4 v2, s[12:15], s67 offen lds
    s_add_u32 s64, s64, 1024
    s_add_u32 s65, s65, s79
    v_mfma_f32_16x16x32_bf16 a[112:115], v[140:143], v[48:51], a[112:115]
    v_mfma_f32_16x16x32_bf16 a[116:119], v[140:143], v[52:55], a[116:119]
    v_mfma_f32_16x16x32_bf16 a[120:123], v[140:143], v[56:59], a[120:123]
    v_mfma_f32_16x16x32_bf16 a[124:127], v[140:143], v[60:63], a[124:127]
    s_add_u32 s63, s63, 1
    s_cmp_lt_u32 s63, 3
    s_cbranch_scc1 L_wk_k0
    s_waitcnt vmcnt(6) lgkmcnt(0)
    s_barrier
    v_mfma_f32_16x16x32_bf16 a[0:3], v[80:83], v[16:19], a[0:3]
    ds_read_b128 v[48:51], v3 offset:32768
    v_mfma_f32_16x16x32_bf16 a[4:7], v[80:83], v[20:23], a[4:7]
    ds_read_b64_tr_b16 v[112:113], v144 offset:32768
    v_mfma_f32_16x16x32_bf16 a[8:11], v[80:83], v[24:27], a[8:11]
    ds_read_b64_tr_b16 v[114:115], v144 offset:34816
    s_add_u32 m0, s70, 98304
    s_add_u32 s67, s64, 0
    buffer_load_dwordx4 v1, s[4:7], s67 offen sc1 lds
    v_mfma_f32_16x16x32_bf16 a[12:15], v[80:83], v[28:31], a[12:15]
    ds_read_b128 v[52:55], v3 offset:33792
    v_mfma_f32_16x16x32_bf16 a[16:19], v[84:87], v[16:19], a[16:19]
    ds_read_b64_tr_b16 v[116:117], v145 offset:32768
    v_mfma_f32_16x16x32_bf16 a[20:23], v[84:87], v[20:23], a[20:23]
    ds_read_b64_tr_b16 v[118:119], v145 offset:34816
    v_mfma_f32_16x16x32_bf16 a[24:27], v[84:87], v[24:27], a[24:27]
    ds_read_b128 v[56:59], v3 offset:34816
    v_mfma_f32_16x16x32_bf16 a[28:31], v[84:87], v[28:31], a[28:31]
    ds_read_b64_tr_b16 v[120:121], v146 offset:32768
    s_add_u32 m0, s70, 99328
    s_add_u32 s67, s64, 16384
    buffer_load_dwordx4 v1, s[4:7], s67 offen sc1 lds
    v_mfma_f32_16x16x32_bf16 a[32:35], v[88:91], v[16:19], a[32:35]
    ds_read_b64_tr_b16 v[122:123], v146 offset:34816
    v_mfma_f32_16x16x32_bf16 a[36:39], v[88:91], v[20:23], a[36:39]
    ds_read_b128 v[60:63], v3 offset:35840
    v_mfma_f32_16x16x32_bf16 a[40:43], v[88:91], v[24:27], a[40:43]
    ds_read_b64_tr_b16 v[124:125], v147 offset:32768
    v_mfma_f32_16x16x32_bf16 a[44:47], v[88:91], v[28:31], a[44:47]
    ds_read_b64_tr_b16 v[126:127], v147 offset:34816
    v_mfma_f32_16x16x32_bf16 a[48:51], v[92:95], v[16:19], a[48:51]
    ds_read_b64_tr_b16 v[128:129], v148 offset:32768
    s_add_u32 m0, s71, 98304
    s_mov_b32 s67, s65
    buffer_load_dwordx4 v2, s[12:15], s67 offen lds
    v_mfma_f32_16x16x32_bf16 a[52:55], v[92:95], v[20:23], a[52:55]
    ds_read_b64_tr_b16 v[130:131], v148 offset:34816
    v_mfma_f32_16x16x32_bf16 a[56:59], v[92:95], v[24:27], a[56:59]
    ds_read_b64_tr_b16 v[132:133], v149 offset:32768
    v_mfma_f32_16x16x32_bf16 a[60:63], v[92:95], v[28:31], a[60:63]
    ds_read_b64_tr_b16 v[134:135], v149 offset:34816
    v_mfma_f32_16x16x32_bf16 a[64:67], v[96:99], v[16:19], a[64:67]
    ds_read_b64_tr_b16 v[136:137], v150 offset:32768
    v_mfma_f32_16x16x32_bf16 a[68:71], v[96:99], v[20:23], a[68:71]
    ds_read_b64_tr_b16 v[138:139], v150 offset:34816
    s_add_u32 m0, s71, 100352
    s_add_u32 s67, s65, s76
    buffer_load_dwordx4 v2, s[12:15], s67 offen lds
    v_mfma_f32_16x16x32_bf16 a[72:75], v[96:99], v[24:27], a[72:75]
    ds_read_b64_tr_b16 v[140:141], v151 offset:32768
    v_mfma_f32_16x16x32_bf16 a[76:79], v[96:99], v[28:31], a[76:79]
    ds_read_b64_tr_b16 v[142:143], v151 offset:34816
    v_mfma_f32_16x16x32_bf16 a[80:83], v[100:103], v[16:19], a[80:83]
    v_mfma_f32_16x16x32_bf16 a[84:87], v[100:103], v[20:23], a[84:87]
    v_mfma_f32_16x16x32_bf16 a[88:91], v[100:103], v[24:27], a[88:91]
    s_add_u32 m0, s71, 106496
    s_add_u32 s67, s65, s77
    buffer_load_dwordx4 v2, s[12:15], s67 offen lds
    v_mfma_f32_16x16x32_bf16 a[92:95], v[100:103], v[28:31], a[92:95]
    v_mfma_f32_16x16x32_bf16 a[96:99], v[104:107], v[16:19], a[96:99]
    v_mfma_f32_16x16x32_bf16 a[100:103], v[104:107], v[20:23], a[100:103]
    v_mfma_f32_16x16x32_bf16 a[104:107], v[104:107], v[24:27], a[104:107]
    v_mfma_f32_16x16x32_bf16 a[108:111], v[104:107], v[28:31], a[108:111]
    s_add_u32 m0, s71, 108544
    s_add_u32 s67, s65, s78
    buffer_load_dwordx4 v2, s[12:15], s67 offen lds
    s_add_u32 s64, s64, 1024
    s_add_u32 s65, s65, s79
    v_mfma_f32_16x16x32_bf16 a[112:115], v[108:111], v[16:19], a[112:115]
    v_mfma_f32_16x16x32_bf16 a[116:119], v[108:111], v[20:23], a[116:119]
    v_mfma_f32_16x16x32_bf16 a[120:123], v[108:111], v[24:27], a[120:123]
    v_mfma_f32_16x16x32_bf16 a[124:127], v[108:111], v[28:31], a[124:127]
    s_waitcnt vmcnt(6) lgkmcnt(0)
    s_barrier
    v_mfma_f32_16x16x32_bf16 a[0:3], v[112:115], v[48:51], a[0:3]
    ds_read_b128 v[16:19], v4 offset:0
    v_mfma_f32_16x16x32_bf16 a[4:7], v[112:115], v[52:55], a[4:7]
    ds_read_b64_tr_b16 v[80:81], v152 offset:0
    v_mfma_f32_16x16x32_bf16 a[8:11], v[112:115], v[56:59], a[8:11]
    ds_read_b64_tr_b16 v[82:83], v152 offset:2048
    v_mfma_f32_16x16x32_bf16 a[12:15], v[112:115], v[60:63], a[12:15]
    ds_read_b128 v[20:23], v4 offset:1024
    v_mfma_f32_16x16x32_bf16 a[16:19], v[116:119], v[48:51], a[16:19]
    ds_read_b64_tr_b16 v[84:85], v153 offset:0
    v_mfma_f32_16x16x32_bf16 a[20:23], v[116:119], v[52:55], a[20:23]
    ds_read_b64_tr_b16 v[86:87], v153 offset:2048
    v_mfma_f32_16x16x32_bf16 a[24:27], v[116:119], v[56:59], a[24:27]
    ds_read_b128 v[24:27], v4 offset:2048
    v_mfma_f32_16x16x32_bf16 a[28:31], v[116:119], v[60:63], a[28:31]
    ds_read_b64_tr_b16 v[88:89], v154 offset:0
    v_mfma_f32_16x16x32_bf16 a[32:35], v[120:123], v[48:51], a[32:35]
    ds_read_b64_tr_b16 v[90:91], v154 offset:2048
    v_mfma_f32_16x16x32_bf16 a[36:39], v[120:123], v[52:55], a[36:39]
    ds_read_b128 v[28:31], v4 offset:3072
    v_mfma_f32_16x16x32_bf16 a[40:43], v[120:123], v[56:59], a[40:43]
    ds_read_b64_tr_b16 v[92:93], v155 offset:0
    v_mfma_f32_16x16x32_bf16 a[44:47], v[120:123], v[60:63], a[44:47]
    ds_read_b64_tr_b16 v[94:95], v155 offset:2048
    v_mfma_f32_16x16x32_bf16 a[48:51], v[124:127], v[48:51], a[48:51]
    ds_read_b64_tr_b16 v[96:97], v156 offset:0
    v_mfma_f32_16x16x32_bf16 a[52:55], v[124:127], v[52:55], a[52:55]
    ds_read_b64_tr_b16 v[98:99], v156 offset:2048
    v_mfma_f32_16x16x32_bf16 a[56:59], v[124:127], v[56:59], a[56:59]
    ds_read_b64_tr_b16 v[100:101], v157 offset:0
    v_mfma_f32_16x16x32_bf16 a[60:63], v[124:127], v[60:63], a[60:63]
    ds_read_b64_tr_b16 v[102:103], v157 offset:2048
    v_mfma_f32_16x16x32_bf16 a[64:67], v[128:131], v[48:51], a[64:67]
    ds_read_b64_tr_b16 v[104:105], v158 offset:0
    v_mfma_f32_16x16x32_bf16 a[68:71], v[128:131], v[52:55], a[68:71]
    ds_read_b64_tr_b16 v[106:107], v158 offset:2048
    v_mfma_f32_16x16x32_bf16 a[72:75], v[128:131], v[56:59], a[72:75]
    ds_read_b64_tr_b16 v[108:109], v159 offset:0
    v_mfma_f32_16x16x32_bf16 a[76:79], v[128:131], v[60:63], a[76:79]
    ds_read_b64_tr_b16 v[110:111], v159 offset:2048
    v_mfma_f32_16x16x32_bf16 a[80:83], v[132:135], v[48:51], a[80:83]
    v_mfma_f32_16x16x32_bf16 a[84:87], v[132:135], v[52:55], a[84:87]
    v_mfma_f32_16x16x32_bf16 a[88:91], v[132:135], v[56:59], a[88:91]
    v_mfma_f32_16x16x32_bf16 a[92:95], v[132:135], v[60:63], a[92:95]
    v_mfma_f32_16x16x32_bf16 a[96:99], v[136:139], v[48:51], a[96:99]
    v_mfma_f32_16x16x32_bf16 a[100:103], v[136:139], v[52:55], a[100:103]
    v_mfma_f32_16x16x32_bf16 a[104:107], v[136:139], v[56:59], a[104:107]
    v_mfma_f32_16x16x32_bf16 a[108:111], v[136:139], v[60:63], a[108:111]
    v_mfma_f32_16x16x32_bf16 a[112:115], v[140:143], v[48:51], a[112:115]
    v_mfma_f32_16x16x32_bf16 a[116:119], v[140:143], v[52:55], a[116:119]
    v_mfma_f32_16x16x32_bf16 a[120:123], v[140:143], v[56:59], a[120:123]
    v_mfma_f32_16x16x32_bf16 a[124:127], v[140:143], v[60:63], a[124:127]
    s_waitcnt vmcnt(0) lgkmcnt(0)
    s_barrier
    v_mfma_f32_16x16x32_bf16 a[0:3], v[80:83], v[16:19], a[0:3]
    ds_read_b128 v[48:51], v4 offset:32768
    v_mfma_f32_16x16x32_bf16 a[4:7], v[80:83], v[20:23], a[4:7]
    ds_read_b64_tr_b16 v[112:113], v152 offset:32768
    v_mfma_f32_16x16x32_bf16 a[8:11], v[80:83], v[24:27], a[8:11]
    ds_read_b64_tr_b16 v[114:115], v152 offset:34816
    v_mfma_f32_16x16x32_bf16 a[12:15], v[80:83], v[28:31], a[12:15]
    ds_read_b128 v[52:55], v4 offset:33792
    v_mfma_f32_16x16x32_bf16 a[16:19], v[84:87], v[16:19], a[16:19]
    ds_read_b64_tr_b16 v[116:117], v153 offset:32768
    v_mfma_f32_16x16x32_bf16 a[20:23], v[84:87], v[20:23], a[20:23]
    ds_read_b64_tr_b16 v[118:119], v153 offset:34816
    v_mfma_f32_16x16x32_bf16 a[24:27], v[84:87], v[24:27], a[24:27]
    ds_read_b128 v[56:59], v4 offset:34816
    v_mfma_f32_16x16x32_bf16 a[28:31], v[84:87], v[28:31], a[28:31]
    ds_read_b64_tr_b16 v[120:121], v154 offset:32768
    v_mfma_f32_16x16x32_bf16 a[32:35], v[88:91], v[16:19], a[32:35]
    ds_read_b64_tr_b16 v[122:123], v154 offset:34816
    v_mfma_f32_16x16x32_bf16 a[36:39], v[88:91], v[20:23], a[36:39]
    ds_read_b128 v[60:63], v4 offset:35840
    v_mfma_f32_16x16x32_bf16 a[40:43], v[88:91], v[24:27], a[40:43]
    ds_read_b64_tr_b16 v[124:125], v155 offset:32768
    v_mfma_f32_16x16x32_bf16 a[44:47], v[88:91], v[28:31], a[44:47]
    ds_read_b64_tr_b16 v[126:127], v155 offset:34816
    v_mfma_f32_16x16x32_bf16 a[48:51], v[92:95], v[16:19], a[48:51]
    ds_read_b64_tr_b16 v[128:129], v156 offset:32768
    v_mfma_f32_16x16x32_bf16 a[52:55], v[92:95], v[20:23], a[52:55]
    ds_read_b64_tr_b16 v[130:131], v156 offset:34816
    v_mfma_f32_16x16x32_bf16 a[56:59], v[92:95], v[24:27], a[56:59]
    ds_read_b64_tr_b16 v[132:133], v157 offset:32768
    v_mfma_f32_16x16x32_bf16 a[60:63], v[92:95], v[28:31], a[60:63]
    ds_read_b64_tr_b16 v[134:135], v157 offset:34816
    v_mfma_f32_16x16x32_bf16 a[64:67], v[96:99], v[16:19], a[64:67]
    ds_read_b64_tr_b16 v[136:137], v158 offset:32768
    v_mfma_f32_16x16x32_bf16 a[68:71], v[96:99], v[20:23], a[68:71]
    ds_read_b64_tr_b16 v[138:139], v158 offset:34816
    v_mfma_f32_16x16x32_bf16 a[72:75], v[96:99], v[24:27], a[72:75]
    ds_read_b64_tr_b16 v[140:141], v159 offset:32768
    v_mfma_f32_16x16x32_bf16 a[76:79], v[96:99], v[28:31], a[76:79]
    ds_read_b64_tr_b16 v[142:143], v159 offset:34816
    v_mfma_f32_16x16x32_bf16 a[80:83], v[100:103], v[16:19], a[80:83]
    v_mfma_f32_16x16x32_bf16 a[84:87], v[100:103], v[20:23], a[84:87]
    v_mfma_f32_16x16x32_bf16 a[88:91], v[100:103], v[24:27], a[88:91]
    v_mfma_f32_16x16x32_bf16 a[92:95], v[100:103], v[28:31], a[92:95]
    v_mfma_f32_16x16x32_bf16 a[96:99], v[104:107], v[16:19], a[96:99]
    v_mfma_f32_16x16x32_bf16 a[100:103], v[104:107], v[20:23], a[100:103]
    v_mfma_f32_16x16x32_bf16 a[104:107], v[104:107], v[24:27], a[104:107]
    v_mfma_f32_16x16x32_bf16 a[108:111], v[104:107], v[28:31], a[108:111]
    v_mfma_f32_16x16x32_bf16 a[112:115], v[108:111], v[16:19], a[112:115]
    v_mfma_f32_16x16x32_bf16 a[116:119], v[108:111], v[20:23], a[116:119]
    v_mfma_f32_16x16x32_bf16 a[120:123], v[108:111], v[24:27], a[120:123]
    v_mfma_f32_16x16x32_bf16 a[124:127], v[108:111], v[28:31], a[124:127]
    s_waitcnt lgkmcnt(0)
    v_mfma_f32_16x16x32_bf16 a[0:3], v[112:115], v[48:51], a[0:3]
    v_mfma_f32_16x16x32_bf16 a[4:7], v[112:115], v[52:55], a[4:7]
    v_mfma_f32_16x16x32_bf16 a[8:11], v[112:115], v[56:59], a[8:11]
    v_mfma_f32_16x16x32_bf16 a[12:15], v[112:115], v[60:63], a[12:15]
    v_mfma_f32_16x16x32_bf16 a[16:19], v[116:119], v[48:51], a[16:19]
    v_mfma_f32_16x16x32_bf16 a[20:23], v[116:119], v[52:55], a[20:23]
    v_mfma_f32_16x16x32_bf16 a[24:27], v[116:119], v[56:59], a[24:27]
    v_mfma_f32_16x16x32_bf16 a[28:31], v[116:119], v[60:63], a[28:31]
    v_mfma_f32_16x16x32_bf16 a[32:35], v[120:123], v[48:51], a[32:35]
    v_mfma_f32_16x16x32_bf16 a[36:39], v[120:123], v[52:55], a[36:39]
    v_mfma_f32_16x16x32_bf16 a[40:43], v[120:123], v[56:59], a[40:43]
    v_mfma_f32_16x16x32_bf16 a[44:47], v[120:123], v[60:63], a[44:47]
    v_mfma_f32_16x16x32_bf16 a[48:51], v[124:127], v[48:51], a[48:51]
    v_mfma_f32_16x16x32_bf16 a[52:55], v[124:127], v[52:55], a[52:55]
    v_mfma_f32_16x16x32_bf16 a[56:59], v[124:127], v[56:59], a[56:59]
    v_mfma_f32_16x16x32_bf16 a[60:63], v[124:127], v[60:63], a[60:63]
    v_mfma_f32_16x16x32_bf16 a[64:67], v[128:131], v[48:51], a[64:67]
    v_mfma_f32_16x16x32_bf16 a[68:71], v[128:131], v[52:55], a[68:71]
    v_mfma_f32_16x16x32_bf16 a[72:75], v[128:131], v[56:59], a[72:75]
    v_mfma_f32_16x16x32_bf16 a[76:79], v[128:131], v[60:63], a[76:79]
    v_mfma_f32_16x16x32_bf16 a[80:83], v[132:135], v[48:51], a[80:83]
    v_mfma_f32_16x16x32_bf16 a[84:87], v[132:135], v[52:55], a[84:87]
    v_mfma_f32_16x16x32_bf16 a[88:91], v[132:135], v[56:59], a[88:91]
    v_mfma_f32_16x16x32_bf16 a[92:95], v[132:135], v[60:63], a[92:95]
    v_mfma_f32_16x16x32_bf16 a[96:99], v[136:139], v[48:51], a[96:99]
    v_mfma_f32_16x16x32_bf16 a[100:103], v[136:139], v[52:55], a[100:103]
    v_mfma_f32_16x16x32_bf16 a[104:107], v[136:139], v[56:59], a[104:107]
    v_mfma_f32_16x16x32_bf16 a[108:111], v[136:139], v[60:63], a[108:111]
    v_mfma_f32_16x16x32_bf16 a[112:115], v[140:143], v[48:51], a[112:115]
    v_mfma_f32_16x16x32_bf16 a[116:119], v[140:143], v[52:55], a[116:119]
    v_mfma_f32_16x16x32_bf16 a[120:123], v[140:143], v[56:59], a[120:123]
    v_mfma_f32_16x16x32_bf16 a[124:127], v[140:143], v[60:63], a[124:127]
    s_branch L_wk_epi
L_wk_v:
    s_mov_b32 s63, 0
L_wk_k1:
    s_waitcnt vmcnt(6) lgkmcnt(0)
    s_barrier
    v_mfma_f32_16x16x32_bf16 a[0:3], v[16:19], v[80:83], a[0:3]
    ds_read_b128 v[48:51], v3 offset:32768
    v_mfma_f32_16x16x32_bf16 a[4:7], v[20:23], v[80:83], a[4:7]
    ds_read_b64_tr_b16 v[112:113], v144 offset:32768
    v_mfma_f32_16x16x32_bf16 a[8:11], v[24:27], v[80:83], a[8:11]
    ds_read_b64_tr_b16 v[114:115], v144 offset:34816
    s_add_u32 m0, s70, 98304
    s_add_u32 s67, s64, 0
    buffer_load_dwordx4 v1, s[4:7], s67 offen sc1 lds
    v_mfma_f32_16x16x32_bf16 a[12:15], v[28:31], v[80:83], a[12:15]
    ds_read_b128 v[52:55], v3 offset:33792
    v_mfma_f32_16x16x32_bf16 a[16:19], v[16:19], v[84:87], a[16:19]
    ds_read_b64_tr_b16 v[116:117], v145 offset:32768
    v_mfma_f32_16x16x32_bf16 a[20:23], v[20:23], v[84:87], a[20:23]
    ds_read_b64_tr_b16 v[118:119], v145 offset:34816
    v_mfma_f32_16x16x32_bf16 a[24:27], v[24:27], v[84:87], a[24:27]
    ds_read_b128 v[56:59], v3 offset:34816
    v_mfma_f32_16x16x32_bf16 a[28:31], v[28:31], v[84:87], a[28:31]
    ds_read_b64_tr_b16 v[120:121], v146 offset:32768
    s_add_u32 m0, s70, 99328
    s_add_u32 s67, s64, 16384
    buffer_load_dwordx4 v1, s[4:7], s67 offen sc1 lds
    v_mfma_f32_16x16x32_bf16 a[32:35], v[16:19], v[88:91], a[32:35]
    ds_read_b64_tr_b16 v[122:123], v146 offset:34816
    v_mfma_f32_16x16x32_bf16 a[36:39], v[20:23], v[88:91], a[36:39]
    ds_read_b128 v[60:63], v3 offset:35840
    v_mfma_f32_16x16x32_bf16 a[40:43], v[24:27], v[88:91], a[40:43]
    ds_read_b64_tr_b16 v[124:125], v147 offset:32768
    v_mfma_f32_16x16x32_bf16 a[44:47], v[28:31], v[88:91], a[44:47]
    ds_read_b64_tr_b16 v[126:127], v147 offset:34816
    v_mfma_f32_16x16x32_bf16 a[48:51], v[16:19], v[92:95], a[48:51]
    ds_read_b64_tr_b16 v[128:129], v148 offset:32768
    s_add_u32 m0, s71, 98304
    s_mov_b32 s67, s65
    buffer_load_dwordx4 v2, s[12:15], s67 offen lds
    v_mfma_f32_16x16x32_bf16 a[52:55], v[20:23], v[92:95], a[52:55]
    ds_read_b64_tr_b16 v[130:131], v148 offset:34816
    v_mfma_f32_16x16x32_bf16 a[56:59], v[24:27], v[92:95], a[56:59]
    ds_read_b64_tr_b16 v[132:133], v149 offset:32768
    v_mfma_f32_16x16x32_bf16 a[60:63], v[28:31], v[92:95], a[60:63]
    ds_read_b64_tr_b16 v[134:135], v149 offset:34816
    v_mfma_f32_16x16x32_bf16 a[64:67], v[16:19], v[96:99], a[64:67]
    ds_read_b64_tr_b16 v[136:137], v150 offset:32768
    v_mfma_f32_16x16x32_bf16 a[68:71], v[20:23], v[96:99], a[68:71]
    ds_read_b64_tr_b16 v[138:139], v150 offset:34816
    s_add_u32 m0, s71, 100352
    s_add_u32 s67, s65, s76
    buffer_load_dwordx4 v2, s[12:15], s67 offen lds
    v_mfma_f32_16x16x32_bf16 a[72:75], v[24:27], v[96:99], a[72:75]
    ds_read_b64_tr_b16 v[140:141], v151 offset:32768
    v_mfma_f32_16x16x32_bf16 a[76:79], v[28:31], v[96:99], a[76:79]
    ds_read_b64_tr_b16 v[142:143], v151 offset:34816
    v_mfma_f32_16x16x32_bf16 a[80:83], v[16:19], v[100:103], a[80:83]
    v_mfma_f32_16x16x32_bf16 a[84:87], v[20:23], v[100:103], a[84:87]
    v_mfma_f32_16x16x32_bf16 a[88:91], v[24:27], v[100:103], a[88:91]
    s_add_u32 m0, s71, 106496
    s_add_u32 s67, s65, s77
    buffer_load_dwordx4 v2, s[12:15], s67 offen lds
    v_mfma_f32_16x16x32_bf16 a[92:95], v[28:31], v[100:103], a[92:95]
    v_mfma_f32_16x16x32_bf16 a[96:99], v[16:19], v[104:107], a[96:99]
    v_mfma_f32_16x16x32_bf16 a[100:103], v[20:23], v[104:107], a[100:103]
    v_mfma_f32_16x16x32_bf16 a[104:107], v[24:27], v[104:107], a[104:107]
    v_mfma_f32_16x16x32_bf16 a[108:111], v[28:31], v[104:107], a[108:111]
    s_add_u32 m0, s71, 108544
    s_add_u32 s67, s65, s78
    buffer_load_dwordx4 v2, s[12:15], s67 offen lds
    s_add_u32 s64, s64, 1024
    s_add_u32 s65, s65, s79
    v_mfma_f32_16x16x32_bf16 a[112:115], v[16:19], v[108:111], a[112:115]
    v_mfma_f32_16x16x32_bf16 a[116:119], v[20:23], v[108:111], a[116:119]
    v_mfma_f32_16x16x32_bf16 a[120:123], v[24:27], v[108:111], a[120:123]
    v_mfma_f32_16x16x32_bf16 a[124:127], v[28:31], v[108:111], a[124:127]
    s_waitcnt vmcnt(6) lgkmcnt(0)
    s_barrier
    v_mfma_f32_16x16x32_bf16 a[0:3], v[48:51], v[112:115], a[0:3]
    ds_read_b128 v[16:19], v4 offset:0
    v_mfma_f32_16x16x32_bf16 a[4:7], v[52:55], v[112:115], a[4:7]
    ds_read_b64_tr_b16 v[80:81], v152 offset:0
    v_mfma_f32_16x16x32_bf16 a[8:11], v[56:59], v[112:115], a[8:11]
    ds_read_b64_tr_b16 v[82:83], v152 offset:2048
    s_add_u32 m0, s70, 0
    s_add_u32 s67, s64, 0
    buffer_load_dwordx4 v1, s[4:7], s67 offen sc1 lds
    v_mfma_f32_16x16x32_bf16 a[12:15], v[60:63], v[112:115], a[12:15]
    ds_read_b128 v[20:23], v4 offset:1024
    v_mfma_f32_16x16x32_bf16 a[16:19], v[48:51], v[116:119], a[16:19]
    ds_read_b64_tr_b16 v[84:85], v153 offset:0
    v_mfma_f32_16x16x32_bf16 a[20:23], v[52:55], v[116:119], a[20:23]
    ds_read_b64_tr_b16 v[86:87], v153 offset:2048
    v_mfma_f32_16x16x32_bf16 a[24:27], v[56:59], v[116:119], a[24:27]
    ds_read_b128 v[24:27], v4 offset:2048
    v_mfma_f32_16x16x32_bf16 a[28:31], v[60:63], v[116:119], a[28:31]
    ds_read_b64_tr_b16 v[88:89], v154 offset:0
    s_add_u32 m0, s70, 1024
    s_add_u32 s67, s64, 16384
    buffer_load_dwordx4 v1, s[4:7], s67 offen sc1 lds
    v_mfma_f32_16x16x32_bf16 a[32:35], v[48:51], v[120:123], a[32:35]
    ds_read_b64_tr_b16 v[90:91], v154 offset:2048
    v_mfma_f32_16x16x32_bf16 a[36:39], v[52:55], v[120:123], a[36:39]
    ds_read_b128 v[28:31], v4 offset:3072
    v_mfma_f32_16x16x32_bf16 a[40:43], v[56:59], v[120:123], a[40:43]
    ds_read_b64_tr_b16 v[92:93], v155 offset:0
    v_mfma_f32_16x16x32_bf16 a[44:47], v[60:63], v[120:123], a[44:47]
    ds_read_b64_tr_b16 v[94:95], v155 offset:2048
    v_mfma_f32_16x16x32_bf16 a[48:51], v[48:51], v[124:127], a[48:51]
    ds_read_b64_tr_b16 v[96:97], v156 offset:0
    s_add_u32 m0, s71, 0
    s_mov_b32 s67, s65
    buffer_load_dwordx4 v2, s[12:15], s67 offen lds
    v_mfma_f32_16x16x32_bf16 a[52:55], v[52:55], v[124:127], a[52:55]
    ds_read_b64_tr_b16 v[98:99], v156 offset:2048
    v_mfma_f32_16x16x32_bf16 a[56:59], v[56:59], v[124:127], a[56:59]
    ds_read_b64_tr_b16 v[100:101], v157 offset:0
    v_mfma_f32_16x16x32_bf16 a[60:63], v[60:63], v[124:127], a[60:63]
    ds_read_b64_tr_b16 v[102:103], v157 offset:2048
    v_mfma_f32_16x16x32_bf16 a[64:67], v[48:51], v[128:131], a[64:67]
    ds_read_b64_tr_b16 v[104:105], v158 offset:0
    v_mfma_f32_16x16x32_bf16 a[68:71], v[52:55], v[128:131], a[68:71]
    ds_read_b64_tr_b16 v[106:107], v158 offset:2048
    s_add_u32 m0, s71, 2048
    s_add_u32 s67, s65, s76
    buffer_load_dwordx4 v2, s[12:15], s67 offen lds
    v_mfma_f32_16x16x32_bf16 a[72:75], v[56:59], v[128:131], a[72:75]
    ds_read_b64_tr_b16 v[108:109], v159 offset:0
    v_mfma_f32_16x16x32_bf16 a[76:79], v[60:63], v[128:131], a[76:79]
    ds_read_b64_tr_b16 v[110:111], v159 offset:2048
    v_mfma_f32_16x16x32_bf16 a[80:83], v[48:51], v[132:135], a[80:83]
    v_mfma_f32_16x16x32_bf16 a[84:87], v[52:55], v[132:135], a[84:87]
    v_mfma_f32_16x16x32_bf16 a[88:91], v[56:59], v[132:135], a[88:91]
    s_add_u32 m0, s71, 8192
    s_add_u32 s67, s65, s77
    buffer_load_dwordx4 v2, s[12:15], s67 offen lds
    v_mfma_f32_16x16x32_bf16 a[92:95], v[60:63], v[132:135], a[92:95]
    v_mfma_f32_16x16x32_bf16 a[96:99], v[48:51], v[136:139], a[96:99]
    v_mfma_f32_16x16x32_bf16 a[100:103], v[52:55], v[136:139], a[100:103]
    v_mfma_f32_16x16x32_bf16 a[104:107], v[56:59], v[136:139], a[104:107]
    v_mfma_f32_16x16x32_bf16 a[108:111], v[60:63], v[136:139], a[108:111]
    s_add_u32 m0, s71, 10240
    s_add_u32 s67, s65, s78
    buffer_load_dwordx4 v2, s[12:15], s67 offen lds
    s_add_u32 s64, s64, 1024
    s_add_u32 s65, s65, s79
    v_mfma_f32_16x16x32_bf16 a[112:115], v[48:51], v[140:143], a[112:115]
    v_mfma_f32_16x16x32_bf16 a[116:119], v[52:55], v[140:143], a[116:119]
    v_mfma_f32_16x16x32_bf16 a[120:123], v[56:59], v[140:143], a[120:123]
    v_mfma_f32_16x16x32_bf16 a[124:127], v[60:63], v[140:143], a[124:127]
    s_waitcnt vmcnt(6) lgkmcnt(0)
    s_barrier
    v_mfma_f32_16x16x32_bf16 a[0:3], v[16:19], v[80:83], a[0:3]
    ds_read_b128 v[48:51], v4 offset:32768
    v_mfma_f32_16x16x32_bf16 a[4:7], v[20:23], v[80:83], a[4:7]
    ds_read_b64_tr_b16 v[112:113], v152 offset:32768
    v_mfma_f32_16x16x32_bf16 a[8:11], v[24:27], v[80:83], a[8:11]
    ds_read_b64_tr_b16 v[114:115], v152 offset:34816
    s_add_u32 m0, s70, 32768
    s_add_u32 s67, s64, 0
    buffer_load_dwordx4 v1, s[4:7], s67 offen sc1 lds
    v_mfma_f32_16x16x32_bf16 a[12:15], v[28:31], v[80:83], a[12:15]
    ds_read_b128 v[52:55], v4 offset:33792
    v_mfma_f32_16x16x32_bf16 a[16:19], v[16:19], v[84:87], a[16:19]
    ds_read_b64_tr_b16 v[116:117], v153 offset:32768
    v_mfma_f32_16x16x32_bf16 a[20:23], v[20:23], v[84:87], a[20:23]
    ds_read_b64_tr_b16 v[118:119], v153 offset:34816
    v_mfma_f32_16x16x32_bf16 a[24:27], v[24:27], v[84:87], a[24:27]
    ds_read_b128 v[56:59], v4 offset:34816
    v_mfma_f32_16x16x32_bf16 a[28:31], v[28:31], v[84:87], a[28:31]
    ds_read_b64_tr_b16 v[120:121], v154 offset:32768
    s_add_u32 m0, s70, 33792
    s_add_u32 s67, s64, 16384
    buffer_load_dwordx4 v1, s[4:7], s67 offen sc1 lds
    v_mfma_f32_16x16x32_bf16 a[32:35], v[16:19], v[88:91], a[32:35]
    ds_read_b64_tr_b16 v[122:123], v154 offset:34816
    v_mfma_f32_16x16x32_bf16 a[36:39], v[20:23], v[88:91], a[36:39]
    ds_read_b128 v[60:63], v4 offset:35840
    v_mfma_f32_16x16x32_bf16 a[40:43], v[24:27], v[88:91], a[40:43]
    ds_read_b64_tr_b16 v[124:125], v155 offset:32768
    v_mfma_f32_16x16x32_bf16 a[44:47], v[28:31], v[88:91], a[44:47]
    ds_read_b64_tr_b16 v[126:127], v155 offset:34816
    v_mfma_f32_16x16x32_bf16 a[48:51], v[16:19], v[92:95], a[48:51]
    ds_read_b64_tr_b16 v[128:129], v156 offset:32768
    s_add_u32 m0, s71, 32768
    s_mov_b32 s67, s65
    buffer_load_dwordx4 v2, s[12:15], s67 offen lds
    v_mfma_f32_16x16x32_bf16 a[52:55], v[20:23], v[92:95], a[52:55]
    ds_read_b64_tr_b16 v[130:131], v156 offset:34816
    v_mfma_f32_16x16x32_bf16 a[56:59], v[24:27], v[92:95], a[56:59]
    ds_read_b64_tr_b16 v[132:133], v157 offset:32768
    v_mfma_f32_16x16x32_bf16 a[60:63], v[28:31], v[92:95], a[60:63]
    ds_read_b64_tr_b16 v[134:135], v157 offset:34816
    v_mfma_f32_16x16x32_bf16 a[64:67], v[16:19], v[96:99], a[64:67]
    ds_read_b64_tr_b16 v[136:137], v158 offset:32768
    v_mfma_f32_16x16x32_bf16 a[68:71], v[20:23], v[96:99], a[68:71]
    ds_read_b64_tr_b16 v[138:139], v158 offset:34816
    s_add_u32 m0, s71, 34816
    s_add_u32 s67, s65, s76
    buffer_load_dwordx4 v2, s[12:15], s67 offen lds
    v_mfma_f32_16x16x32_bf16 a[72:75], v[24:27], v[96:99], a[72:75]
    ds_read_b64_tr_b16 v[140:141], v159 offset:32768
    v_mfma_f32_16x16x32_bf16 a[76:79], v[28:31], v[96:99], a[76:79]
    ds_read_b64_tr_b16 v[142:143], v159 offset:34816
    v_mfma_f32_16x16x32_bf16 a[80:83], v[16:19], v[100:103], a[80:83]
    v_mfma_f32_16x16x32_bf16 a[84:87], v[20:23], v[100:103], a[84:87]
    v_mfma_f32_16x16x32_bf16 a[88:91], v[24:27], v[100:103], a[88:91]
    s_add_u32 m0, s71, 40960
    s_add_u32 s67, s65, s77
    buffer_load_dwordx4 v2, s[12:15], s67 offen lds
    v_mfma_f32_16x16x32_bf16 a[92:95], v[28:31], v[100:103], a[92:95]
    v_mfma_f32_16x16x32_bf16 a[96:99], v[16:19], v[104:107], a[96:99]
    v_mfma_f32_16x16x32_bf16 a[100:103], v[20:23], v[104:107], a[100:103]
    v_mfma_f32_16x16x32_bf16 a[104:107], v[24:27], v[104:107], a[104:107]
    v_mfma_f32_16x16x32_bf16 a[108:111], v[28:31], v[104:107], a[108:111]
    s_add_u32 m0, s71, 43008
    s_add_u32 s67, s65, s78
    buffer_load_dwordx4 v2, s[12:15], s67 offen lds
    s_add_u32 s64, s64, 1024
    s_add_u32 s65, s65, s79
    v_mfma_f32_16x16x32_bf16 a[112:115], v[16:19], v[108:111], a[112:115]
    v_mfma_f32_16x16x32_bf16 a[116:119], v[20:23], v[108:111], a[116:119]
    v_mfma_f32_16x16x32_bf16 a[120:123], v[24:27], v[108:111], a[120:123]
    v_mfma_f32_16x16x32_bf16 a[124:127], v[28:31], v[108:111], a[124:127]
    s_waitcnt vmcnt(6) lgkmcnt(0)
    s_barrier
    v_mfma_f32_16x16x32_bf16 a[0:3], v[48:51], v[112:115], a[0:3]
    ds_read_b128 v[16:19], v3 offset:0
    v_mfma_f32_16x16x32_bf16 a[4:7], v[52:55], v[112:115], a[4:7]
    ds_read_b64_tr_b16 v[80:81], v144 offset:0
    v_mfma_f32_16x16x32_bf16 a[8:11], v[56:59], v[112:115], a[8:11]
    ds_read_b64_tr_b16 v[82:83], v144 offset:2048
    s_add_u32 m0, s70, 65536
    s_add_u32 s67, s64, 0
    buffer_load_dwordx4 v1, s[4:7], s67 offen sc1 lds
    v_mfma_f32_16x16x32_bf16 a[12:15], v[60:63], v[112:115], a[12:15]
    ds_read_b128 v[20:23], v3 offset:1024
    v_mfma_f32_16x16x32_bf16 a[16:19], v[48:51], v[116:119], a[16:19]
    ds_read_b64_tr_b16 v[84:85], v145 offset:0
    v_mfma_f32_16x16x32_bf16 a[20:23], v[52:55], v[116:119], a[20:23]
    ds_read_b64_tr_b16 v[86:87], v145 offset:2048
    v_mfma_f32_16x16x32_bf16 a[24:27], v[56:59], v[116:119], a[24:27]
    ds_read_b128 v[24:27], v3 offset:2048
    v_mfma_f32_16x16x32_bf16 a[28:31], v[60:63], v[116:119], a[28:31]
    ds_read_b64_tr_b16 v[88:89], v146 offset:0
    s_add_u32 m0, s70, 66560
    s_add_u32 s67, s64, 16384
    buffer_load_dwordx4 v1, s[4:7], s67 offen sc1 lds
    v_mfma_f32_16x16x32_bf16 a[32:35], v[48:51], v[120:123], a[32:35]
    ds_read_b64_tr_b16 v[90:91], v146 offset:2048
    v_mfma_f32_16x16x32_bf16 a[36:39], v[52:55], v[120:123], a[36:39]
    ds_read_b128 v[28:31], v3 offset:3072
    v_mfma_f32_16x16x32_bf16 a[40:43], v[56:59], v[120:123], a[40:43]
    ds_read_b64_tr_b16 v[92:93], v147 offset:0
    v_mfma_f32_16x16x32_bf16 a[44:47], v[60:63], v[120:123], a[44:47]
    ds_read_b64_tr_b16 v[94:95], v147 offset:2048
    v_mfma_f32_16x16x32_bf16 a[48:51], v[48:51], v[124:127], a[48:51]
    ds_read_b64_tr_b16 v[96:97], v148 offset:0
    s_add_u32 m0, s71, 65536
    s_mov_b32 s67, s65
    buffer_load_dwordx4 v2, s[12:15], s67 offen lds
    v_mfma_f32_16x16x32_bf16 a[52:55], v[52:55], v[124:127], a[52:55]
    ds_read_b64_tr_b16 v[98:99], v148 offset:2048
    v_mfma_f32_16x16x32_bf16 a[56:59], v[56:59], v[124:127], a[56:59]
    ds_read_b64_tr_b16 v[100:101], v149 offset:0
    v_mfma_f32_16x16x32_bf16 a[60:63], v[60:63], v[124:127], a[60:63]
    ds_read_b64_tr_b16 v[102:103], v149 offset:2048
    v_mfma_f32_16x16x32_bf16 a[64:67], v[48:51], v[128:131], a[64:67]
    ds_read_b64_tr_b16 v[104:105], v150 offset:0
    v_mfma_f32_16x16x32_bf16 a[68:71], v[52:55], v[128:131], a[68:71]
    ds_read_b64_tr_b16 v[106:107], v150 offset:2048
    s_add_u32 m0, s71, 67584
    s_add_u32 s67, s65, s76
    buffer_load_dwordx4 v2, s[12:15], s67 offen lds
    v_mfma_f32_16x16x32_bf16 a[72:75], v[56:59], v[128:131], a[72:75]
    ds_read_b64_tr_b16 v[108:109], v151 offset:0
    v_mfma_f32_16x16x32_bf16 a[76:79], v[60:63], v[128:131], a[76:79]
    ds_read_b64_tr_b16 v[110:111], v151 offset:2048
    v_mfma_f32_16x16x32_bf16 a[80:83], v[48:51], v[132:135], a[80:83]
    v_mfma_f32_16x16x32_bf16 a[84:87], v[52:55], v[132:135], a[84:87]
    v_mfma_f32_16x16x32_bf16 a[88:91], v[56:59], v[132:135], a[88:91]
    s_add_u32 m0, s71, 73728
    s_add_u32 s67, s65, s77
    buffer_load_dwordx4 v2, s[12:15], s67 offen lds
    v_mfma_f32_16x16x32_bf16 a[92:95], v[60:63], v[132:135], a[92:95]
    v_mfma_f32_16x16x32_bf16 a[96:99], v[48:51], v[136:139], a[96:99]
    v_mfma_f32_16x16x32_bf16 a[100:103], v[52:55], v[136:139], a[100:103]
    v_mfma_f32_16x16x32_bf16 a[104:107], v[56:59], v[136:139], a[104:107]
    v_mfma_f32_16x16x32_bf16 a[108:111], v[60:63], v[136:139], a[108:111]
    s_add_u32 m0, s71, 75776
    s_add_u32 s67, s65, s78
    buffer_load_dwordx4 v2, s[12:15], s67 offen lds
    s_add_u32 s64, s64, 1024
    s_add_u32 s65, s65, s79
    v_mfma_f32_16x16x32_bf16 a[112:115], v[48:51], v[140:143], a[112:115]
    v_mfma_f32_16x16x32_bf16 a[116:119], v[52:55], v[140:143], a[116:119]
    v_mfma_f32_16x16x32_bf16 a[120:123], v[56:59], v[140:143], a[120:123]
    v_mfma_f32_16x16x32_bf16 a[124:127], v[60:63], v[140:143], a[124:127]
    s_add_u32 s63, s63, 1
    s_cmp_lt_u32 s63, 3
    s_cbranch_scc1 L_wk_k1
    s_waitcnt vmcnt(6) lgkmcnt(0)
    s_barrier
    v_mfma_f32_16x16x32_bf16 a[0:3], v[16:19], v[80:83], a[0:3]
    ds_read_b128 v[48:51], v3 offset:32768
    v_mfma_f32_16x16x32_bf16 a[4:7], v[20:23], v[80:83], a[4:7]
    ds_read_b64_tr_b16 v[112:113], v144 offset:32768
    v_mfma_f32_16x16x32_bf16 a[8:11], v[24:27], v[80:83], a[8:11]
    ds_read_b64_tr_b16 v[114:115], v144 offset:34816
    s_add_u32 m0, s70, 98304
    s_add_u32 s67, s64, 0
    buffer_load_dwordx4 v1, s[4:7], s67 offen sc1 lds
    v_mfma_f32_16x16x32_bf16 a[12:15], v[28:31], v[80:83], a[12:15]
    ds_read_b128 v[52:55], v3 offset:33792
    v_mfma_f32_16x16x32_bf16 a[16:19], v[16:19], v[84:87], a[16:19]
    ds_read_b64_tr_b16 v[116:117], v145 offset:32768
    v_mfma_f32_16x16x32_bf16 a[20:23], v[20:23], v[84:87], a[20:23]
    ds_read_b64_tr_b16 v[118:119], v145 offset:34816
    v_mfma_f32_16x16x32_bf16 a[24:27], v[24:27], v[84:87], a[24:27]
    ds_read_b128 v[56:59], v3 offset:34816
    v_mfma_f32_16x16x32_bf16 a[28:31], v[28:31], v[84:87], a[28:31]
    ds_read_b64_tr_b16 v[120:121], v146 offset:32768
    s_add_u32 m0, s70, 99328
    s_add_u32 s67, s64, 16384
    buffer_load_dwordx4 v1, s[4:7], s67 offen sc1 lds
    v_mfma_f32_16x16x32_bf16 a[32:35], v[16:19], v[88:91], a[32:35]
    ds_read_b64_tr_b16 v[122:123], v146 offset:34816
    v_mfma_f32_16x16x32_bf16 a[36:39], v[20:23], v[88:91], a[36:39]
    ds_read_b128 v[60:63], v3 offset:35840
    v_mfma_f32_16x16x32_bf16 a[40:43], v[24:27], v[88:91], a[40:43]
    ds_read_b64_tr_b16 v[124:125], v147 offset:32768
    v_mfma_f32_16x16x32_bf16 a[44:47], v[28:31], v[88:91], a[44:47]
    ds_read_b64_tr_b16 v[126:127], v147 offset:34816
    v_mfma_f32_16x16x32_bf16 a[48:51], v[16:19], v[92:95], a[48:51]
    ds_read_b64_tr_b16 v[128:129], v148 offset:32768
    s_add_u32 m0, s71, 98304
    s_mov_b32 s67, s65
    buffer_load_dwordx4 v2, s[12:15], s67 offen lds
    v_mfma_f32_16x16x32_bf16 a[52:55], v[20:23], v[92:95], a[52:55]
    ds_read_b64_tr_b16 v[130:131], v148 offset:34816
    v_mfma_f32_16x16x32_bf16 a[56:59], v[24:27], v[92:95], a[56:59]
    ds_read_b64_tr_b16 v[132:133], v149 offset:32768
    v_mfma_f32_16x16x32_bf16 a[60:63], v[28:31], v[92:95], a[60:63]
    ds_read_b64_tr_b16 v[134:135], v149 offset:34816
    v_mfma_f32_16x16x32_bf16 a[64:67], v[16:19], v[96:99], a[64:67]
    ds_read_b64_tr_b16 v[136:137], v150 offset:32768
    v_mfma_f32_16x16x32_bf16 a[68:71], v[20:23], v[96:99], a[68:71]
    ds_read_b64_tr_b16 v[138:139], v150 offset:34816
    s_add_u32 m0, s71, 100352
    s_add_u32 s67, s65, s76
    buffer_load_dwordx4 v2, s[12:15], s67 offen lds
    v_mfma_f32_16x16x32_bf16 a[72:75], v[24:27], v[96:99], a[72:75]
    ds_read_b64_tr_b16 v[140:141], v151 offset:32768
    v_mfma_f32_16x16x32_bf16 a[76:79], v[28:31], v[96:99], a[76:79]
    ds_read_b64_tr_b16 v[142:143], v151 offset:34816
    v_mfma_f32_16x16x32_bf16 a[80:83], v[16:19], v[100:103], a[80:83]
    v_mfma_f32_16x16x32_bf16 a[84:87], v[20:23], v[100:103], a[84:87]
    v_mfma_f32_16x16x32_bf16 a[88:91], v[24:27], v[100:103], a[88:91]
    s_add_u32 m0, s71, 106496
    s_add_u32 s67, s65, s77
    buffer_load_dwordx4 v2, s[12:15], s67 offen lds
    v_mfma_f32_16x16x32_bf16 a[92:95], v[28:31], v[100:103], a[92:95]
    v_mfma_f32_16x16x32_bf16 a[96:99], v[16:19], v[104:107], a[96:99]
    v_mfma_f32_16x16x32_bf16 a[100:103], v[20:23], v[104:107], a[100:103]
    v_mfma_f32_16x16x32_bf16 a[104:107], v[24:27], v[104:107], a[104:107]
    v_mfma_f32_16x16x32_bf16 a[108:111], v[28:31], v[104:107], a[108:111]
    s_add_u32 m0, s71, 108544
    s_add_u32 s67, s65, s78
    buffer_load_dwordx4 v2, s[12:15], s67 offen lds
    s_add_u32 s64, s64, 1024
    s_add_u32 s65, s65, s79
    v_mfma_f32_16x16x32_bf16 a[112:115], v[16:19], v[108:111], a[112:115]
    v_mfma_f32_16x16x32_bf16 a[116:119], v[20:23], v[108:111], a[116:119]
    v_mfma_f32_16x16x32_bf16 a[120:123], v[24:27], v[108:111], a[120:123]
    v_mfma_f32_16x16x32_bf16 a[124:127], v[28:31], v[108:111], a[124:127]
    s_waitcnt vmcnt(6) lgkmcnt(0)
    s_barrier
    v_mfma_f32_16x16x32_bf16 a[0:3], v[48:51], v[112:115], a[0:3]
    ds_read_b128 v[16:19], v4 offset:0
    v_mfma_f32_16x16x32_bf16 a[4:7], v[52:55], v[112:115], a[4:7]
    ds_read_b64_tr_b16 v[80:81], v152 offset:0
    v_mfma_f32_16x16x32_bf16 a[8:11], v[56:59], v[112:115], a[8:11]
    ds_read_b64_tr_b16 v[82:83], v152 offset:2048
    v_mfma_f32_16x16x32_bf16 a[12:15], v[60:63], v[112:115], a[12:15]
    ds_read_b128 v[20:23], v4 offset:1024
    v_mfma_f32_16x16x32_bf16 a[16:19], v[48:51], v[116:119], a[16:19]
    ds_read_b64_tr_b16 v[84:85], v153 offset:0
    v_mfma_f32_16x16x32_bf16 a[20:23], v[52:55], v[116:119], a[20:23]
    ds_read_b64_tr_b16 v[86:87], v153 offset:2048
    v_mfma_f32_16x16x32_bf16 a[24:27], v[56:59], v[116:119], a[24:27]
    ds_read_b128 v[24:27], v4 offset:2048
    v_mfma_f32_16x16x32_bf16 a[28:31], v[60:63], v[116:119], a[28:31]
    ds_read_b64_tr_b16 v[88:89], v154 offset:0
    v_mfma_f32_16x16x32_bf16 a[32:35], v[48:51], v[120:123], a[32:35]
    ds_read_b64_tr_b16 v[90:91], v154 offset:2048
    v_mfma_f32_16x16x32_bf16 a[36:39], v[52:55], v[120:123], a[36:39]
    ds_read_b128 v[28:31], v4 offset:3072
    v_mfma_f32_16x16x32_bf16 a[40:43], v[56:59], v[120:123], a[40:43]
    ds_read_b64_tr_b16 v[92:93], v155 offset:0
    v_mfma_f32_16x16x32_bf16 a[44:47], v[60:63], v[120:123], a[44:47]
    ds_read_b64_tr_b16 v[94:95], v155 offset:2048
    v_mfma_f32_16x16x32_bf16 a[48:51], v[48:51], v[124:127], a[48:51]
    ds_read_b64_tr_b16 v[96:97], v156 offset:0
    v_mfma_f32_16x16x32_bf16 a[52:55], v[52:55], v[124:127], a[52:55]
    ds_read_b64_tr_b16 v[98:99], v156 offset:2048
    v_mfma_f32_16x16x32_bf16 a[56:59], v[56:59], v[124:127], a[56:59]
    ds_read_b64_tr_b16 v[100:101], v157 offset:0
    v_mfma_f32_16x16x32_bf16 a[60:63], v[60:63], v[124:127], a[60:63]
    ds_read_b64_tr_b16 v[102:103], v157 offset:2048
    v_mfma_f32_16x16x32_bf16 a[64:67], v[48:51], v[128:131], a[64:67]
    ds_read_b64_tr_b16 v[104:105], v158 offset:0
    v_mfma_f32_16x16x32_bf16 a[68:71], v[52:55], v[128:131], a[68:71]
    ds_read_b64_tr_b16 v[106:107], v158 offset:2048
    v_mfma_f32_16x16x32_bf16 a[72:75], v[56:59], v[128:131], a[72:75]
    ds_read_b64_tr_b16 v[108:109], v159 offset:0
    v_mfma_f32_16x16x32_bf16 a[76:79], v[60:63], v[128:131], a[76:79]
    ds_read_b64_tr_b16 v[110:111], v159 offset:2048
    v_mfma_f32_16x16x32_bf16 a[80:83], v[48:51], v[132:135], a[80:83]
    v_mfma_f32_16x16x32_bf16 a[84:87], v[52:55], v[132:135], a[84:87]
    v_mfma_f32_16x16x32_bf16 a[88:91], v[56:59], v[132:135], a[88:91]
    v_mfma_f32_16x16x32_bf16 a[92:95], v[60:63], v[132:135], a[92:95]
    v_mfma_f32_16x16x32_bf16 a[96:99], v[48:51], v[136:139], a[96:99]
    v_mfma_f32_16x16x32_bf16 a[100:103], v[52:55], v[136:139], a[100:103]
    v_mfma_f32_16x16x32_bf16 a[104:107], v[56:59], v[136:139], a[104:107]
    v_mfma_f32_16x16x32_bf16 a[108:111], v[60:63], v[136:139], a[108:111]
    v_mfma_f32_16x16x32_bf16 a[112:115], v[48:51], v[140:143], a[112:115]
    v_mfma_f32_16x16x32_bf16 a[116:119], v[52:55], v[140:143], a[116:119]
    v_mfma_f32_16x16x32_bf16 a[120:123], v[56:59], v[140:143], a[120:123]
    v_mfma_f32_16x16x32_bf16 a[124:127], v[60:63], v[140:143], a[124:127]
    s_waitcnt vmcnt(0) lgkmcnt(0)
    s_barrier
    v_mfma_f32_16x16x32_bf16 a[0:3], v[16:19], v[80:83], a[0:3]
    ds_read_b128 v[48:51], v4 offset:32768
    v_mfma_f32_16x16x32_bf16 a[4:7], v[20:23], v[80:83], a[4:7]
    ds_read_b64_tr_b16 v[112:113], v152 offset:32768
    v_mfma_f32_16x16x32_bf16 a[8:11], v[24:27], v[80:83], a[8:11]
    ds_read_b64_tr_b16 v[114:115], v152 offset:34816
    v_mfma_f32_16x16x32_bf16 a[12:15], v[28:31], v[80:83], a[12:15]
    ds_read_b128 v[52:55], v4 offset:33792
    v_mfma_f32_16x16x32_bf16 a[16:19], v[16:19], v[84:87], a[16:19]
    ds_read_b64_tr_b16 v[116:117], v153 offset:32768
    v_mfma_f32_16x16x32_bf16 a[20:23], v[20:23], v[84:87], a[20:23]
    ds_read_b64_tr_b16 v[118:119], v153 offset:34816
    v_mfma_f32_16x16x32_bf16 a[24:27], v[24:27], v[84:87], a[24:27]
    ds_read_b128 v[56:59], v4 offset:34816
    v_mfma_f32_16x16x32_bf16 a[28:31], v[28:31], v[84:87], a[28:31]
    ds_read_b64_tr_b16 v[120:121], v154 offset:32768
    v_mfma_f32_16x16x32_bf16 a[32:35], v[16:19], v[88:91], a[32:35]
    ds_read_b64_tr_b16 v[122:123], v154 offset:34816
    v_mfma_f32_16x16x32_bf16 a[36:39], v[20:23], v[88:91], a[36:39]
    ds_read_b128 v[60:63], v4 offset:35840
    v_mfma_f32_16x16x32_bf16 a[40:43], v[24:27], v[88:91], a[40:43]
    ds_read_b64_tr_b16 v[124:125], v155 offset:32768
    v_mfma_f32_16x16x32_bf16 a[44:47], v[28:31], v[88:91], a[44:47]
    ds_read_b64_tr_b16 v[126:127], v155 offset:34816
    v_mfma_f32_16x16x32_bf16 a[48:51], v[16:19], v[92:95], a[48:51]
    ds_read_b64_tr_b16 v[128:129], v156 offset:32768
    v_mfma_f32_16x16x32_bf16 a[52:55], v[20:23], v[92:95], a[52:55]
    ds_read_b64_tr_b16 v[130:131], v156 offset:34816
    v_mfma_f32_16x16x32_bf16 a[56:59], v[24:27], v[92:95], a[56:59]
    ds_read_b64_tr_b16 v[132:133], v157 offset:32768
    v_mfma_f32_16x16x32_bf16 a[60:63], v[28:31], v[92:95], a[60:63]
    ds_read_b64_tr_b16 v[134:135], v157 offset:34816
    v_mfma_f32_16x16x32_bf16 a[64:67], v[16:19], v[96:99], a[64:67]
    ds_read_b64_tr_b16 v[136:137], v158 offset:32768
    v_mfma_f32_16x16x32_bf16 a[68:71], v[20:23], v[96:99], a[68:71]
    ds_read_b64_tr_b16 v[138:139], v158 offset:34816
    v_mfma_f32_16x16x32_bf16 a[72:75], v[24:27], v[96:99], a[72:75]
    ds_read_b64_tr_b16 v[140:141], v159 offset:32768
    v_mfma_f32_16x16x32_bf16 a[76:79], v[28:31], v[96:99], a[76:79]
    ds_read_b64_tr_b16 v[142:143], v159 offset:34816
    v_mfma_f32_16x16x32_bf16 a[80:83], v[16:19], v[100:103], a[80:83]
    v_mfma_f32_16x16x32_bf16 a[84:87], v[20:23], v[100:103], a[84:87]
    v_mfma_f32_16x16x32_bf16 a[88:91], v[24:27], v[100:103], a[88:91]
    v_mfma_f32_16x16x32_bf16 a[92:95], v[28:31], v[100:103], a[92:95]
    v_mfma_f32_16x16x32_bf16 a[96:99], v[16:19], v[104:107], a[96:99]
    v_mfma_f32_16x16x32_bf16 a[100:103], v[20:23], v[104:107], a[100:103]
    v_mfma_f32_16x16x32_bf16 a[104:107], v[24:27], v[104:107], a[104:107]
    v_mfma_f32_16x16x32_bf16 a[108:111], v[28:31], v[104:107], a[108:111]
    v_mfma_f32_16x16x32_bf16 a[112:115], v[16:19], v[108:111], a[112:115]
    v_mfma_f32_16x16x32_bf16 a[116:119], v[20:23], v[108:111], a[116:119]
    v_mfma_f32_16x16x32_bf16 a[120:123], v[24:27], v[108:111], a[120:123]
    v_mfma_f32_16x16x32_bf16 a[124:127], v[28:31], v[108:111], a[124:127]
    s_waitcnt lgkmcnt(0)
    v_mfma_f32_16x16x32_bf16 a[0:3], v[48:51], v[112:115], a[0:3]
    v_mfma_f32_16x16x32_bf16 a[4:7], v[52:55], v[112:115], a[4:7]
    v_mfma_f32_16x16x32_bf16 a[8:11], v[56:59], v[112:115], a[8:11]
    v_mfma_f32_16x16x32_bf16 a[12:15], v[60:63], v[112:115], a[12:15]
    v_mfma_f32_16x16x32_bf16 a[16:19], v[48:51], v[116:119], a[16:19]
    v_mfma_f32_16x16x32_bf16 a[20:23], v[52:55], v[116:119], a[20:23]
    v_mfma_f32_16x16x32_bf16 a[24:27], v[56:59], v[116:119], a[24:27]
    v_mfma_f32_16x16x32_bf16 a[28:31], v[60:63], v[116:119], a[28:31]
    v_mfma_f32_16x16x32_bf16 a[32:35], v[48:51], v[120:123], a[32:35]
    v_mfma_f32_16x16x32_bf16 a[36:39], v[52:55], v[120:123], a[36:39]
    v_mfma_f32_16x16x32_bf16 a[40:43], v[56:59], v[120:123], a[40:43]
    v_mfma_f32_16x16x32_bf16 a[44:47], v[60:63], v[120:123], a[44:47]
    v_mfma_f32_16x16x32_bf16 a[48:51], v[48:51], v[124:127], a[48:51]
    v_mfma_f32_16x16x32_bf16 a[52:55], v[52:55], v[124:127], a[52:55]
    v_mfma_f32_16x16x32_bf16 a[56:59], v[56:59], v[124:127], a[56:59]
    v_mfma_f32_16x16x32_bf16 a[60:63], v[60:63], v[124:127], a[60:63]
    v_mfma_f32_16x16x32_bf16 a[64:67], v[48:51], v[128:131], a[64:67]
    v_mfma_f32_16x16x32_bf16 a[68:71], v[52:55], v[128:131], a[68:71]
    v_mfma_f32_16x16x32_bf16 a[72:75], v[56:59], v[128:131], a[72:75]
    v_mfma_f32_16x16x32_bf16 a[76:79], v[60:63], v[128:131], a[76:79]
    v_mfma_f32_16x16x32_bf16 a[80:83], v[48:51], v[132:135], a[80:83]
    v_mfma_f32_16x16x32_bf16 a[84:87], v[52:55], v[132:135], a[84:87]
    v_mfma_f32_16x16x32_bf16 a[88:91], v[56:59], v[132:135], a[88:91]
    v_mfma_f32_16x16x32_bf16 a[92:95], v[60:63], v[132:135], a[92:95]
    v_mfma_f32_16x16x32_bf16 a[96:99], v[48:51], v[136:139], a[96:99]
    v_mfma_f32_16x16x32_bf16 a[100:103], v[52:55], v[136:139], a[100:103]
    v_mfma_f32_16x16x32_bf16 a[104:107], v[56:59], v[136:139], a[104:107]
    v_mfma_f32_16x16x32_bf16 a[108:111], v[60:63], v[136:139], a[108:111]
    v_mfma_f32_16x16x32_bf16 a[112:115], v[48:51], v[140:143], a[112:115]
    v_mfma_f32_16x16x32_bf16 a[116:119], v[52:55], v[140:143], a[116:119]
    v_mfma_f32_16x16x32_bf16 a[120:123], v[56:59], v[140:143], a[120:123]
    v_mfma_f32_16x16x32_bf16 a[124:127], v[60:63], v[140:143], a[124:127]
    v_and_b32 v8, 15, v0
    v_lshrrev_b32 v9, 4, v0
    v_lshlrev_b32 v6, 6, v8
    v_lshl_add_u32 v6, v9, 4, v6
    s_lshr_b32 s67, s60, 1
    s_lshl_b32 s68, s61, 1
    s_add_u32 s67, s67, s68
    s_lshl_b32 s67, s67, 19
    s_and_b32 s68, s62, 15
    s_lshl_b32 s68, s68, 1
    s_and_b32 s69, s60, 1
    s_add_u32 s68, s68, s69
    s_lshl_b32 s68, s68, 13
    s_add_u32 s73, s67, s68
    s_add_u32 s73, s73, 35651584
    v_accvgpr_read_b32 v20, a0
    v_accvgpr_read_b32 v21, a1
    v_accvgpr_read_b32 v22, a2
    v_accvgpr_read_b32 v23, a3
    v_accvgpr_read_b32 v24, a4
    v_accvgpr_read_b32 v25, a5
    v_accvgpr_read_b32 v26, a6
    v_accvgpr_read_b32 v27, a7
    v_cvt_pk_bf16_f32 v16, v20, v21
    v_cvt_pk_bf16_f32 v17, v22, v23
    v_cvt_pk_bf16_f32 v18, v24, v25
    v_cvt_pk_bf16_f32 v19, v26, v27
    s_add_u32 s67, s73, 0
    buffer_store_dwordx4 v[16:19], v6, s[4:7], s67 offen offset:0 sc1
    v_accvgpr_read_b32 v32, a16
    v_accvgpr_read_b32 v33, a17
    v_accvgpr_read_b32 v34, a18
    v_accvgpr_read_b32 v35, a19
    v_accvgpr_read_b32 v36, a20
    v_accvgpr_read_b32 v37, a21
    v_accvgpr_read_b32 v38, a22
    v_accvgpr_read_b32 v39, a23
    v_cvt_pk_bf16_f32 v28, v32, v33
    v_cvt_pk_bf16_f32 v29, v34, v35
    v_cvt_pk_bf16_f32 v30, v36, v37
    v_cvt_pk_bf16_f32 v31, v38, v39
    s_add_u32 s67, s73, 0
    buffer_store_dwordx4 v[28:31], v6, s[4:7], s67 offen offset:1024 sc1
    v_accvgpr_read_b32 v44, a32
    v_accvgpr_read_b32 v45, a33
    v_accvgpr_read_b32 v46, a34
    v_accvgpr_read_b32 v47, a35
    v_accvgpr_read_b32 v48, a36
    v_accvgpr_read_b32 v49, a37
    v_accvgpr_read_b32 v50, a38
    v_accvgpr_read_b32 v51, a39
    v_cvt_pk_bf16_f32 v40, v44, v45
    v_cvt_pk_bf16_f32 v41, v46, v47
    v_cvt_pk_bf16_f32 v42, v48, v49
    v_cvt_pk_bf16_f32 v43, v50, v51
    s_add_u32 s67, s73, 0
    buffer_store_dwordx4 v[40:43], v6, s[4:7], s67 offen offset:2048 sc1
    v_accvgpr_read_b32 v56, a48
    v_accvgpr_read_b32 v57, a49
    v_accvgpr_read_b32 v58, a50
    v_accvgpr_read_b32 v59, a51
    v_accvgpr_read_b32 v60, a52
    v_accvgpr_read_b32 v61, a53
    v_accvgpr_read_b32 v62, a54
    v_accvgpr_read_b32 v63, a55
    v_cvt_pk_bf16_f32 v52, v56, v57
    v_cvt_pk_bf16_f32 v53, v58, v59
    v_cvt_pk_bf16_f32 v54, v60, v61
    v_cvt_pk_bf16_f32 v55, v62, v63
    s_add_u32 s67, s73, 0
    buffer_store_dwordx4 v[52:55], v6, s[4:7], s67 offen offset:3072 sc1
    v_accvgpr_read_b32 v20, a64
    v_accvgpr_read_b32 v21, a65
    v_accvgpr_read_b32 v22, a66
    v_accvgpr_read_b32 v23, a67
    v_accvgpr_read_b32 v24, a68
    v_accvgpr_read_b32 v25, a69
    v_accvgpr_read_b32 v26, a70
    v_accvgpr_read_b32 v27, a71
    v_cvt_pk_bf16_f32 v16, v20, v21
    v_cvt_pk_bf16_f32 v17, v22, v23
    v_cvt_pk_bf16_f32 v18, v24, v25
    v_cvt_pk_bf16_f32 v19, v26, v27
    s_add_u32 s67, s73, 4096
    buffer_store_dwordx4 v[16:19], v6, s[4:7], s67 offen offset:0 sc1
    v_accvgpr_read_b32 v32, a80
    v_accvgpr_read_b32 v33, a81
    v_accvgpr_read_b32 v34, a82
    v_accvgpr_read_b32 v35, a83
    v_accvgpr_read_b32 v36, a84
    v_accvgpr_read_b32 v37, a85
    v_accvgpr_read_b32 v38, a86
    v_accvgpr_read_b32 v39, a87
    v_cvt_pk_bf16_f32 v28, v32, v33
    v_cvt_pk_bf16_f32 v29, v34, v35
    v_cvt_pk_bf16_f32 v30, v36, v37
    v_cvt_pk_bf16_f32 v31, v38, v39
    s_add_u32 s67, s73, 4096
    buffer_store_dwordx4 v[28:31], v6, s[4:7], s67 offen offset:1024 sc1
    v_accvgpr_read_b32 v44, a96
    v_accvgpr_read_b32 v45, a97
    v_accvgpr_read_b32 v46, a98
    v_accvgpr_read_b32 v47, a99
    v_accvgpr_read_b32 v48, a100
    v_accvgpr_read_b32 v49, a101
    v_accvgpr_read_b32 v50, a102
    v_accvgpr_read_b32 v51, a103
    v_cvt_pk_bf16_f32 v40, v44, v45
    v_cvt_pk_bf16_f32 v41, v46, v47
    v_cvt_pk_bf16_f32 v42, v48, v49
    v_cvt_pk_bf16_f32 v43, v50, v51
    s_add_u32 s67, s73, 4096
    buffer_store_dwordx4 v[40:43], v6, s[4:7], s67 offen offset:2048 sc1
    v_accvgpr_read_b32 v56, a112
    v_accvgpr_read_b32 v57, a113
    v_accvgpr_read_b32 v58, a114
    v_accvgpr_read_b32 v59, a115
    v_accvgpr_read_b32 v60, a116
    v_accvgpr_read_b32 v61, a117
    v_accvgpr_read_b32 v62, a118
    v_accvgpr_read_b32 v63, a119
    v_cvt_pk_bf16_f32 v52, v56, v57
    v_cvt_pk_bf16_f32 v53, v58, v59
    v_cvt_pk_bf16_f32 v54, v60, v61
    v_cvt_pk_bf16_f32 v55, v62, v63
    s_add_u32 s67, s73, 4096
    buffer_store_dwordx4 v[52:55], v6, s[4:7], s67 offen offset:3072 sc1
    v_accvgpr_read_b32 v20, a8
    v_accvgpr_read_b32 v21, a9
    v_accvgpr_read_b32 v22, a10
    v_accvgpr_read_b32 v23, a11
    v_accvgpr_read_b32 v24, a12
    v_accvgpr_read_b32 v25, a13
    v_accvgpr_read_b32 v26, a14
    v_accvgpr_read_b32 v27, a15
    v_cvt_pk_bf16_f32 v16, v20, v21
    v_cvt_pk_bf16_f32 v17, v22, v23
    v_cvt_pk_bf16_f32 v18, v24, v25
    v_cvt_pk_bf16_f32 v19, v26, v27
    s_add_u32 s67, s73, 262144
    buffer_store_dwordx4 v[16:19], v6, s[4:7], s67 offen offset:0 sc1
    v_accvgpr_read_b32 v32, a24
    v_accvgpr_read_b32 v33, a25
    v_accvgpr_read_b32 v34, a26
    v_accvgpr_read_b32 v35, a27
    v_accvgpr_read_b32 v36, a28
    v_accvgpr_read_b32 v37, a29
    v_accvgpr_read_b32 v38, a30
    v_accvgpr_read_b32 v39, a31
    v_cvt_pk_bf16_f32 v28, v32, v33
    v_cvt_pk_bf16_f32 v29, v34, v35
    v_cvt_pk_bf16_f32 v30, v36, v37
    v_cvt_pk_bf16_f32 v31, v38, v39
    s_add_u32 s67, s73, 262144
    buffer_store_dwordx4 v[28:31], v6, s[4:7], s67 offen offset:1024 sc1
    v_accvgpr_read_b32 v44, a40
    v_accvgpr_read_b32 v45, a41
    v_accvgpr_read_b32 v46, a42
    v_accvgpr_read_b32 v47, a43
    v_accvgpr_read_b32 v48, a44
    v_accvgpr_read_b32 v49, a45
    v_accvgpr_read_b32 v50, a46
    v_accvgpr_read_b32 v51, a47
    v_cvt_pk_bf16_f32 v40, v44, v45
    v_cvt_pk_bf16_f32 v41, v46, v47
    v_cvt_pk_bf16_f32 v42, v48, v49
    v_cvt_pk_bf16_f32 v43, v50, v51
    s_add_u32 s67, s73, 262144
    buffer_store_dwordx4 v[40:43], v6, s[4:7], s67 offen offset:2048 sc1
    v_accvgpr_read_b32 v56, a56
    v_accvgpr_read_b32 v57, a57
    v_accvgpr_read_b32 v58, a58
    v_accvgpr_read_b32 v59, a59
    v_accvgpr_read_b32 v60, a60
    v_accvgpr_read_b32 v61, a61
    v_accvgpr_read_b32 v62, a62
    v_accvgpr_read_b32 v63, a63
    v_cvt_pk_bf16_f32 v52, v56, v57
    v_cvt_pk_bf16_f32 v53, v58, v59
    v_cvt_pk_bf16_f32 v54, v60, v61
    v_cvt_pk_bf16_f32 v55, v62, v63
    s_add_u32 s67, s73, 262144
    buffer_store_dwordx4 v[52:55], v6, s[4:7], s67 offen offset:3072 sc1
    v_accvgpr_read_b32 v20, a72
    v_accvgpr_read_b32 v21, a73
    v_accvgpr_read_b32 v22, a74
    v_accvgpr_read_b32 v23, a75
    v_accvgpr_read_b32 v24, a76
    v_accvgpr_read_b32 v25, a77
    v_accvgpr_read_b32 v26, a78
    v_accvgpr_read_b32 v27, a79
    v_cvt_pk_bf16_f32 v16, v20, v21
    v_cvt_pk_bf16_f32 v17, v22, v23
    v_cvt_pk_bf16_f32 v18, v24, v25
    v_cvt_pk_bf16_f32 v19, v26, v27
    s_add_u32 s67, s73, 266240
    buffer_store_dwordx4 v[16:19], v6, s[4:7], s67 offen offset:0 sc1
    v_accvgpr_read_b32 v32, a88
    v_accvgpr_read_b32 v33, a89
    v_accvgpr_read_b32 v34, a90
    v_accvgpr_read_b32 v35, a91
    v_accvgpr_read_b32 v36, a92
    v_accvgpr_read_b32 v37, a93
    v_accvgpr_read_b32 v38, a94
    v_accvgpr_read_b32 v39, a95
    v_cvt_pk_bf16_f32 v28, v32, v33
    v_cvt_pk_bf16_f32 v29, v34, v35
    v_cvt_pk_bf16_f32 v30, v36, v37
    v_cvt_pk_bf16_f32 v31, v38, v39
    s_add_u32 s67, s73, 266240
    buffer_store_dwordx4 v[28:31], v6, s[4:7], s67 offen offset:1024 sc1
    v_accvgpr_read_b32 v44, a104
    v_accvgpr_read_b32 v45, a105
    v_accvgpr_read_b32 v46, a106
    v_accvgpr_read_b32 v47, a107
    v_accvgpr_read_b32 v48, a108
    v_accvgpr_read_b32 v49, a109
    v_accvgpr_read_b32 v50, a110
    v_accvgpr_read_b32 v51, a111
    v_cvt_pk_bf16_f32 v40, v44, v45
    v_cvt_pk_bf16_f32 v41, v46, v47
    v_cvt_pk_bf16_f32 v42, v48, v49
    v_cvt_pk_bf16_f32 v43, v50, v51
    s_add_u32 s67, s73, 266240
    buffer_store_dwordx4 v[40:43], v6, s[4:7], s67 offen offset:2048 sc1
    v_accvgpr_read_b32 v56, a120
    v_accvgpr_read_b32 v57, a121
    v_accvgpr_read_b32 v58, a122
    v_accvgpr_read_b32 v59, a123
    v_accvgpr_read_b32 v60, a124
    v_accvgpr_read_b32 v61, a125
    v_accvgpr_read_b32 v62, a126
    v_accvgpr_read_b32 v63, a127
    v_cvt_pk_bf16_f32 v52, v56, v57
    v_cvt_pk_bf16_f32 v53, v58, v59
    v_cvt_pk_bf16_f32 v54, v60, v61
    v_cvt_pk_bf16_f32 v55, v62, v63
    s_add_u32 s67, s73, 266240
    buffer_store_dwordx4 v[52:55], v6, s[4:7], s67 offen offset:3072 sc1
    s_branch L_wk_done
L_wk_epi:
    v_lshlrev_b32 v6, 4, v0
    s_lshr_b32 s67, s60, 1
    s_lshl_b32 s68, s61, 1
    s_add_u32 s67, s67, s68
    s_lshl_b32 s67, s67, 6
    s_mul_i32 s67, s67, s66
    s_and_b32 s68, s62, 15
    s_lshl_b32 s68, s68, 1
    s_and_b32 s69, s60, 1
    s_add_u32 s68, s68, s69
    s_lshl_b32 s68, s68, 12
    s_add_u32 s73, s67, s68
    s_mov_b32 s68, 2097152
    s_cmp_eq_u32 s72, 1
    s_cselect_b32 s68, 18874368, s68
    s_cmp_eq_u32 s72, 3
    s_cselect_b32 s68, 69206016, s68
    s_add_u32 s73, s73, s68
    s_cmp_eq_u32 s72, 3
    s_cbranch_scc1 L_wk_epf
    v_accvgpr_read_b32 v20, a0
    v_accvgpr_read_b32 v22, a1
    v_accvgpr_read_b32 v24, a2
    v_accvgpr_read_b32 v26, a3
    v_accvgpr_read_b32 v21, a16
    v_accvgpr_read_b32 v23, a17
    v_accvgpr_read_b32 v25, a18
    v_accvgpr_read_b32 v27, a19
    v_cvt_pk_bf16_f32 v16, v20, v21
    v_cvt_pk_bf16_f32 v17, v22, v23
    v_cvt_pk_bf16_f32 v18, v24, v25
    v_cvt_pk_bf16_f32 v19, v26, v27
    buffer_store_dwordx4 v[16:19], v6, s[4:7], s73 offen offset:0 sc1
    v_accvgpr_read_b32 v40, a32
    v_accvgpr_read_b32 v42, a33
    v_accvgpr_read_b32 v44, a34
    v_accvgpr_read_b32 v46, a35
    v_accvgpr_read_b32 v41, a48
    v_accvgpr_read_b32 v43, a49
    v_accvgpr_read_b32 v45, a50
    v_accvgpr_read_b32 v47, a51
    v_cvt_pk_bf16_f32 v36, v40, v41
    v_cvt_pk_bf16_f32 v37, v42, v43
    v_cvt_pk_bf16_f32 v38, v44, v45
    v_cvt_pk_bf16_f32 v39, v46, v47
    buffer_store_dwordx4 v[36:39], v6, s[4:7], s73 offen offset:1024 sc1
    v_accvgpr_read_b32 v60, a64
    v_accvgpr_read_b32 v62, a65
    v_accvgpr_read_b32 v64, a66
    v_accvgpr_read_b32 v66, a67
    v_accvgpr_read_b32 v61, a80
    v_accvgpr_read_b32 v63, a81
    v_accvgpr_read_b32 v65, a82
    v_accvgpr_read_b32 v67, a83
    v_cvt_pk_bf16_f32 v56, v60, v61
    v_cvt_pk_bf16_f32 v57, v62, v63
    v_cvt_pk_bf16_f32 v58, v64, v65
    v_cvt_pk_bf16_f32 v59, v66, v67
    buffer_store_dwordx4 v[56:59], v6, s[4:7], s73 offen offset:2048 sc1
    v_accvgpr_read_b32 v80, a96
    v_accvgpr_read_b32 v82, a97
    v_accvgpr_read_b32 v84, a98
    v_accvgpr_read_b32 v86, a99
    v_accvgpr_read_b32 v81, a112
    v_accvgpr_read_b32 v83, a113
    v_accvgpr_read_b32 v85, a114
    v_accvgpr_read_b32 v87, a115
    v_cvt_pk_bf16_f32 v76, v80, v81
    v_cvt_pk_bf16_f32 v77, v82, v83
    v_cvt_pk_bf16_f32 v78, v84, v85
    v_cvt_pk_bf16_f32 v79, v86, v87
    buffer_store_dwordx4 v[76:79], v6, s[4:7], s73 offen offset:3072 sc1
    s_add_u32 s73, s73, s77
    v_accvgpr_read_b32 v20, a4
    v_accvgpr_read_b32 v22, a5
    v_accvgpr_read_b32 v24, a6
    v_accvgpr_read_b32 v26, a7
    v_accvgpr_read_b32 v21, a20
    v_accvgpr_read_b32 v23, a21
    v_accvgpr_read_b32 v25, a22
    v_accvgpr_read_b32 v27, a23
    v_cvt_pk_bf16_f32 v16, v20, v21
    v_cvt_pk_bf16_f32 v17, v22, v23
    v_cvt_pk_bf16_f32 v18, v24, v25
    v_cvt_pk_bf16_f32 v19, v26, v27
    buffer_store_dwordx4 v[16:19], v6, s[4:7], s73 offen offset:0 sc1
    v_accvgpr_read_b32 v40, a36
    v_accvgpr_read_b32 v42, a37
    v_accvgpr_read_b32 v44, a38
    v_accvgpr_read_b32 v46, a39
    v_accvgpr_read_b32 v41, a52
    v_accvgpr_read_b32 v43, a53
    v_accvgpr_read_b32 v45, a54
    v_accvgpr_read_b32 v47, a55
    v_cvt_pk_bf16_f32 v36, v40, v41
    v_cvt_pk_bf16_f32 v37, v42, v43
    v_cvt_pk_bf16_f32 v38, v44, v45
    v_cvt_pk_bf16_f32 v39, v46, v47
    buffer_store_dwordx4 v[36:39], v6, s[4:7], s73 offen offset:1024 sc1
    v_accvgpr_read_b32 v60, a68
    v_accvgpr_read_b32 v62, a69
    v_accvgpr_read_b32 v64, a70
    v_accvgpr_read_b32 v66, a71
    v_accvgpr_read_b32 v61, a84
    v_accvgpr_read_b32 v63, a85
    v_accvgpr_read_b32 v65, a86
    v_accvgpr_read_b32 v67, a87
    v_cvt_pk_bf16_f32 v56, v60, v61
    v_cvt_pk_bf16_f32 v57, v62, v63
    v_cvt_pk_bf16_f32 v58, v64, v65
    v_cvt_pk_bf16_f32 v59, v66, v67
    buffer_store_dwordx4 v[56:59], v6, s[4:7], s73 offen offset:2048 sc1
    v_accvgpr_read_b32 v80, a100
    v_accvgpr_read_b32 v82, a101
    v_accvgpr_read_b32 v84, a102
    v_accvgpr_read_b32 v86, a103
    v_accvgpr_read_b32 v81, a116
    v_accvgpr_read_b32 v83, a117
    v_accvgpr_read_b32 v85, a118
    v_accvgpr_read_b32 v87, a119
    v_cvt_pk_bf16_f32 v76, v80, v81
    v_cvt_pk_bf16_f32 v77, v82, v83
    v_cvt_pk_bf16_f32 v78, v84, v85
    v_cvt_pk_bf16_f32 v79, v86, v87
    buffer_store_dwordx4 v[76:79], v6, s[4:7], s73 offen offset:3072 sc1
    s_add_u32 s73, s73, s77
    v_accvgpr_read_b32 v20, a8
    v_accvgpr_read_b32 v22, a9
    v_accvgpr_read_b32 v24, a10
    v_accvgpr_read_b32 v26, a11
    v_accvgpr_read_b32 v21, a24
    v_accvgpr_read_b32 v23, a25
    v_accvgpr_read_b32 v25, a26
    v_accvgpr_read_b32 v27, a27
    v_cvt_pk_bf16_f32 v16, v20, v21
    v_cvt_pk_bf16_f32 v17, v22, v23
    v_cvt_pk_bf16_f32 v18, v24, v25
    v_cvt_pk_bf16_f32 v19, v26, v27
    buffer_store_dwordx4 v[16:19], v6, s[4:7], s73 offen offset:0 sc1
    v_accvgpr_read_b32 v40, a40
    v_accvgpr_read_b32 v42, a41
    v_accvgpr_read_b32 v44, a42
    v_accvgpr_read_b32 v46, a43
    v_accvgpr_read_b32 v41, a56
    v_accvgpr_read_b32 v43, a57
    v_accvgpr_read_b32 v45, a58
    v_accvgpr_read_b32 v47, a59
    v_cvt_pk_bf16_f32 v36, v40, v41
    v_cvt_pk_bf16_f32 v37, v42, v43
    v_cvt_pk_bf16_f32 v38, v44, v45
    v_cvt_pk_bf16_f32 v39, v46, v47
    buffer_store_dwordx4 v[36:39], v6, s[4:7], s73 offen offset:1024 sc1
    v_accvgpr_read_b32 v60, a72
    v_accvgpr_read_b32 v62, a73
    v_accvgpr_read_b32 v64, a74
    v_accvgpr_read_b32 v66, a75
    v_accvgpr_read_b32 v61, a88
    v_accvgpr_read_b32 v63, a89
    v_accvgpr_read_b32 v65, a90
    v_accvgpr_read_b32 v67, a91
    v_cvt_pk_bf16_f32 v56, v60, v61
    v_cvt_pk_bf16_f32 v57, v62, v63
    v_cvt_pk_bf16_f32 v58, v64, v65
    v_cvt_pk_bf16_f32 v59, v66, v67
    buffer_store_dwordx4 v[56:59], v6, s[4:7], s73 offen offset:2048 sc1
    v_accvgpr_read_b32 v80, a104
    v_accvgpr_read_b32 v82, a105
    v_accvgpr_read_b32 v84, a106
    v_accvgpr_read_b32 v86, a107
    v_accvgpr_read_b32 v81, a120
    v_accvgpr_read_b32 v83, a121
    v_accvgpr_read_b32 v85, a122
    v_accvgpr_read_b32 v87, a123
    v_cvt_pk_bf16_f32 v76, v80, v81
    v_cvt_pk_bf16_f32 v77, v82, v83
    v_cvt_pk_bf16_f32 v78, v84, v85
    v_cvt_pk_bf16_f32 v79, v86, v87
    buffer_store_dwordx4 v[76:79], v6, s[4:7], s73 offen offset:3072 sc1
    s_add_u32 s73, s73, s77
    v_accvgpr_read_b32 v20, a12
    v_accvgpr_read_b32 v22, a13
    v_accvgpr_read_b32 v24, a14
    v_accvgpr_read_b32 v26, a15
    v_accvgpr_read_b32 v21, a28
    v_accvgpr_read_b32 v23, a29
    v_accvgpr_read_b32 v25, a30
    v_accvgpr_read_b32 v27, a31
    v_cvt_pk_bf16_f32 v16, v20, v21
    v_cvt_pk_bf16_f32 v17, v22, v23
    v_cvt_pk_bf16_f32 v18, v24, v25
    v_cvt_pk_bf16_f32 v19, v26, v27
    buffer_store_dwordx4 v[16:19], v6, s[4:7], s73 offen offset:0 sc1
    v_accvgpr_read_b32 v40, a44
    v_accvgpr_read_b32 v42, a45
    v_accvgpr_read_b32 v44, a46
    v_accvgpr_read_b32 v46, a47
    v_accvgpr_read_b32 v41, a60
    v_accvgpr_read_b32 v43, a61
    v_accvgpr_read_b32 v45, a62
    v_accvgpr_read_b32 v47, a63
    v_cvt_pk_bf16_f32 v36, v40, v41
    v_cvt_pk_bf16_f32 v37, v42, v43
    v_cvt_pk_bf16_f32 v38, v44, v45
    v_cvt_pk_bf16_f32 v39, v46, v47
    buffer_store_dwordx4 v[36:39], v6, s[4:7], s73 offen offset:1024 sc1
    v_accvgpr_read_b32 v60, a76
    v_accvgpr_read_b32 v62, a77
    v_accvgpr_read_b32 v64, a78
    v_accvgpr_read_b32 v66, a79
    v_accvgpr_read_b32 v61, a92
    v_accvgpr_read_b32 v63, a93
    v_accvgpr_read_b32 v65, a94
    v_accvgpr_read_b32 v67, a95
    v_cvt_pk_bf16_f32 v56, v60, v61
    v_cvt_pk_bf16_f32 v57, v62, v63
    v_cvt_pk_bf16_f32 v58, v64, v65
    v_cvt_pk_bf16_f32 v59, v66, v67
    buffer_store_dwordx4 v[56:59], v6, s[4:7], s73 offen offset:2048 sc1
    v_accvgpr_read_b32 v80, a108
    v_accvgpr_read_b32 v82, a109
    v_accvgpr_read_b32 v84, a110
    v_accvgpr_read_b32 v86, a111
    v_accvgpr_read_b32 v81, a124
    v_accvgpr_read_b32 v83, a125
    v_accvgpr_read_b32 v85, a126
    v_accvgpr_read_b32 v87, a127
    v_cvt_pk_bf16_f32 v76, v80, v81
    v_cvt_pk_bf16_f32 v77, v82, v83
    v_cvt_pk_bf16_f32 v78, v84, v85
    v_cvt_pk_bf16_f32 v79, v86, v87
    buffer_store_dwordx4 v[76:79], v6, s[4:7], s73 offen offset:3072 sc1
    s_add_u32 s73, s73, s77
    s_branch L_wk_done
L_wk_epf:
    v_accvgpr_read_b32 v20, a0
    v_accvgpr_read_b32 v22, a1
    v_accvgpr_read_b32 v24, a2
    v_accvgpr_read_b32 v26, a3
    v_accvgpr_read_b32 v21, a16
    v_accvgpr_read_b32 v23, a17
    v_accvgpr_read_b32 v25, a18
    v_accvgpr_read_b32 v27, a19
    v_cvt_pk_bf16_f32 v16, v20, v21
    v_cvt_pk_bf16_f32 v17, v22, v23
    v_cvt_pk_bf16_f32 v18, v24, v25
    v_cvt_pk_bf16_f32 v19, v26, v27
    v_lshlrev_b32 v20, 16, v16
    v_and_b32 v21, 0xffff0000, v16
    v_lshlrev_b32 v22, 16, v17
    v_and_b32 v23, 0xffff0000, v17
    v_lshlrev_b32 v24, 16, v18
    v_and_b32 v25, 0xffff0000, v18
    v_lshlrev_b32 v26, 16, v19
    v_and_b32 v27, 0xffff0000, v19
    v_mul_f32 v28, 3216550459, v20
    v_mul_f32 v29, 3216550459, v21
    v_mul_f32 v30, 3216550459, v22
    v_mul_f32 v31, 3216550459, v23
    v_mul_f32 v32, 3216550459, v24
    v_mul_f32 v33, 3216550459, v25
    v_mul_f32 v34, 3216550459, v26
    v_mul_f32 v35, 3216550459, v27
    v_exp_f32 v28, v28
    v_exp_f32 v29, v29
    v_exp_f32 v30, v30
    v_exp_f32 v31, v31
    v_exp_f32 v32, v32
    v_exp_f32 v33, v33
    v_exp_f32 v34, v34
    v_exp_f32 v35, v35
    v_add_f32 v28, 1.0, v28
    v_add_f32 v29, 1.0, v29
    v_add_f32 v30, 1.0, v30
    v_add_f32 v31, 1.0, v31
    v_add_f32 v32, 1.0, v32
    v_add_f32 v33, 1.0, v33
    v_add_f32 v34, 1.0, v34
    v_add_f32 v35, 1.0, v35
    v_rcp_f32 v28, v28
    v_rcp_f32 v29, v29
    v_rcp_f32 v30, v30
    v_rcp_f32 v31, v31
    v_rcp_f32 v32, v32
    v_rcp_f32 v33, v33
    v_rcp_f32 v34, v34
    v_rcp_f32 v35, v35
    v_mul_f32 v20, v20, v28
    v_mul_f32 v21, v21, v29
    v_mul_f32 v22, v22, v30
    v_mul_f32 v23, v23, v31
    v_mul_f32 v24, v24, v32
    v_mul_f32 v25, v25, v33
    v_mul_f32 v26, v26, v34
    v_mul_f32 v27, v27, v35
    v_cvt_pk_bf16_f32 v16, v20, v21
    v_cvt_pk_bf16_f32 v17, v22, v23
    v_cvt_pk_bf16_f32 v18, v24, v25
    v_cvt_pk_bf16_f32 v19, v26, v27
    buffer_store_dwordx4 v[16:19], v6, s[4:7], s73 offen offset:0 sc1
    v_accvgpr_read_b32 v40, a32
    v_accvgpr_read_b32 v42, a33
    v_accvgpr_read_b32 v44, a34
    v_accvgpr_read_b32 v46, a35
    v_accvgpr_read_b32 v41, a48
    v_accvgpr_read_b32 v43, a49
    v_accvgpr_read_b32 v45, a50
    v_accvgpr_read_b32 v47, a51
    v_cvt_pk_bf16_f32 v36, v40, v41
    v_cvt_pk_bf16_f32 v37, v42, v43
    v_cvt_pk_bf16_f32 v38, v44, v45
    v_cvt_pk_bf16_f32 v39, v46, v47
    v_lshlrev_b32 v40, 16, v36
    v_and_b32 v41, 0xffff0000, v36
    v_lshlrev_b32 v42, 16, v37
    v_and_b32 v43, 0xffff0000, v37
    v_lshlrev_b32 v44, 16, v38
    v_and_b32 v45, 0xffff0000, v38
    v_lshlrev_b32 v46, 16, v39
    v_and_b32 v47, 0xffff0000, v39
    v_mul_f32 v48, 3216550459, v40
    v_mul_f32 v49, 3216550459, v41
    v_mul_f32 v50, 3216550459, v42
    v_mul_f32 v51, 3216550459, v43
    v_mul_f32 v52, 3216550459, v44
    v_mul_f32 v53, 3216550459, v45
    v_mul_f32 v54, 3216550459, v46
    v_mul_f32 v55, 3216550459, v47
    v_exp_f32 v48, v48
    v_exp_f32 v49, v49
    v_exp_f32 v50, v50
    v_exp_f32 v51, v51
    v_exp_f32 v52, v52
    v_exp_f32 v53, v53
    v_exp_f32 v54, v54
    v_exp_f32 v55, v55
    v_add_f32 v48, 1.0, v48
    v_add_f32 v49, 1.0, v49
    v_add_f32 v50, 1.0, v50
    v_add_f32 v51, 1.0, v51
    v_add_f32 v52, 1.0, v52
    v_add_f32 v53, 1.0, v53
    v_add_f32 v54, 1.0, v54
    v_add_f32 v55, 1.0, v55
    v_rcp_f32 v48, v48
    v_rcp_f32 v49, v49
    v_rcp_f32 v50, v50
    v_rcp_f32 v51, v51
    v_rcp_f32 v52, v52
    v_rcp_f32 v53, v53
    v_rcp_f32 v54, v54
    v_rcp_f32 v55, v55
    v_mul_f32 v40, v40, v48
    v_mul_f32 v41, v41, v49
    v_mul_f32 v42, v42, v50
    v_mul_f32 v43, v43, v51
    v_mul_f32 v44, v44, v52
    v_mul_f32 v45, v45, v53
    v_mul_f32 v46, v46, v54
    v_mul_f32 v47, v47, v55
    v_cvt_pk_bf16_f32 v36, v40, v41
    v_cvt_pk_bf16_f32 v37, v42, v43
    v_cvt_pk_bf16_f32 v38, v44, v45
    v_cvt_pk_bf16_f32 v39, v46, v47
    buffer_store_dwordx4 v[36:39], v6, s[4:7], s73 offen offset:1024 sc1
    v_accvgpr_read_b32 v60, a64
    v_accvgpr_read_b32 v62, a65
    v_accvgpr_read_b32 v64, a66
    v_accvgpr_read_b32 v66, a67
    v_accvgpr_read_b32 v61, a80
    v_accvgpr_read_b32 v63, a81
    v_accvgpr_read_b32 v65, a82
    v_accvgpr_read_b32 v67, a83
    v_cvt_pk_bf16_f32 v56, v60, v61
    v_cvt_pk_bf16_f32 v57, v62, v63
    v_cvt_pk_bf16_f32 v58, v64, v65
    v_cvt_pk_bf16_f32 v59, v66, v67
    v_lshlrev_b32 v60, 16, v56
    v_and_b32 v61, 0xffff0000, v56
    v_lshlrev_b32 v62, 16, v57
    v_and_b32 v63, 0xffff0000, v57
    v_lshlrev_b32 v64, 16, v58
    v_and_b32 v65, 0xffff0000, v58
    v_lshlrev_b32 v66, 16, v59
    v_and_b32 v67, 0xffff0000, v59
    v_mul_f32 v68, 3216550459, v60
    v_mul_f32 v69, 3216550459, v61
    v_mul_f32 v70, 3216550459, v62
    v_mul_f32 v71, 3216550459, v63
    v_mul_f32 v72, 3216550459, v64
    v_mul_f32 v73, 3216550459, v65
    v_mul_f32 v74, 3216550459, v66
    v_mul_f32 v75, 3216550459, v67
    v_exp_f32 v68, v68
    v_exp_f32 v69, v69
    v_exp_f32 v70, v70
    v_exp_f32 v71, v71
    v_exp_f32 v72, v72
    v_exp_f32 v73, v73
    v_exp_f32 v74, v74
    v_exp_f32 v75, v75
    v_add_f32 v68, 1.0, v68
    v_add_f32 v69, 1.0, v69
    v_add_f32 v70, 1.0, v70
    v_add_f32 v71, 1.0, v71
    v_add_f32 v72, 1.0, v72
    v_add_f32 v73, 1.0, v73
    v_add_f32 v74, 1.0, v74
    v_add_f32 v75, 1.0, v75
    v_rcp_f32 v68, v68
    v_rcp_f32 v69, v69
    v_rcp_f32 v70, v70
    v_rcp_f32 v71, v71
    v_rcp_f32 v72, v72
    v_rcp_f32 v73, v73
    v_rcp_f32 v74, v74
    v_rcp_f32 v75, v75
    v_mul_f32 v60, v60, v68
    v_mul_f32 v61, v61, v69
    v_mul_f32 v62, v62, v70
    v_mul_f32 v63, v63, v71
    v_mul_f32 v64, v64, v72
    v_mul_f32 v65, v65, v73
    v_mul_f32 v66, v66, v74
    v_mul_f32 v67, v67, v75
    v_cvt_pk_bf16_f32 v56, v60, v61
    v_cvt_pk_bf16_f32 v57, v62, v63
    v_cvt_pk_bf16_f32 v58, v64, v65
    v_cvt_pk_bf16_f32 v59, v66, v67
    buffer_store_dwordx4 v[56:59], v6, s[4:7], s73 offen offset:2048 sc1
    v_accvgpr_read_b32 v80, a96
    v_accvgpr_read_b32 v82, a97
    v_accvgpr_read_b32 v84, a98
    v_accvgpr_read_b32 v86, a99
    v_accvgpr_read_b32 v81, a112
    v_accvgpr_read_b32 v83, a113
    v_accvgpr_read_b32 v85, a114
    v_accvgpr_read_b32 v87, a115
    v_cvt_pk_bf16_f32 v76, v80, v81
    v_cvt_pk_bf16_f32 v77, v82, v83
    v_cvt_pk_bf16_f32 v78, v84, v85
    v_cvt_pk_bf16_f32 v79, v86, v87
    v_lshlrev_b32 v80, 16, v76
    v_and_b32 v81, 0xffff0000, v76
    v_lshlrev_b32 v82, 16, v77
    v_and_b32 v83, 0xffff0000, v77
    v_lshlrev_b32 v84, 16, v78
    v_and_b32 v85, 0xffff0000, v78
    v_lshlrev_b32 v86, 16, v79
    v_and_b32 v87, 0xffff0000, v79
    v_mul_f32 v88, 3216550459, v80
    v_mul_f32 v89, 3216550459, v81
    v_mul_f32 v90, 3216550459, v82
    v_mul_f32 v91, 3216550459, v83
    v_mul_f32 v92, 3216550459, v84
    v_mul_f32 v93, 3216550459, v85
    v_mul_f32 v94, 3216550459, v86
    v_mul_f32 v95, 3216550459, v87
    v_exp_f32 v88, v88
    v_exp_f32 v89, v89
    v_exp_f32 v90, v90
    v_exp_f32 v91, v91
    v_exp_f32 v92, v92
    v_exp_f32 v93, v93
    v_exp_f32 v94, v94
    v_exp_f32 v95, v95
    v_add_f32 v88, 1.0, v88
    v_add_f32 v89, 1.0, v89
    v_add_f32 v90, 1.0, v90
    v_add_f32 v91, 1.0, v91
    v_add_f32 v92, 1.0, v92
    v_add_f32 v93, 1.0, v93
    v_add_f32 v94, 1.0, v94
    v_add_f32 v95, 1.0, v95
    v_rcp_f32 v88, v88
    v_rcp_f32 v89, v89
    v_rcp_f32 v90, v90
    v_rcp_f32 v91, v91
    v_rcp_f32 v92, v92
    v_rcp_f32 v93, v93
    v_rcp_f32 v94, v94
    v_rcp_f32 v95, v95
    v_mul_f32 v80, v80, v88
    v_mul_f32 v81, v81, v89
    v_mul_f32 v82, v82, v90
    v_mul_f32 v83, v83, v91
    v_mul_f32 v84, v84, v92
    v_mul_f32 v85, v85, v93
    v_mul_f32 v86, v86, v94
    v_mul_f32 v87, v87, v95
    v_cvt_pk_bf16_f32 v76, v80, v81
    v_cvt_pk_bf16_f32 v77, v82, v83
    v_cvt_pk_bf16_f32 v78, v84, v85
    v_cvt_pk_bf16_f32 v79, v86, v87
    buffer_store_dwordx4 v[76:79], v6, s[4:7], s73 offen offset:3072 sc1
    s_add_u32 s73, s73, s77
    v_accvgpr_read_b32 v20, a4
    v_accvgpr_read_b32 v22, a5
    v_accvgpr_read_b32 v24, a6
    v_accvgpr_read_b32 v26, a7
    v_accvgpr_read_b32 v21, a20
    v_accvgpr_read_b32 v23, a21
    v_accvgpr_read_b32 v25, a22
    v_accvgpr_read_b32 v27, a23
    v_cvt_pk_bf16_f32 v16, v20, v21
    v_cvt_pk_bf16_f32 v17, v22, v23
    v_cvt_pk_bf16_f32 v18, v24, v25
    v_cvt_pk_bf16_f32 v19, v26, v27
    v_lshlrev_b32 v20, 16, v16
    v_and_b32 v21, 0xffff0000, v16
    v_lshlrev_b32 v22, 16, v17
    v_and_b32 v23, 0xffff0000, v17
    v_lshlrev_b32 v24, 16, v18
    v_and_b32 v25, 0xffff0000, v18
    v_lshlrev_b32 v26, 16, v19
    v_and_b32 v27, 0xffff0000, v19
    v_mul_f32 v28, 3216550459, v20
    v_mul_f32 v29, 3216550459, v21
    v_mul_f32 v30, 3216550459, v22
    v_mul_f32 v31, 3216550459, v23
    v_mul_f32 v32, 3216550459, v24
    v_mul_f32 v33, 3216550459, v25
    v_mul_f32 v34, 3216550459, v26
    v_mul_f32 v35, 3216550459, v27
    v_exp_f32 v28, v28
    v_exp_f32 v29, v29
    v_exp_f32 v30, v30
    v_exp_f32 v31, v31
    v_exp_f32 v32, v32
    v_exp_f32 v33, v33
    v_exp_f32 v34, v34
    v_exp_f32 v35, v35
    v_add_f32 v28, 1.0, v28
    v_add_f32 v29, 1.0, v29
    v_add_f32 v30, 1.0, v30
    v_add_f32 v31, 1.0, v31
    v_add_f32 v32, 1.0, v32
    v_add_f32 v33, 1.0, v33
    v_add_f32 v34, 1.0, v34
    v_add_f32 v35, 1.0, v35
    v_rcp_f32 v28, v28
    v_rcp_f32 v29, v29
    v_rcp_f32 v30, v30
    v_rcp_f32 v31, v31
    v_rcp_f32 v32, v32
    v_rcp_f32 v33, v33
    v_rcp_f32 v34, v34
    v_rcp_f32 v35, v35
    v_mul_f32 v20, v20, v28
    v_mul_f32 v21, v21, v29
    v_mul_f32 v22, v22, v30
    v_mul_f32 v23, v23, v31
    v_mul_f32 v24, v24, v32
    v_mul_f32 v25, v25, v33
    v_mul_f32 v26, v26, v34
    v_mul_f32 v27, v27, v35
    v_cvt_pk_bf16_f32 v16, v20, v21
    v_cvt_pk_bf16_f32 v17, v22, v23
    v_cvt_pk_bf16_f32 v18, v24, v25
    v_cvt_pk_bf16_f32 v19, v26, v27
    buffer_store_dwordx4 v[16:19], v6, s[4:7], s73 offen offset:0 sc1
    v_accvgpr_read_b32 v40, a36
    v_accvgpr_read_b32 v42, a37
    v_accvgpr_read_b32 v44, a38
    v_accvgpr_read_b32 v46, a39
    v_accvgpr_read_b32 v41, a52
    v_accvgpr_read_b32 v43, a53
    v_accvgpr_read_b32 v45, a54
    v_accvgpr_read_b32 v47, a55
    v_cvt_pk_bf16_f32 v36, v40, v41
    v_cvt_pk_bf16_f32 v37, v42, v43
    v_cvt_pk_bf16_f32 v38, v44, v45
    v_cvt_pk_bf16_f32 v39, v46, v47
    v_lshlrev_b32 v40, 16, v36
    v_and_b32 v41, 0xffff0000, v36
    v_lshlrev_b32 v42, 16, v37
    v_and_b32 v43, 0xffff0000, v37
    v_lshlrev_b32 v44, 16, v38
    v_and_b32 v45, 0xffff0000, v38
    v_lshlrev_b32 v46, 16, v39
    v_and_b32 v47, 0xffff0000, v39
    v_mul_f32 v48, 3216550459, v40
    v_mul_f32 v49, 3216550459, v41
    v_mul_f32 v50, 3216550459, v42
    v_mul_f32 v51, 3216550459, v43
    v_mul_f32 v52, 3216550459, v44
    v_mul_f32 v53, 3216550459, v45
    v_mul_f32 v54, 3216550459, v46
    v_mul_f32 v55, 3216550459, v47
    v_exp_f32 v48, v48
    v_exp_f32 v49, v49
    v_exp_f32 v50, v50
    v_exp_f32 v51, v51
    v_exp_f32 v52, v52
    v_exp_f32 v53, v53
    v_exp_f32 v54, v54
    v_exp_f32 v55, v55
    v_add_f32 v48, 1.0, v48
    v_add_f32 v49, 1.0, v49
    v_add_f32 v50, 1.0, v50
    v_add_f32 v51, 1.0, v51
    v_add_f32 v52, 1.0, v52
    v_add_f32 v53, 1.0, v53
    v_add_f32 v54, 1.0, v54
    v_add_f32 v55, 1.0, v55
    v_rcp_f32 v48, v48
    v_rcp_f32 v49, v49
    v_rcp_f32 v50, v50
    v_rcp_f32 v51, v51
    v_rcp_f32 v52, v52
    v_rcp_f32 v53, v53
    v_rcp_f32 v54, v54
    v_rcp_f32 v55, v55
    v_mul_f32 v40, v40, v48
    v_mul_f32 v41, v41, v49
    v_mul_f32 v42, v42, v50
    v_mul_f32 v43, v43, v51
    v_mul_f32 v44, v44, v52
    v_mul_f32 v45, v45, v53
    v_mul_f32 v46, v46, v54
    v_mul_f32 v47, v47, v55
    v_cvt_pk_bf16_f32 v36, v40, v41
    v_cvt_pk_bf16_f32 v37, v42, v43
    v_cvt_pk_bf16_f32 v38, v44, v45
    v_cvt_pk_bf16_f32 v39, v46, v47
    buffer_store_dwordx4 v[36:39], v6, s[4:7], s73 offen offset:1024 sc1
    v_accvgpr_read_b32 v60, a68
    v_accvgpr_read_b32 v62, a69
    v_accvgpr_read_b32 v64, a70
    v_accvgpr_read_b32 v66, a71
    v_accvgpr_read_b32 v61, a84
    v_accvgpr_read_b32 v63, a85
    v_accvgpr_read_b32 v65, a86
    v_accvgpr_read_b32 v67, a87
    v_cvt_pk_bf16_f32 v56, v60, v61
    v_cvt_pk_bf16_f32 v57, v62, v63
    v_cvt_pk_bf16_f32 v58, v64, v65
    v_cvt_pk_bf16_f32 v59, v66, v67
    v_lshlrev_b32 v60, 16, v56
    v_and_b32 v61, 0xffff0000, v56
    v_lshlrev_b32 v62, 16, v57
    v_and_b32 v63, 0xffff0000, v57
    v_lshlrev_b32 v64, 16, v58
    v_and_b32 v65, 0xffff0000, v58
    v_lshlrev_b32 v66, 16, v59
    v_and_b32 v67, 0xffff0000, v59
    v_mul_f32 v68, 3216550459, v60
    v_mul_f32 v69, 3216550459, v61
    v_mul_f32 v70, 3216550459, v62
    v_mul_f32 v71, 3216550459, v63
    v_mul_f32 v72, 3216550459, v64
    v_mul_f32 v73, 3216550459, v65
    v_mul_f32 v74, 3216550459, v66
    v_mul_f32 v75, 3216550459, v67
    v_exp_f32 v68, v68
    v_exp_f32 v69, v69
    v_exp_f32 v70, v70
    v_exp_f32 v71, v71
    v_exp_f32 v72, v72
    v_exp_f32 v73, v73
    v_exp_f32 v74, v74
    v_exp_f32 v75, v75
    v_add_f32 v68, 1.0, v68
    v_add_f32 v69, 1.0, v69
    v_add_f32 v70, 1.0, v70
    v_add_f32 v71, 1.0, v71
    v_add_f32 v72, 1.0, v72
    v_add_f32 v73, 1.0, v73
    v_add_f32 v74, 1.0, v74
    v_add_f32 v75, 1.0, v75
    v_rcp_f32 v68, v68
    v_rcp_f32 v69, v69
    v_rcp_f32 v70, v70
    v_rcp_f32 v71, v71
    v_rcp_f32 v72, v72
    v_rcp_f32 v73, v73
    v_rcp_f32 v74, v74
    v_rcp_f32 v75, v75
    v_mul_f32 v60, v60, v68
    v_mul_f32 v61, v61, v69
    v_mul_f32 v62, v62, v70
    v_mul_f32 v63, v63, v71
    v_mul_f32 v64, v64, v72
    v_mul_f32 v65, v65, v73
    v_mul_f32 v66, v66, v74
    v_mul_f32 v67, v67, v75
    v_cvt_pk_bf16_f32 v56, v60, v61
    v_cvt_pk_bf16_f32 v57, v62, v63
    v_cvt_pk_bf16_f32 v58, v64, v65
    v_cvt_pk_bf16_f32 v59, v66, v67
    buffer_store_dwordx4 v[56:59], v6, s[4:7], s73 offen offset:2048 sc1
    v_accvgpr_read_b32 v80, a100
    v_accvgpr_read_b32 v82, a101
    v_accvgpr_read_b32 v84, a102
    v_accvgpr_read_b32 v86, a103
    v_accvgpr_read_b32 v81, a116
    v_accvgpr_read_b32 v83, a117
    v_accvgpr_read_b32 v85, a118
    v_accvgpr_read_b32 v87, a119
    v_cvt_pk_bf16_f32 v76, v80, v81
    v_cvt_pk_bf16_f32 v77, v82, v83
    v_cvt_pk_bf16_f32 v78, v84, v85
    v_cvt_pk_bf16_f32 v79, v86, v87
    v_lshlrev_b32 v80, 16, v76
    v_and_b32 v81, 0xffff0000, v76
    v_lshlrev_b32 v82, 16, v77
    v_and_b32 v83, 0xffff0000, v77
    v_lshlrev_b32 v84, 16, v78
    v_and_b32 v85, 0xffff0000, v78
    v_lshlrev_b32 v86, 16, v79
    v_and_b32 v87, 0xffff0000, v79
    v_mul_f32 v88, 3216550459, v80
    v_mul_f32 v89, 3216550459, v81
    v_mul_f32 v90, 3216550459, v82
    v_mul_f32 v91, 3216550459, v83
    v_mul_f32 v92, 3216550459, v84
    v_mul_f32 v93, 3216550459, v85
    v_mul_f32 v94, 3216550459, v86
    v_mul_f32 v95, 3216550459, v87
    v_exp_f32 v88, v88
    v_exp_f32 v89, v89
    v_exp_f32 v90, v90
    v_exp_f32 v91, v91
    v_exp_f32 v92, v92
    v_exp_f32 v93, v93
    v_exp_f32 v94, v94
    v_exp_f32 v95, v95
    v_add_f32 v88, 1.0, v88
    v_add_f32 v89, 1.0, v89
    v_add_f32 v90, 1.0, v90
    v_add_f32 v91, 1.0, v91
    v_add_f32 v92, 1.0, v92
    v_add_f32 v93, 1.0, v93
    v_add_f32 v94, 1.0, v94
    v_add_f32 v95, 1.0, v95
    v_rcp_f32 v88, v88
    v_rcp_f32 v89, v89
    v_rcp_f32 v90, v90
    v_rcp_f32 v91, v91
    v_rcp_f32 v92, v92
    v_rcp_f32 v93, v93
    v_rcp_f32 v94, v94
    v_rcp_f32 v95, v95
    v_mul_f32 v80, v80, v88
    v_mul_f32 v81, v81, v89
    v_mul_f32 v82, v82, v90
    v_mul_f32 v83, v83, v91
    v_mul_f32 v84, v84, v92
    v_mul_f32 v85, v85, v93
    v_mul_f32 v86, v86, v94
    v_mul_f32 v87, v87, v95
    v_cvt_pk_bf16_f32 v76, v80, v81
    v_cvt_pk_bf16_f32 v77, v82, v83
    v_cvt_pk_bf16_f32 v78, v84, v85
    v_cvt_pk_bf16_f32 v79, v86, v87
    buffer_store_dwordx4 v[76:79], v6, s[4:7], s73 offen offset:3072 sc1
    s_add_u32 s73, s73, s77
    v_accvgpr_read_b32 v20, a8
    v_accvgpr_read_b32 v22, a9
    v_accvgpr_read_b32 v24, a10
    v_accvgpr_read_b32 v26, a11
    v_accvgpr_read_b32 v21, a24
    v_accvgpr_read_b32 v23, a25
    v_accvgpr_read_b32 v25, a26
    v_accvgpr_read_b32 v27, a27
    v_cvt_pk_bf16_f32 v16, v20, v21
    v_cvt_pk_bf16_f32 v17, v22, v23
    v_cvt_pk_bf16_f32 v18, v24, v25
    v_cvt_pk_bf16_f32 v19, v26, v27
    v_lshlrev_b32 v20, 16, v16
    v_and_b32 v21, 0xffff0000, v16
    v_lshlrev_b32 v22, 16, v17
    v_and_b32 v23, 0xffff0000, v17
    v_lshlrev_b32 v24, 16, v18
    v_and_b32 v25, 0xffff0000, v18
    v_lshlrev_b32 v26, 16, v19
    v_and_b32 v27, 0xffff0000, v19
    v_mul_f32 v28, 3216550459, v20
    v_mul_f32 v29, 3216550459, v21
    v_mul_f32 v30, 3216550459, v22
    v_mul_f32 v31, 3216550459, v23
    v_mul_f32 v32, 3216550459, v24
    v_mul_f32 v33, 3216550459, v25
    v_mul_f32 v34, 3216550459, v26
    v_mul_f32 v35, 3216550459, v27
    v_exp_f32 v28, v28
    v_exp_f32 v29, v29
    v_exp_f32 v30, v30
    v_exp_f32 v31, v31
    v_exp_f32 v32, v32
    v_exp_f32 v33, v33
    v_exp_f32 v34, v34
    v_exp_f32 v35, v35
    v_add_f32 v28, 1.0, v28
    v_add_f32 v29, 1.0, v29
    v_add_f32 v30, 1.0, v30
    v_add_f32 v31, 1.0, v31
    v_add_f32 v32, 1.0, v32
    v_add_f32 v33, 1.0, v33
    v_add_f32 v34, 1.0, v34
    v_add_f32 v35, 1.0, v35
    v_rcp_f32 v28, v28
    v_rcp_f32 v29, v29
    v_rcp_f32 v30, v30
    v_rcp_f32 v31, v31
    v_rcp_f32 v32, v32
    v_rcp_f32 v33, v33
    v_rcp_f32 v34, v34
    v_rcp_f32 v35, v35
    v_mul_f32 v20, v20, v28
    v_mul_f32 v21, v21, v29
    v_mul_f32 v22, v22, v30
    v_mul_f32 v23, v23, v31
    v_mul_f32 v24, v24, v32
    v_mul_f32 v25, v25, v33
    v_mul_f32 v26, v26, v34
    v_mul_f32 v27, v27, v35
    v_cvt_pk_bf16_f32 v16, v20, v21
    v_cvt_pk_bf16_f32 v17, v22, v23
    v_cvt_pk_bf16_f32 v18, v24, v25
    v_cvt_pk_bf16_f32 v19, v26, v27
    buffer_store_dwordx4 v[16:19], v6, s[4:7], s73 offen offset:0 sc1
    v_accvgpr_read_b32 v40, a40
    v_accvgpr_read_b32 v42, a41
    v_accvgpr_read_b32 v44, a42
    v_accvgpr_read_b32 v46, a43
    v_accvgpr_read_b32 v41, a56
    v_accvgpr_read_b32 v43, a57
    v_accvgpr_read_b32 v45, a58
    v_accvgpr_read_b32 v47, a59
    v_cvt_pk_bf16_f32 v36, v40, v41
    v_cvt_pk_bf16_f32 v37, v42, v43
    v_cvt_pk_bf16_f32 v38, v44, v45
    v_cvt_pk_bf16_f32 v39, v46, v47
    v_lshlrev_b32 v40, 16, v36
    v_and_b32 v41, 0xffff0000, v36
    v_lshlrev_b32 v42, 16, v37
    v_and_b32 v43, 0xffff0000, v37
    v_lshlrev_b32 v44, 16, v38
    v_and_b32 v45, 0xffff0000, v38
    v_lshlrev_b32 v46, 16, v39
    v_and_b32 v47, 0xffff0000, v39
    v_mul_f32 v48, 3216550459, v40
    v_mul_f32 v49, 3216550459, v41
    v_mul_f32 v50, 3216550459, v42
    v_mul_f32 v51, 3216550459, v43
    v_mul_f32 v52, 3216550459, v44
    v_mul_f32 v53, 3216550459, v45
    v_mul_f32 v54, 3216550459, v46
    v_mul_f32 v55, 3216550459, v47
    v_exp_f32 v48, v48
    v_exp_f32 v49, v49
    v_exp_f32 v50, v50
    v_exp_f32 v51, v51
    v_exp_f32 v52, v52
    v_exp_f32 v53, v53
    v_exp_f32 v54, v54
    v_exp_f32 v55, v55
    v_add_f32 v48, 1.0, v48
    v_add_f32 v49, 1.0, v49
    v_add_f32 v50, 1.0, v50
    v_add_f32 v51, 1.0, v51
    v_add_f32 v52, 1.0, v52
    v_add_f32 v53, 1.0, v53
    v_add_f32 v54, 1.0, v54
    v_add_f32 v55, 1.0, v55
    v_rcp_f32 v48, v48
    v_rcp_f32 v49, v49
    v_rcp_f32 v50, v50
    v_rcp_f32 v51, v51
    v_rcp_f32 v52, v52
    v_rcp_f32 v53, v53
    v_rcp_f32 v54, v54
    v_rcp_f32 v55, v55
    v_mul_f32 v40, v40, v48
    v_mul_f32 v41, v41, v49
    v_mul_f32 v42, v42, v50
    v_mul_f32 v43, v43, v51
    v_mul_f32 v44, v44, v52
    v_mul_f32 v45, v45, v53
    v_mul_f32 v46, v46, v54
    v_mul_f32 v47, v47, v55
    v_cvt_pk_bf16_f32 v36, v40, v41
    v_cvt_pk_bf16_f32 v37, v42, v43
    v_cvt_pk_bf16_f32 v38, v44, v45
    v_cvt_pk_bf16_f32 v39, v46, v47
    buffer_store_dwordx4 v[36:39], v6, s[4:7], s73 offen offset:1024 sc1
    v_accvgpr_read_b32 v60, a72
    v_accvgpr_read_b32 v62, a73
    v_accvgpr_read_b32 v64, a74
    v_accvgpr_read_b32 v66, a75
    v_accvgpr_read_b32 v61, a88
    v_accvgpr_read_b32 v63, a89
    v_accvgpr_read_b32 v65, a90
    v_accvgpr_read_b32 v67, a91
    v_cvt_pk_bf16_f32 v56, v60, v61
    v_cvt_pk_bf16_f32 v57, v62, v63
    v_cvt_pk_bf16_f32 v58, v64, v65
    v_cvt_pk_bf16_f32 v59, v66, v67
    v_lshlrev_b32 v60, 16, v56
    v_and_b32 v61, 0xffff0000, v56
    v_lshlrev_b32 v62, 16, v57
    v_and_b32 v63, 0xffff0000, v57
    v_lshlrev_b32 v64, 16, v58
    v_and_b32 v65, 0xffff0000, v58
    v_lshlrev_b32 v66, 16, v59
    v_and_b32 v67, 0xffff0000, v59
    v_mul_f32 v68, 3216550459, v60
    v_mul_f32 v69, 3216550459, v61
    v_mul_f32 v70, 3216550459, v62
    v_mul_f32 v71, 3216550459, v63
    v_mul_f32 v72, 3216550459, v64
    v_mul_f32 v73, 3216550459, v65
    v_mul_f32 v74, 3216550459, v66
    v_mul_f32 v75, 3216550459, v67
    v_exp_f32 v68, v68
    v_exp_f32 v69, v69
    v_exp_f32 v70, v70
    v_exp_f32 v71, v71
    v_exp_f32 v72, v72
    v_exp_f32 v73, v73
    v_exp_f32 v74, v74
    v_exp_f32 v75, v75
    v_add_f32 v68, 1.0, v68
    v_add_f32 v69, 1.0, v69
    v_add_f32 v70, 1.0, v70
    v_add_f32 v71, 1.0, v71
    v_add_f32 v72, 1.0, v72
    v_add_f32 v73, 1.0, v73
    v_add_f32 v74, 1.0, v74
    v_add_f32 v75, 1.0, v75
    v_rcp_f32 v68, v68
    v_rcp_f32 v69, v69
    v_rcp_f32 v70, v70
    v_rcp_f32 v71, v71
    v_rcp_f32 v72, v72
    v_rcp_f32 v73, v73
    v_rcp_f32 v74, v74
    v_rcp_f32 v75, v75
    v_mul_f32 v60, v60, v68
    v_mul_f32 v61, v61, v69
    v_mul_f32 v62, v62, v70
    v_mul_f32 v63, v63, v71
    v_mul_f32 v64, v64, v72
    v_mul_f32 v65, v65, v73
    v_mul_f32 v66, v66, v74
    v_mul_f32 v67, v67, v75
    v_cvt_pk_bf16_f32 v56, v60, v61
    v_cvt_pk_bf16_f32 v57, v62, v63
    v_cvt_pk_bf16_f32 v58, v64, v65
    v_cvt_pk_bf16_f32 v59, v66, v67
    buffer_store_dwordx4 v[56:59], v6, s[4:7], s73 offen offset:2048 sc1
    v_accvgpr_read_b32 v80, a104
    v_accvgpr_read_b32 v82, a105
    v_accvgpr_read_b32 v84, a106
    v_accvgpr_read_b32 v86, a107
    v_accvgpr_read_b32 v81, a120
    v_accvgpr_read_b32 v83, a121
    v_accvgpr_read_b32 v85, a122
    v_accvgpr_read_b32 v87, a123
    v_cvt_pk_bf16_f32 v76, v80, v81
    v_cvt_pk_bf16_f32 v77, v82, v83
    v_cvt_pk_bf16_f32 v78, v84, v85
    v_cvt_pk_bf16_f32 v79, v86, v87
    v_lshlrev_b32 v80, 16, v76
    v_and_b32 v81, 0xffff0000, v76
    v_lshlrev_b32 v82, 16, v77
    v_and_b32 v83, 0xffff0000, v77
    v_lshlrev_b32 v84, 16, v78
    v_and_b32 v85, 0xffff0000, v78
    v_lshlrev_b32 v86, 16, v79
    v_and_b32 v87, 0xffff0000, v79
    v_mul_f32 v88, 3216550459, v80
    v_mul_f32 v89, 3216550459, v81
    v_mul_f32 v90, 3216550459, v82
    v_mul_f32 v91, 3216550459, v83
    v_mul_f32 v92, 3216550459, v84
    v_mul_f32 v93, 3216550459, v85
    v_mul_f32 v94, 3216550459, v86
    v_mul_f32 v95, 3216550459, v87
    v_exp_f32 v88, v88
    v_exp_f32 v89, v89
    v_exp_f32 v90, v90
    v_exp_f32 v91, v91
    v_exp_f32 v92, v92
    v_exp_f32 v93, v93
    v_exp_f32 v94, v94
    v_exp_f32 v95, v95
    v_add_f32 v88, 1.0, v88
    v_add_f32 v89, 1.0, v89
    v_add_f32 v90, 1.0, v90
    v_add_f32 v91, 1.0, v91
    v_add_f32 v92, 1.0, v92
    v_add_f32 v93, 1.0, v93
    v_add_f32 v94, 1.0, v94
    v_add_f32 v95, 1.0, v95
    v_rcp_f32 v88, v88
    v_rcp_f32 v89, v89
    v_rcp_f32 v90, v90
    v_rcp_f32 v91, v91
    v_rcp_f32 v92, v92
    v_rcp_f32 v93, v93
    v_rcp_f32 v94, v94
    v_rcp_f32 v95, v95
    v_mul_f32 v80, v80, v88
    v_mul_f32 v81, v81, v89
    v_mul_f32 v82, v82, v90
    v_mul_f32 v83, v83, v91
    v_mul_f32 v84, v84, v92
    v_mul_f32 v85, v85, v93
    v_mul_f32 v86, v86, v94
    v_mul_f32 v87, v87, v95
    v_cvt_pk_bf16_f32 v76, v80, v81
    v_cvt_pk_bf16_f32 v77, v82, v83
    v_cvt_pk_bf16_f32 v78, v84, v85
    v_cvt_pk_bf16_f32 v79, v86, v87
    buffer_store_dwordx4 v[76:79], v6, s[4:7], s73 offen offset:3072 sc1
    s_add_u32 s73, s73, s77
    v_accvgpr_read_b32 v20, a12
    v_accvgpr_read_b32 v22, a13
    v_accvgpr_read_b32 v24, a14
    v_accvgpr_read_b32 v26, a15
    v_accvgpr_read_b32 v21, a28
    v_accvgpr_read_b32 v23, a29
    v_accvgpr_read_b32 v25, a30
    v_accvgpr_read_b32 v27, a31
    v_cvt_pk_bf16_f32 v16, v20, v21
    v_cvt_pk_bf16_f32 v17, v22, v23
    v_cvt_pk_bf16_f32 v18, v24, v25
    v_cvt_pk_bf16_f32 v19, v26, v27
    v_lshlrev_b32 v20, 16, v16
    v_and_b32 v21, 0xffff0000, v16
    v_lshlrev_b32 v22, 16, v17
    v_and_b32 v23, 0xffff0000, v17
    v_lshlrev_b32 v24, 16, v18
    v_and_b32 v25, 0xffff0000, v18
    v_lshlrev_b32 v26, 16, v19
    v_and_b32 v27, 0xffff0000, v19
    v_mul_f32 v28, 3216550459, v20
    v_mul_f32 v29, 3216550459, v21
    v_mul_f32 v30, 3216550459, v22
    v_mul_f32 v31, 3216550459, v23
    v_mul_f32 v32, 3216550459, v24
    v_mul_f32 v33, 3216550459, v25
    v_mul_f32 v34, 3216550459, v26
    v_mul_f32 v35, 3216550459, v27
    v_exp_f32 v28, v28
    v_exp_f32 v29, v29
    v_exp_f32 v30, v30
    v_exp_f32 v31, v31
    v_exp_f32 v32, v32
    v_exp_f32 v33, v33
    v_exp_f32 v34, v34
    v_exp_f32 v35, v35
    v_add_f32 v28, 1.0, v28
    v_add_f32 v29, 1.0, v29
    v_add_f32 v30, 1.0, v30
    v_add_f32 v31, 1.0, v31
    v_add_f32 v32, 1.0, v32
    v_add_f32 v33, 1.0, v33
    v_add_f32 v34, 1.0, v34
    v_add_f32 v35, 1.0, v35
    v_rcp_f32 v28, v28
    v_rcp_f32 v29, v29
    v_rcp_f32 v30, v30
    v_rcp_f32 v31, v31
    v_rcp_f32 v32, v32
    v_rcp_f32 v33, v33
    v_rcp_f32 v34, v34
    v_rcp_f32 v35, v35
    v_mul_f32 v20, v20, v28
    v_mul_f32 v21, v21, v29
    v_mul_f32 v22, v22, v30
    v_mul_f32 v23, v23, v31
    v_mul_f32 v24, v24, v32
    v_mul_f32 v25, v25, v33
    v_mul_f32 v26, v26, v34
    v_mul_f32 v27, v27, v35
    v_cvt_pk_bf16_f32 v16, v20, v21
    v_cvt_pk_bf16_f32 v17, v22, v23
    v_cvt_pk_bf16_f32 v18, v24, v25
    v_cvt_pk_bf16_f32 v19, v26, v27
    buffer_store_dwordx4 v[16:19], v6, s[4:7], s73 offen offset:0 sc1
    v_accvgpr_read_b32 v40, a44
    v_accvgpr_read_b32 v42, a45
    v_accvgpr_read_b32 v44, a46
    v_accvgpr_read_b32 v46, a47
    v_accvgpr_read_b32 v41, a60
    v_accvgpr_read_b32 v43, a61
    v_accvgpr_read_b32 v45, a62
    v_accvgpr_read_b32 v47, a63
    v_cvt_pk_bf16_f32 v36, v40, v41
    v_cvt_pk_bf16_f32 v37, v42, v43
    v_cvt_pk_bf16_f32 v38, v44, v45
    v_cvt_pk_bf16_f32 v39, v46, v47
    v_lshlrev_b32 v40, 16, v36
    v_and_b32 v41, 0xffff0000, v36
    v_lshlrev_b32 v42, 16, v37
    v_and_b32 v43, 0xffff0000, v37
    v_lshlrev_b32 v44, 16, v38
    v_and_b32 v45, 0xffff0000, v38
    v_lshlrev_b32 v46, 16, v39
    v_and_b32 v47, 0xffff0000, v39
    v_mul_f32 v48, 3216550459, v40
    v_mul_f32 v49, 3216550459, v41
    v_mul_f32 v50, 3216550459, v42
    v_mul_f32 v51, 3216550459, v43
    v_mul_f32 v52, 3216550459, v44
    v_mul_f32 v53, 3216550459, v45
    v_mul_f32 v54, 3216550459, v46
    v_mul_f32 v55, 3216550459, v47
    v_exp_f32 v48, v48
    v_exp_f32 v49, v49
    v_exp_f32 v50, v50
    v_exp_f32 v51, v51
    v_exp_f32 v52, v52
    v_exp_f32 v53, v53
    v_exp_f32 v54, v54
    v_exp_f32 v55, v55
    v_add_f32 v48, 1.0, v48
    v_add_f32 v49, 1.0, v49
    v_add_f32 v50, 1.0, v50
    v_add_f32 v51, 1.0, v51
    v_add_f32 v52, 1.0, v52
    v_add_f32 v53, 1.0, v53
    v_add_f32 v54, 1.0, v54
    v_add_f32 v55, 1.0, v55
    v_rcp_f32 v48, v48
    v_rcp_f32 v49, v49
    v_rcp_f32 v50, v50
    v_rcp_f32 v51, v51
    v_rcp_f32 v52, v52
    v_rcp_f32 v53, v53
    v_rcp_f32 v54, v54
    v_rcp_f32 v55, v55
    v_mul_f32 v40, v40, v48
    v_mul_f32 v41, v41, v49
    v_mul_f32 v42, v42, v50
    v_mul_f32 v43, v43, v51
    v_mul_f32 v44, v44, v52
    v_mul_f32 v45, v45, v53
    v_mul_f32 v46, v46, v54
    v_mul_f32 v47, v47, v55
    v_cvt_pk_bf16_f32 v36, v40, v41
    v_cvt_pk_bf16_f32 v37, v42, v43
    v_cvt_pk_bf16_f32 v38, v44, v45
    v_cvt_pk_bf16_f32 v39, v46, v47
    buffer_store_dwordx4 v[36:39], v6, s[4:7], s73 offen offset:1024 sc1
    v_accvgpr_read_b32 v60, a76
    v_accvgpr_read_b32 v62, a77
    v_accvgpr_read_b32 v64, a78
    v_accvgpr_read_b32 v66, a79
    v_accvgpr_read_b32 v61, a92
    v_accvgpr_read_b32 v63, a93
    v_accvgpr_read_b32 v65, a94
    v_accvgpr_read_b32 v67, a95
    v_cvt_pk_bf16_f32 v56, v60, v61
    v_cvt_pk_bf16_f32 v57, v62, v63
    v_cvt_pk_bf16_f32 v58, v64, v65
    v_cvt_pk_bf16_f32 v59, v66, v67
    v_lshlrev_b32 v60, 16, v56
    v_and_b32 v61, 0xffff0000, v56
    v_lshlrev_b32 v62, 16, v57
    v_and_b32 v63, 0xffff0000, v57
    v_lshlrev_b32 v64, 16, v58
    v_and_b32 v65, 0xffff0000, v58
    v_lshlrev_b32 v66, 16, v59
    v_and_b32 v67, 0xffff0000, v59
    v_mul_f32 v68, 3216550459, v60
    v_mul_f32 v69, 3216550459, v61
    v_mul_f32 v70, 3216550459, v62
    v_mul_f32 v71, 3216550459, v63
    v_mul_f32 v72, 3216550459, v64
    v_mul_f32 v73, 3216550459, v65
    v_mul_f32 v74, 3216550459, v66
    v_mul_f32 v75, 3216550459, v67
    v_exp_f32 v68, v68
    v_exp_f32 v69, v69
    v_exp_f32 v70, v70
    v_exp_f32 v71, v71
    v_exp_f32 v72, v72
    v_exp_f32 v73, v73
    v_exp_f32 v74, v74
    v_exp_f32 v75, v75
    v_add_f32 v68, 1.0, v68
    v_add_f32 v69, 1.0, v69
    v_add_f32 v70, 1.0, v70
    v_add_f32 v71, 1.0, v71
    v_add_f32 v72, 1.0, v72
    v_add_f32 v73, 1.0, v73
    v_add_f32 v74, 1.0, v74
    v_add_f32 v75, 1.0, v75
    v_rcp_f32 v68, v68
    v_rcp_f32 v69, v69
    v_rcp_f32 v70, v70
    v_rcp_f32 v71, v71
    v_rcp_f32 v72, v72
    v_rcp_f32 v73, v73
    v_rcp_f32 v74, v74
    v_rcp_f32 v75, v75
    v_mul_f32 v60, v60, v68
    v_mul_f32 v61, v61, v69
    v_mul_f32 v62, v62, v70
    v_mul_f32 v63, v63, v71
    v_mul_f32 v64, v64, v72
    v_mul_f32 v65, v65, v73
    v_mul_f32 v66, v66, v74
    v_mul_f32 v67, v67, v75
    v_cvt_pk_bf16_f32 v56, v60, v61
    v_cvt_pk_bf16_f32 v57, v62, v63
    v_cvt_pk_bf16_f32 v58, v64, v65
    v_cvt_pk_bf16_f32 v59, v66, v67
    buffer_store_dwordx4 v[56:59], v6, s[4:7], s73 offen offset:2048 sc1
    v_accvgpr_read_b32 v80, a108
    v_accvgpr_read_b32 v82, a109
    v_accvgpr_read_b32 v84, a110
    v_accvgpr_read_b32 v86, a111
    v_accvgpr_read_b32 v81, a124
    v_accvgpr_read_b32 v83, a125
    v_accvgpr_read_b32 v85, a126
    v_accvgpr_read_b32 v87, a127
    v_cvt_pk_bf16_f32 v76, v80, v81
    v_cvt_pk_bf16_f32 v77, v82, v83
    v_cvt_pk_bf16_f32 v78, v84, v85
    v_cvt_pk_bf16_f32 v79, v86, v87
    v_lshlrev_b32 v80, 16, v76
    v_and_b32 v81, 0xffff0000, v76
    v_lshlrev_b32 v82, 16, v77
    v_and_b32 v83, 0xffff0000, v77
    v_lshlrev_b32 v84, 16, v78
    v_and_b32 v85, 0xffff0000, v78
    v_lshlrev_b32 v86, 16, v79
    v_and_b32 v87, 0xffff0000, v79
    v_mul_f32 v88, 3216550459, v80
    v_mul_f32 v89, 3216550459, v81
    v_mul_f32 v90, 3216550459, v82
    v_mul_f32 v91, 3216550459, v83
    v_mul_f32 v92, 3216550459, v84
    v_mul_f32 v93, 3216550459, v85
    v_mul_f32 v94, 3216550459, v86
    v_mul_f32 v95, 3216550459, v87
    v_exp_f32 v88, v88
    v_exp_f32 v89, v89
    v_exp_f32 v90, v90
    v_exp_f32 v91, v91
    v_exp_f32 v92, v92
    v_exp_f32 v93, v93
    v_exp_f32 v94, v94
    v_exp_f32 v95, v95
    v_add_f32 v88, 1.0, v88
    v_add_f32 v89, 1.0, v89
    v_add_f32 v90, 1.0, v90
    v_add_f32 v91, 1.0, v91
    v_add_f32 v92, 1.0, v92
    v_add_f32 v93, 1.0, v93
    v_add_f32 v94, 1.0, v94
    v_add_f32 v95, 1.0, v95
    v_rcp_f32 v88, v88
    v_rcp_f32 v89, v89
    v_rcp_f32 v90, v90
    v_rcp_f32 v91, v91
    v_rcp_f32 v92, v92
    v_rcp_f32 v93, v93
    v_rcp_f32 v94, v94
    v_rcp_f32 v95, v95
    v_mul_f32 v80, v80, v88
    v_mul_f32 v81, v81, v89
    v_mul_f32 v82, v82, v90
    v_mul_f32 v83, v83, v91
    v_mul_f32 v84, v84, v92
    v_mul_f32 v85, v85, v93
    v_mul_f32 v86, v86, v94
    v_mul_f32 v87, v87, v95
    v_cvt_pk_bf16_f32 v76, v80, v81
    v_cvt_pk_bf16_f32 v77, v82, v83
    v_cvt_pk_bf16_f32 v78, v84, v85
    v_cvt_pk_bf16_f32 v79, v86, v87
    buffer_store_dwordx4 v[76:79], v6, s[4:7], s73 offen offset:3072 sc1
    s_add_u32 s73, s73, s77
L_wk_done:
    s_and_b32 s81, s62, 15
    s_lshl_b32 s81, s81, 4
    s_cmp_eq_u32 s72, 3
    s_cselect_b32 s81, 256, s81
    s_add_u32 s81, s81, s61
    s_lshl_b32 s81, s81, 2
    s_add_u32 s81, s81, 87097344
    s_cmp_eq_u32 s72, 0
    s_cselect_b32 s82, 256, 1
    s_waitcnt vmcnt(0)
    s_barrier
    s_cmp_lg_u32 s60, 0
    s_cbranch_scc1 L_wk_next
    v_mov_b32 v14, s82
    s_mov_b64 exec, 1
    buffer_atomic_add v14, v12, s[4:7], s81 offen
    s_mov_b64 exec, -1
    s_branch L_wk_next
L_att_next:
    s_add_u32 s74, s74, 112
    s_cmp_ge_u32 s74, 512
    s_cbranch_scc1 L_rec_exit
L_att:
    s_mov_b32 s81, s74
    s_lshr_b32 s24, s81, 3
    s_and_b32 s25, s81, 7
    s_lshl_b32 s25, s25, 2
    s_add_u32 s25, s25, s60
    s_lshr_b32 s81, s25, 1
    s_lshl_b32 s81, s81, 4
    s_lshr_b32 s82, s24, 2
    s_add_u32 s81, s81, s82
    s_lshl_b32 s81, s81, 2
    s_add_u32 s81, s81, 87097344
    v_lshrrev_b32 v160, 4, v0
    v_and_b32 v161, 15, v0
    v_lshlrev_b32 v162, 4, v0
    s_lshl_b32 s26, s24, 18
    s_lshl_b32 s27, s25, 12
    s_add_u32 s26, s26, s27
    s_add_u32 s27, s26, 2097152
    s_add_u32 s28, s27, 131072
    s_add_u32 s29, s26, 18874368
    s_add_u32 s30, s29, 131072
    s_add_u32 s34, s26, 52428800
    s_add_u32 s35, s34, 131072
    s_lshl_b32 s31, s24, 5
    s_add_u32 s31, s31, s25
    s_lshl_b32 s36, s31, 12
    s_add_u32 s36, s36, 77594624
    s_lshl_b32 s32, s31, 13
    s_add_u32 s32, s32, 35651584
    s_add_u32 s33, s32, 4096
    v_lshrrev_b32 v166, 2, v161
    v_and_b32 v167, 1, v161
    v_lshlrev_b32 v163, 8, v166
    v_lshl_add_u32 v163, v160, 6, v163
    v_lshl_add_u32 v163, v167, 3, v163
    v_lshlrev_b32 v164, 6, v161
    v_lshl_add_u32 v164, v160, 4, v164
    s_mov_b32 s75, 0
L_wf_a1:
    buffer_load_dword v14, v12, s[4:7], s81 offen sc0 sc1
    s_add_u32 s75, s75, 1
    s_cmp_lt_u32 s75, 65536
    s_cbranch_scc0 L_rec_exit
    s_waitcnt vmcnt(0)
    v_readfirstlane_b32 s84, v14
    s_nop 0
    s_cmp_eq_u32 s84, 258
    s_cbranch_scc1 L_wfd_a1
    s_sleep 8
    s_branch L_wf_a1
L_wfd_a1:
    buffer_load_dwordx4 v[16:19], v162, s[4:7], s27 offen offset:0 sc1
    buffer_load_dwordx4 v[20:23], v162, s[4:7], s27 offen offset:1024 sc1
    buffer_load_dwordx4 v[24:27], v162, s[4:7], s27 offen offset:2048 sc1
    buffer_load_dwordx4 v[28:31], v162, s[4:7], s27 offen offset:3072 sc1
    buffer_load_dwordx4 v[48:51], v162, s[4:7], s29 offen offset:0 sc1
    buffer_load_dwordx4 v[52:55], v162, s[4:7], s29 offen offset:1024 sc1
    buffer_load_dwordx4 v[56:59], v162, s[4:7], s29 offen offset:2048 sc1
    buffer_load_dwordx4 v[60:63], v162, s[4:7], s29 offen offset:3072 sc1
    buffer_load_dwordx4 v[32:35], v162, s[4:7], s28 offen offset:0 sc1
    buffer_load_dwordx4 v[36:39], v162, s[4:7], s28 offen offset:1024 sc1
    buffer_load_dwordx4 v[40:43], v162, s[4:7], s28 offen offset:2048 sc1
    buffer_load_dwordx4 v[44:47], v162, s[4:7], s28 offen offset:3072 sc1
    buffer_load_dwordx4 v[64:67], v162, s[4:7], s30 offen offset:0 sc1
    buffer_load_dwordx4 v[68:71], v162, s[4:7], s30 offen offset:1024 sc1
    buffer_load_dwordx4 v[72:75], v162, s[4:7], s30 offen offset:2048 sc1
    buffer_load_dwordx4 v[76:79], v162, s[4:7], s30 offen offset:3072 sc1
    buffer_load_dwordx4 v[96:99], v164, s[4:7], s32 offen offset:0 sc1
    buffer_load_dwordx4 v[100:103], v164, s[4:7], s32 offen offset:1024 sc1
    buffer_load_dwordx4 v[104:107], v164, s[4:7], s32 offen offset:2048 sc1
    buffer_load_dwordx4 v[108:111], v164, s[4:7], s32 offen offset:3072 sc1
    buffer_load_dwordx4 v[112:115], v164, s[4:7], s33 offen offset:0 sc1
    buffer_load_dwordx4 v[116:119], v164, s[4:7], s33 offen offset:1024 sc1
    buffer_load_dwordx4 v[120:123], v164, s[4:7], s33 offen offset:2048 sc1
    buffer_load_dwordx4 v[124:127], v164, s[4:7], s33 offen offset:3072 sc1
    v_mov_b32 v172, 0x3f803f80
    v_mov_b32 v173, 0x3f803f80
    v_mov_b32 v174, 0x3f803f80
    v_mov_b32 v175, 0x3f803f80
    v_lshlrev_b32 v166, 2, v160
    v_add_u32 v167, 0, v166
    v_cmp_le_u32 s[40:41], v167, v161
    v_add_u32 v167, 1, v166
    v_cmp_le_u32 s[42:43], v167, v161
    v_add_u32 v167, 2, v166
    v_cmp_le_u32 s[44:45], v167, v161
    v_add_u32 v167, 3, v166
    v_cmp_le_u32 s[46:47], v167, v161
    s_mov_b32 s48, 1040356334
    v_mov_b32 v166, 0xf149f2ca
    v_mov_b32 v189, 0
    s_waitcnt vmcnt(8)
    v_mfma_f32_16x16x32_bf16 v[224:227], v[48:51], v[16:19], 0
    v_mfma_f32_16x16x32_bf16 v[228:231], v[48:51], v[32:35], 0
    v_mfma_f32_16x16x32_bf16 v[232:235], v[64:67], v[32:35], 0
    v_mfma_f32_16x16x32_bf16 v[224:227], v[52:55], v[20:23], v[224:227]
    v_mfma_f32_16x16x32_bf16 v[228:231], v[52:55], v[36:39], v[228:231]
    v_mfma_f32_16x16x32_bf16 v[232:235], v[68:71], v[36:39], v[232:235]
    v_mfma_f32_16x16x32_bf16 v[224:227], v[56:59], v[24:27], v[224:227]
    v_mfma_f32_16x16x32_bf16 v[228:231], v[56:59], v[40:43], v[228:231]
    v_mfma_f32_16x16x32_bf16 v[232:235], v[72:75], v[40:43], v[232:235]
    v_mfma_f32_16x16x32_bf16 v[224:227], v[60:63], v[28:31], v[224:227]
    v_mfma_f32_16x16x32_bf16 v[228:231], v[60:63], v[44:47], v[228:231]
    v_mfma_f32_16x16x32_bf16 v[232:235], v[76:79], v[44:47], v[232:235]
    v_cndmask_b32 v224, v166, v224, s[40:41]
    v_cndmask_b32 v225, v166, v225, s[42:43]
    v_cndmask_b32 v226, v166, v226, s[44:45]
    v_cndmask_b32 v227, v166, v227, s[46:47]
    s_nop 3
    v_cndmask_b32 v232, v166, v232, s[40:41]
    v_cndmask_b32 v233, v166, v233, s[42:43]
    v_cndmask_b32 v234, v166, v234, s[44:45]
    v_cndmask_b32 v235, v166, v235, s[46:47]
    s_lshl_b32 s81, s25, 7
    s_add_u32 s81, s81, 87105536
    s_mov_b32 s75, 0
L_wf_a2:
    buffer_load_dword v14, v12, s[4:7], s81 offen sc0 sc1
    s_add_u32 s75, s75, 1
    s_cmp_lt_u32 s75, 65536
    s_cbranch_scc0 L_rec_exit
    s_waitcnt vmcnt(0)
    v_readfirstlane_b32 s84, v14
    s_nop 0
    s_cmp_gt_u32 s84, s24
    s_cbranch_scc1 L_wfd_a2
    s_sleep 2
    s_add_u32 s84, s84, 1
    s_cmp_ge_u32 s84, s24
    s_cbranch_scc1 L_wf_a2
    s_sleep 40
    s_branch L_wf_a2
L_wfd_a2:
    buffer_load_dword v80, v163, s[4:7], s36 offen offset:4 sc1
    buffer_load_dword v81, v163, s[4:7], s36 offen offset:20 sc1
    buffer_load_dword v82, v163, s[4:7], s36 offen offset:36 sc1
    buffer_load_dword v83, v163, s[4:7], s36 offen offset:52 sc1
    buffer_load_dword v84, v163, s[4:7], s36 offen offset:1028 sc1
    buffer_load_dword v85, v163, s[4:7], s36 offen offset:1044 sc1
    buffer_load_dword v86, v163, s[4:7], s36 offen offset:1060 sc1
    buffer_load_dword v87, v163, s[4:7], s36 offen offset:1076 sc1
    buffer_load_dword v88, v163, s[4:7], s36 offen offset:2052 sc1
    buffer_load_dword v89, v163, s[4:7], s36 offen offset:2068 sc1
    buffer_load_dword v90, v163, s[4:7], s36 offen offset:2084 sc1
    buffer_load_dword v91, v163, s[4:7], s36 offen offset:2100 sc1
    buffer_load_dword v92, v163, s[4:7], s36 offen offset:3076 sc1
    buffer_load_dword v93, v163, s[4:7], s36 offen offset:3092 sc1
    buffer_load_dword v94, v163, s[4:7], s36 offen offset:3108 sc1
    buffer_load_dword v95, v163, s[4:7], s36 offen offset:3124 sc1
    buffer_load_dwordx4 v[128:131], v162, s[4:7], s36 offen offset:0 sc1
    buffer_load_dwordx4 v[132:135], v162, s[4:7], s36 offen offset:1024 sc1
    buffer_load_dwordx4 v[136:139], v162, s[4:7], s36 offen offset:2048 sc1
    buffer_load_dwordx4 v[140:143], v162, s[4:7], s36 offen offset:3072 sc1
    s_waitcnt vmcnt(4)
    v_mfma_f32_16x16x32_bf16 v[176:179], v[80:83], v[16:19], 0
    v_mfma_f32_16x16x32_bf16 v[180:183], v[80:83], v[32:35], 0
    v_mfma_f32_16x16x32_bf16 v[176:179], v[84:87], v[20:23], v[176:179]
    v_mfma_f32_16x16x32_bf16 v[180:183], v[84:87], v[36:39], v[180:183]
    v_mfma_f32_16x16x32_bf16 v[176:179], v[88:91], v[24:27], v[176:179]
    v_mfma_f32_16x16x32_bf16 v[180:183], v[88:91], v[40:43], v[180:183]
    v_mfma_f32_16x16x32_bf16 v[176:179], v[92:95], v[28:31], v[176:179]
    v_mfma_f32_16x16x32_bf16 v[180:183], v[92:95], v[44:47], v[180:183]
    v_max3_f32 v168, v227, v225, v226
    v_max_f32 v168, v168, v224
    s_nop 1
    v_max3_f32 v168, v168, v176, v177
    v_mov_b32 v169, v168
    s_nop 1
    v_permlane32_swap_b32 v168, v169
    v_max_f32 v168, v168, v169
    v_mov_b32 v169, v168
    s_nop 1
    v_permlane16_swap_b32 v168, v169
    v_max_f32 v168, v168, v169
    v_mul_f32 v168, s48, v168
    v_fma_f32 v176, v176, s48, -v168
    v_fma_f32 v177, v177, s48, -v168
    v_fma_f32 v224, v224, s48, -v168
    v_fma_f32 v225, v225, s48, -v168
    v_fma_f32 v226, v226, s48, -v168
    v_fma_f32 v227, v227, s48, -v168
    v_exp_f32 v176, v176
    v_exp_f32 v177, v177
    v_exp_f32 v224, v224
    v_exp_f32 v225, v225
    v_exp_f32 v226, v226
    v_exp_f32 v227, v227
    v_cvt_pk_bf16_f32 v188, v176, v177
    v_cvt_pk_bf16_f32 v192, v224, v225
    v_cvt_pk_bf16_f32 v193, v226, v227
    v_mov_b32 v194, 0
    v_mov_b32 v195, 0
    s_waitcnt vmcnt(0)
    v_mfma_f32_16x16x16_bf16 v[196:199], v[172:173], v[188:189], 0
    v_mfma_f32_16x16x16_bf16 v[200:203], v[128:129], v[188:189], 0
    v_mfma_f32_16x16x16_bf16 v[204:207], v[130:131], v[188:189], 0
    v_mfma_f32_16x16x32_bf16 v[196:199], v[172:175], v[192:195], v[196:199]
    v_mfma_f32_16x16x32_bf16 v[200:203], v[96:99], v[192:195], v[200:203]
    v_mfma_f32_16x16x32_bf16 v[204:207], v[100:103], v[192:195], v[204:207]
    v_rcp_f32 v167, v196
    v_mfma_f32_16x16x16_bf16 v[208:211], v[132:133], v[188:189], 0
    v_mfma_f32_16x16x16_bf16 v[212:215], v[134:135], v[188:189], 0
    v_mfma_f32_16x16x32_bf16 v[208:211], v[104:107], v[192:195], v[208:211]
    v_mfma_f32_16x16x32_bf16 v[212:215], v[108:111], v[192:195], v[212:215]
    v_mul_f32 v200, v167, v200
    v_mul_f32 v201, v167, v201
    v_mul_f32 v202, v167, v202
    v_mul_f32 v203, v167, v203
    v_mul_f32 v204, v167, v204
    v_mul_f32 v205, v167, v205
    v_mul_f32 v206, v167, v206
    v_mul_f32 v207, v167, v207
    v_cvt_pk_bf16_f32 v216, v200, v204
    v_cvt_pk_bf16_f32 v217, v201, v205
    v_cvt_pk_bf16_f32 v218, v202, v206
    v_cvt_pk_bf16_f32 v219, v203, v207
    buffer_store_dwordx4 v[216:219], v162, s[4:7], s34 offen offset:0 sc1
    v_mfma_f32_16x16x16_bf16 v[200:203], v[136:137], v[188:189], 0
    v_mfma_f32_16x16x16_bf16 v[204:207], v[138:139], v[188:189], 0
    v_mfma_f32_16x16x32_bf16 v[200:203], v[112:115], v[192:195], v[200:203]
    v_mfma_f32_16x16x32_bf16 v[204:207], v[116:119], v[192:195], v[204:207]
    v_mul_f32 v208, v167, v208
    v_mul_f32 v209, v167, v209
    v_mul_f32 v210, v167, v210
    v_mul_f32 v211, v167, v211
    v_mul_f32 v212, v167, v212
    v_mul_f32 v213, v167, v213
    v_mul_f32 v214, v167, v214
    v_mul_f32 v215, v167, v215
    v_cvt_pk_bf16_f32 v220, v208, v212
    v_cvt_pk_bf16_f32 v221, v209, v213
    v_cvt_pk_bf16_f32 v222, v210, v214
    v_cvt_pk_bf16_f32 v223, v211, v215
    buffer_store_dwordx4 v[220:223], v162, s[4:7], s34 offen offset:1024 sc1
    v_mfma_f32_16x16x16_bf16 v[208:211], v[140:141], v[188:189], 0
    v_mfma_f32_16x16x16_bf16 v[212:215], v[142:143], v[188:189], 0
    v_mfma_f32_16x16x32_bf16 v[208:211], v[120:123], v[192:195], v[208:211]
    v_mfma_f32_16x16x32_bf16 v[212:215], v[124:127], v[192:195], v[212:215]
    v_mul_f32 v200, v167, v200
    v_mul_f32 v201, v167, v201
    v_mul_f32 v202, v167, v202
    v_mul_f32 v203, v167, v203
    v_mul_f32 v204, v167, v204
    v_mul_f32 v205, v167, v205
    v_mul_f32 v206, v167, v206
    v_mul_f32 v207, v167, v207
    v_cvt_pk_bf16_f32 v216, v200, v204
    v_cvt_pk_bf16_f32 v217, v201, v205
    v_cvt_pk_bf16_f32 v218, v202, v206
    v_cvt_pk_bf16_f32 v219, v203, v207
    buffer_store_dwordx4 v[216:219], v162, s[4:7], s34 offen offset:2048 sc1
    v_mul_f32 v208, v167, v208
    v_mul_f32 v209, v167, v209
    v_mul_f32 v210, v167, v210
    v_mul_f32 v211, v167, v211
    v_mul_f32 v212, v167, v212
    v_mul_f32 v213, v167, v213
    v_mul_f32 v214, v167, v214
    v_mul_f32 v215, v167, v215
    v_cvt_pk_bf16_f32 v220, v208, v212
    v_cvt_pk_bf16_f32 v221, v209, v213
    v_cvt_pk_bf16_f32 v222, v210, v214
    v_cvt_pk_bf16_f32 v223, v211, v215
    buffer_store_dwordx4 v[220:223], v162, s[4:7], s34 offen offset:3072 sc1
    v_max3_f32 v168, v231, v229, v230
    v_max3_f32 v168, v168, v232, v233
    v_max3_f32 v168, v168, v234, v235
    v_max_f32 v168, v168, v228
    v_max3_f32 v168, v168, v180, v181
    v_mov_b32 v169, v168
    s_nop 1
    v_permlane32_swap_b32 v168, v169
    v_max_f32 v168, v168, v169
    v_mov_b32 v169, v168
    s_nop 1
    v_permlane16_swap_b32 v168, v169
    v_max_f32 v168, v168, v169
    v_mul_f32 v168, s48, v168
    v_fma_f32 v180, v180, s48, -v168
    v_fma_f32 v181, v181, s48, -v168
    v_fma_f32 v228, v228, s48, -v168
    v_fma_f32 v229, v229, s48, -v168
    v_fma_f32 v230, v230, s48, -v168
    v_fma_f32 v231, v231, s48, -v168
    v_fma_f32 v232, v232, s48, -v168
    v_fma_f32 v233, v233, s48, -v168
    v_fma_f32 v234, v234, s48, -v168
    v_fma_f32 v235, v235, s48, -v168
    v_exp_f32 v180, v180
    v_exp_f32 v181, v181
    v_exp_f32 v228, v228
    v_exp_f32 v229, v229
    v_exp_f32 v230, v230
    v_exp_f32 v231, v231
    v_exp_f32 v232, v232
    v_exp_f32 v233, v233
    v_exp_f32 v234, v234
    v_exp_f32 v235, v235
    v_cvt_pk_bf16_f32 v188, v180, v181
    v_cvt_pk_bf16_f32 v192, v228, v229
    v_cvt_pk_bf16_f32 v193, v230, v231
    v_cvt_pk_bf16_f32 v194, v232, v233
    v_cvt_pk_bf16_f32 v195, v234, v235
    v_mfma_f32_16x16x16_bf16 v[196:199], v[172:173], v[188:189], 0
    v_mfma_f32_16x16x16_bf16 v[200:203], v[128:129], v[188:189], 0
    v_mfma_f32_16x16x16_bf16 v[204:207], v[130:131], v[188:189], 0
    v_mfma_f32_16x16x32_bf16 v[196:199], v[172:175], v[192:195], v[196:199]
    v_mfma_f32_16x16x32_bf16 v[200:203], v[96:99], v[192:195], v[200:203]
    v_mfma_f32_16x16x32_bf16 v[204:207], v[100:103], v[192:195], v[204:207]
    v_rcp_f32 v167, v196
    v_mfma_f32_16x16x16_bf16 v[208:211], v[132:133], v[188:189], 0
    v_mfma_f32_16x16x16_bf16 v[212:215], v[134:135], v[188:189], 0
    v_mfma_f32_16x16x32_bf16 v[208:211], v[104:107], v[192:195], v[208:211]
    v_mfma_f32_16x16x32_bf16 v[212:215], v[108:111], v[192:195], v[212:215]
    v_mul_f32 v200, v167, v200
    v_mul_f32 v201, v167, v201
    v_mul_f32 v202, v167, v202
    v_mul_f32 v203, v167, v203
    v_mul_f32 v204, v167, v204
    v_mul_f32 v205, v167, v205
    v_mul_f32 v206, v167, v206
    v_mul_f32 v207, v167, v207
    v_cvt_pk_bf16_f32 v216, v200, v204
    v_cvt_pk_bf16_f32 v217, v201, v205
    v_cvt_pk_bf16_f32 v218, v202, v206
    v_cvt_pk_bf16_f32 v219, v203, v207
    buffer_store_dwordx4 v[216:219], v162, s[4:7], s35 offen offset:0 sc1
    v_mfma_f32_16x16x16_bf16 v[200:203], v[136:137], v[188:189], 0
    v_mfma_f32_16x16x16_bf16 v[204:207], v[138:139], v[188:189], 0
    v_mfma_f32_16x16x32_bf16 v[200:203], v[112:115], v[192:195], v[200:203]
    v_mfma_f32_16x16x32_bf16 v[204:207], v[116:119], v[192:195], v[204:207]
    v_mul_f32 v208, v167, v208
    v_mul_f32 v209, v167, v209
    v_mul_f32 v210, v167, v210
    v_mul_f32 v211, v167, v211
    v_mul_f32 v212, v167, v212
    v_mul_f32 v213, v167, v213
    v_mul_f32 v214, v167, v214
    v_mul_f32 v215, v167, v215
    v_cvt_pk_bf16_f32 v220, v208, v212
    v_cvt_pk_bf16_f32 v221, v209, v213
    v_cvt_pk_bf16_f32 v222, v210, v214
    v_cvt_pk_bf16_f32 v223, v211, v215
    buffer_store_dwordx4 v[220:223], v162, s[4:7], s35 offen offset:1024 sc1
    v_mfma_f32_16x16x16_bf16 v[208:211], v[140:141], v[188:189], 0
    v_mfma_f32_16x16x16_bf16 v[212:215], v[142:143], v[188:189], 0
    v_mfma_f32_16x16x32_bf16 v[208:211], v[120:123], v[192:195], v[208:211]
    v_mfma_f32_16x16x32_bf16 v[212:215], v[124:127], v[192:195], v[212:215]
    v_mul_f32 v200, v167, v200
    v_mul_f32 v201, v167, v201
    v_mul_f32 v202, v167, v202
    v_mul_f32 v203, v167, v203
    v_mul_f32 v204, v167, v204
    v_mul_f32 v205, v167, v205
    v_mul_f32 v206, v167, v206
    v_mul_f32 v207, v167, v207
    v_cvt_pk_bf16_f32 v216, v200, v204
    v_cvt_pk_bf16_f32 v217, v201, v205
    v_cvt_pk_bf16_f32 v218, v202, v206
    v_cvt_pk_bf16_f32 v219, v203, v207
    buffer_store_dwordx4 v[216:219], v162, s[4:7], s35 offen offset:2048 sc1
    v_mul_f32 v208, v167, v208
    v_mul_f32 v209, v167, v209
    v_mul_f32 v210, v167, v210
    v_mul_f32 v211, v167, v211
    v_mul_f32 v212, v167, v212
    v_mul_f32 v213, v167, v213
    v_mul_f32 v214, v167, v214
    v_mul_f32 v215, v167, v215
    v_cvt_pk_bf16_f32 v220, v208, v212
    v_cvt_pk_bf16_f32 v221, v209, v213
    v_cvt_pk_bf16_f32 v222, v210, v214
    v_cvt_pk_bf16_f32 v223, v211, v215
    buffer_store_dwordx4 v[220:223], v162, s[4:7], s35 offen offset:3072 sc1
    s_lshl_b32 s81, s24, 6
    s_add_u32 s81, s81, 87101440
    s_waitcnt vmcnt(0)
    s_barrier
    s_cmp_lg_u32 s60, 0
    s_cbranch_scc1 L_att_next
    v_mov_b32 v14, 1
    s_mov_b64 exec, 1
    buffer_atomic_add v14, v12, s[4:7], s81 offen
    s_mov_b64 exec, -1
    s_branch L_att_next
L_g2:
    s_mov_b32 s81, s74
    s_and_b32 s24, s81, 15
    s_lshr_b32 s85, s81, 4
    s_load_dwordx4 s[28:31], s[0:1], 72
    s_load_dwordx2 s[32:33], s[0:1], 0
    v_lshrrev_b32 v1, 4, v0
    v_and_b32 v2, 15, v0
    s_lshl_b32 s25, s60, 15
    s_lshl_b32 s26, s60, 10
    v_lshlrev_b32 v7, 4, v0
    v_add_u32 v3, s26, v7
    v_bfe_u32 v4, v0, 2, 1
    v_lshlrev_b32 v4, 4, v4
    v_lshrrev_b32 v8, 5, v0
    v_lshl_add_u32 v4, v8, 2, v4
    v_bfe_u32 v8, v0, 3, 2
    v_add_u32 v4, v4, v8
    v_lshlrev_b32 v4, 10, v4
    v_and_b32 v8, 3, v0
    v_lshl_add_u32 v4, v8, 4, v4
    s_lshl_b32 s27, s24, 6
    s_add_u32 s81, s27, s25
    v_add_u32 v4, s81, v4
    v_bfe_u32 v5, v0, 2, 2
    v_lshl_add_u32 v5, v1, 3, v5
    v_lshlrev_b32 v5, 6, v5
    v_lshl_add_u32 v5, v8, 4, v5
    v_add_u32 v5, s25, v5
    v_lshlrev_b32 v6, 10, v2
    v_lshl_add_u32 v6, v1, 4, v6
    v_add_u32 v6, s27, v6
    s_mov_b32 s12, s22
    s_mov_b32 s13, s23
    s_mov_b32 s14, 0x400000
    s_waitcnt lgkmcnt(0)
    s_mov_b32 s40, s30
    s_mov_b32 s41, s31
    s_mov_b32 s42, 0x200000
    s_mov_b32 s43, 0x20000
    s_mov_b32 s44, s32
    s_mov_b32 s45, s33
    s_mov_b32 s46, 0x200000
    s_mov_b32 s47, 0x20000
    s_add_u32 m0, s25, 0
    s_mov_b32 s34, 0
    buffer_load_dwordx4 v4, s[12:15], s34 offen lds
    s_add_u32 m0, s25, 1024
    s_mov_b32 s34, 8192
    buffer_load_dwordx4 v4, s[12:15], s34 offen lds
    s_add_u32 m0, s25, 2048
    s_mov_b32 s34, 131072
    buffer_load_dwordx4 v4, s[12:15], s34 offen lds
    s_add_u32 m0, s25, 3072
    s_mov_b32 s34, 139264
    buffer_load_dwordx4 v4, s[12:15], s34 offen lds
    s_add_u32 m0, s25, 4096
    s_mov_b32 s34, 262144
    buffer_load_dwordx4 v4, s[12:15], s34 offen lds
    s_add_u32 m0, s25, 5120
    s_mov_b32 s34, 270336
    buffer_load_dwordx4 v4, s[12:15], s34 offen lds
    s_add_u32 m0, s25, 6144
    s_mov_b32 s34, 393216
    buffer_load_dwordx4 v4, s[12:15], s34 offen lds
    s_add_u32 m0, s25, 7168
    s_mov_b32 s34, 401408
    buffer_load_dwordx4 v4, s[12:15], s34 offen lds
    s_add_u32 m0, s25, 8192
    s_mov_b32 s34, 524288
    buffer_load_dwordx4 v4, s[12:15], s34 offen lds
    s_add_u32 m0, s25, 9216
    s_mov_b32 s34, 532480
    buffer_load_dwordx4 v4, s[12:15], s34 offen lds
    s_add_u32 m0, s25, 10240
    s_mov_b32 s34, 655360
    buffer_load_dwordx4 v4, s[12:15], s34 offen lds
    s_add_u32 m0, s25, 11264
    s_mov_b32 s34, 663552
    buffer_load_dwordx4 v4, s[12:15], s34 offen lds
    s_add_u32 m0, s25, 12288
    s_mov_b32 s34, 786432
    buffer_load_dwordx4 v4, s[12:15], s34 offen lds
    s_add_u32 m0, s25, 13312
    s_mov_b32 s34, 794624
    buffer_load_dwordx4 v4, s[12:15], s34 offen lds
    s_add_u32 m0, s25, 14336
    s_mov_b32 s34, 917504
    buffer_load_dwordx4 v4, s[12:15], s34 offen lds
    s_add_u32 m0, s25, 15360
    s_mov_b32 s34, 925696
    buffer_load_dwordx4 v4, s[12:15], s34 offen lds
    s_add_u32 m0, s25, 16384
    s_mov_b32 s34, 1048576
    buffer_load_dwordx4 v4, s[12:15], s34 offen lds
    s_add_u32 m0, s25, 17408
    s_mov_b32 s34, 1056768
    buffer_load_dwordx4 v4, s[12:15], s34 offen lds
    s_add_u32 m0, s25, 18432
    s_mov_b32 s34, 1179648
    buffer_load_dwordx4 v4, s[12:15], s34 offen lds
    s_add_u32 m0, s25, 19456
    s_mov_b32 s34, 1187840
    buffer_load_dwordx4 v4, s[12:15], s34 offen lds
    s_add_u32 m0, s25, 20480
    s_mov_b32 s34, 1310720
    buffer_load_dwordx4 v4, s[12:15], s34 offen lds
    s_add_u32 m0, s25, 21504
    s_mov_b32 s34, 1318912
    buffer_load_dwordx4 v4, s[12:15], s34 offen lds
    s_add_u32 m0, s25, 22528
    s_mov_b32 s34, 1441792
    buffer_load_dwordx4 v4, s[12:15], s34 offen lds
    s_add_u32 m0, s25, 23552
    s_mov_b32 s34, 1449984
    buffer_load_dwordx4 v4, s[12:15], s34 offen lds
    s_add_u32 m0, s25, 24576
    s_mov_b32 s34, 1572864
    buffer_load_dwordx4 v4, s[12:15], s34 offen lds
    s_add_u32 m0, s25, 25600
    s_mov_b32 s34, 1581056
    buffer_load_dwordx4 v4, s[12:15], s34 offen lds
    s_add_u32 m0, s25, 26624
    s_mov_b32 s34, 1703936
    buffer_load_dwordx4 v4, s[12:15], s34 offen lds
    s_add_u32 m0, s25, 27648
    s_mov_b32 s34, 1712128
    buffer_load_dwordx4 v4, s[12:15], s34 offen lds
    s_add_u32 m0, s25, 28672
    s_mov_b32 s34, 1835008
    buffer_load_dwordx4 v4, s[12:15], s34 offen lds
    s_add_u32 m0, s25, 29696
    s_mov_b32 s34, 1843200
    buffer_load_dwordx4 v4, s[12:15], s34 offen lds
    s_add_u32 m0, s25, 30720
    s_mov_b32 s34, 1966080
    buffer_load_dwordx4 v4, s[12:15], s34 offen lds
    s_add_u32 m0, s25, 31744
    s_mov_b32 s34, 1974272
    buffer_load_dwordx4 v4, s[12:15], s34 offen lds
    s_waitcnt vmcnt(0)
    ds_read_b64_tr_b16 a[0:1], v5 offset:0
    ds_read_b64_tr_b16 a[2:3], v5 offset:256
    ds_read_b64_tr_b16 a[4:5], v5 offset:8
    ds_read_b64_tr_b16 a[6:7], v5 offset:264
    ds_read_b64_tr_b16 a[8:9], v5 offset:2048
    ds_read_b64_tr_b16 a[10:11], v5 offset:2304
    ds_read_b64_tr_b16 a[12:13], v5 offset:2056
    ds_read_b64_tr_b16 a[14:15], v5 offset:2312
    ds_read_b64_tr_b16 a[16:17], v5 offset:4096
    ds_read_b64_tr_b16 a[18:19], v5 offset:4352
    ds_read_b64_tr_b16 a[20:21], v5 offset:4104
    ds_read_b64_tr_b16 a[22:23], v5 offset:4360
    s_waitcnt lgkmcnt(0)
    ds_read_b64_tr_b16 a[24:25], v5 offset:6144
    ds_read_b64_tr_b16 a[26:27], v5 offset:6400
    ds_read_b64_tr_b16 a[28:29], v5 offset:6152
    ds_read_b64_tr_b16 a[30:31], v5 offset:6408
    ds_read_b64_tr_b16 a[32:33], v5 offset:8192
    ds_read_b64_tr_b16 a[34:35], v5 offset:8448
    ds_read_b64_tr_b16 a[36:37], v5 offset:8200
    ds_read_b64_tr_b16 a[38:39], v5 offset:8456
    ds_read_b64_tr_b16 a[40:41], v5 offset:10240
    ds_read_b64_tr_b16 a[42:43], v5 offset:10496
    ds_read_b64_tr_b16 a[44:45], v5 offset:10248
    ds_read_b64_tr_b16 a[46:47], v5 offset:10504
    s_waitcnt lgkmcnt(0)
    ds_read_b64_tr_b16 a[48:49], v5 offset:12288
    ds_read_b64_tr_b16 a[50:51], v5 offset:12544
    ds_read_b64_tr_b16 a[52:53], v5 offset:12296
    ds_read_b64_tr_b16 a[54:55], v5 offset:12552
    ds_read_b64_tr_b16 a[56:57], v5 offset:14336
    ds_read_b64_tr_b16 a[58:59], v5 offset:14592
    ds_read_b64_tr_b16 a[60:61], v5 offset:14344
    ds_read_b64_tr_b16 a[62:63], v5 offset:14600
    ds_read_b64_tr_b16 a[64:65], v5 offset:16384
    ds_read_b64_tr_b16 a[66:67], v5 offset:16640
    ds_read_b64_tr_b16 a[68:69], v5 offset:16392
    ds_read_b64_tr_b16 a[70:71], v5 offset:16648
    s_waitcnt lgkmcnt(0)
    ds_read_b64_tr_b16 a[72:73], v5 offset:18432
    ds_read_b64_tr_b16 a[74:75], v5 offset:18688
    ds_read_b64_tr_b16 a[76:77], v5 offset:18440
    ds_read_b64_tr_b16 a[78:79], v5 offset:18696
    ds_read_b64_tr_b16 a[80:81], v5 offset:20480
    ds_read_b64_tr_b16 a[82:83], v5 offset:20736
    ds_read_b64_tr_b16 a[84:85], v5 offset:20488
    ds_read_b64_tr_b16 a[86:87], v5 offset:20744
    ds_read_b64_tr_b16 a[88:89], v5 offset:22528
    ds_read_b64_tr_b16 a[90:91], v5 offset:22784
    ds_read_b64_tr_b16 a[92:93], v5 offset:22536
    ds_read_b64_tr_b16 a[94:95], v5 offset:22792
    s_waitcnt lgkmcnt(0)
    ds_read_b64_tr_b16 a[96:97], v5 offset:24576
    ds_read_b64_tr_b16 a[98:99], v5 offset:24832
    ds_read_b64_tr_b16 a[100:101], v5 offset:24584
    ds_read_b64_tr_b16 a[102:103], v5 offset:24840
    ds_read_b64_tr_b16 a[104:105], v5 offset:26624
    ds_read_b64_tr_b16 a[106:107], v5 offset:26880
    ds_read_b64_tr_b16 a[108:109], v5 offset:26632
    ds_read_b64_tr_b16 a[110:111], v5 offset:26888
    ds_read_b64_tr_b16 a[112:113], v5 offset:28672
    ds_read_b64_tr_b16 a[114:115], v5 offset:28928
    ds_read_b64_tr_b16 a[116:117], v5 offset:28680
    ds_read_b64_tr_b16 a[118:119], v5 offset:28936
    s_waitcnt lgkmcnt(0)
    ds_read_b64_tr_b16 a[120:121], v5 offset:30720
    ds_read_b64_tr_b16 a[122:123], v5 offset:30976
    ds_read_b64_tr_b16 a[124:125], v5 offset:30728
    ds_read_b64_tr_b16 a[126:127], v5 offset:30984
    s_waitcnt lgkmcnt(0)
    s_add_u32 m0, s25, 0
    s_mov_b32 s34, 2097152
    buffer_load_dwordx4 v4, s[12:15], s34 offen lds
    s_add_u32 m0, s25, 1024
    s_mov_b32 s34, 2105344
    buffer_load_dwordx4 v4, s[12:15], s34 offen lds
    s_add_u32 m0, s25, 2048
    s_mov_b32 s34, 2228224
    buffer_load_dwordx4 v4, s[12:15], s34 offen lds
    s_add_u32 m0, s25, 3072
    s_mov_b32 s34, 2236416
    buffer_load_dwordx4 v4, s[12:15], s34 offen lds
    s_add_u32 m0, s25, 4096
    s_mov_b32 s34, 2359296
    buffer_load_dwordx4 v4, s[12:15], s34 offen lds
    s_add_u32 m0, s25, 5120
    s_mov_b32 s34, 2367488
    buffer_load_dwordx4 v4, s[12:15], s34 offen lds
    s_add_u32 m0, s25, 6144
    s_mov_b32 s34, 2490368
    buffer_load_dwordx4 v4, s[12:15], s34 offen lds
    s_add_u32 m0, s25, 7168
    s_mov_b32 s34, 2498560
    buffer_load_dwordx4 v4, s[12:15], s34 offen lds
    s_add_u32 m0, s25, 8192
    s_mov_b32 s34, 2621440
    buffer_load_dwordx4 v4, s[12:15], s34 offen lds
    s_add_u32 m0, s25, 9216
    s_mov_b32 s34, 2629632
    buffer_load_dwordx4 v4, s[12:15], s34 offen lds
    s_add_u32 m0, s25, 10240
    s_mov_b32 s34, 2752512
    buffer_load_dwordx4 v4, s[12:15], s34 offen lds
    s_add_u32 m0, s25, 11264
    s_mov_b32 s34, 2760704
    buffer_load_dwordx4 v4, s[12:15], s34 offen lds
    s_add_u32 m0, s25, 12288
    s_mov_b32 s34, 2883584
    buffer_load_dwordx4 v4, s[12:15], s34 offen lds
    s_add_u32 m0, s25, 13312
    s_mov_b32 s34, 2891776
    buffer_load_dwordx4 v4, s[12:15], s34 offen lds
    s_add_u32 m0, s25, 14336
    s_mov_b32 s34, 3014656
    buffer_load_dwordx4 v4, s[12:15], s34 offen lds
    s_add_u32 m0, s25, 15360
    s_mov_b32 s34, 3022848
    buffer_load_dwordx4 v4, s[12:15], s34 offen lds
    s_add_u32 m0, s25, 16384
    s_mov_b32 s34, 3145728
    buffer_load_dwordx4 v4, s[12:15], s34 offen lds
    s_add_u32 m0, s25, 17408
    s_mov_b32 s34, 3153920
    buffer_load_dwordx4 v4, s[12:15], s34 offen lds
    s_add_u32 m0, s25, 18432
    s_mov_b32 s34, 3276800
    buffer_load_dwordx4 v4, s[12:15], s34 offen lds
    s_add_u32 m0, s25, 19456
    s_mov_b32 s34, 3284992
    buffer_load_dwordx4 v4, s[12:15], s34 offen lds
    s_add_u32 m0, s25, 20480
    s_mov_b32 s34, 3407872
    buffer_load_dwordx4 v4, s[12:15], s34 offen lds
    s_add_u32 m0, s25, 21504
    s_mov_b32 s34, 3416064
    buffer_load_dwordx4 v4, s[12:15], s34 offen lds
    s_add_u32 m0, s25, 22528
    s_mov_b32 s34, 3538944
    buffer_load_dwordx4 v4, s[12:15], s34 offen lds
    s_add_u32 m0, s25, 23552
    s_mov_b32 s34, 3547136
    buffer_load_dwordx4 v4, s[12:15], s34 offen lds
    s_add_u32 m0, s25, 24576
    s_mov_b32 s34, 3670016
    buffer_load_dwordx4 v4, s[12:15], s34 offen lds
    s_add_u32 m0, s25, 25600
    s_mov_b32 s34, 3678208
    buffer_load_dwordx4 v4, s[12:15], s34 offen lds
    s_add_u32 m0, s25, 26624
    s_mov_b32 s34, 3801088
    buffer_load_dwordx4 v4, s[12:15], s34 offen lds
    s_add_u32 m0, s25, 27648
    s_mov_b32 s34, 3809280
    buffer_load_dwordx4 v4, s[12:15], s34 offen lds
    s_add_u32 m0, s25, 28672
    s_mov_b32 s34, 3932160
    buffer_load_dwordx4 v4, s[12:15], s34 offen lds
    s_add_u32 m0, s25, 29696
    s_mov_b32 s34, 3940352
    buffer_load_dwordx4 v4, s[12:15], s34 offen lds
    s_add_u32 m0, s25, 30720
    s_mov_b32 s34, 4063232
    buffer_load_dwordx4 v4, s[12:15], s34 offen lds
    s_add_u32 m0, s25, 31744
    s_mov_b32 s34, 4071424
    buffer_load_dwordx4 v4, s[12:15], s34 offen lds
    s_waitcnt vmcnt(0)
    ds_read_b64_tr_b16 a[128:129], v5 offset:0
    ds_read_b64_tr_b16 a[130:131], v5 offset:256
    ds_read_b64_tr_b16 a[132:133], v5 offset:8
    ds_read_b64_tr_b16 a[134:135], v5 offset:264
    ds_read_b64_tr_b16 a[136:137], v5 offset:2048
    ds_read_b64_tr_b16 a[138:139], v5 offset:2304
    ds_read_b64_tr_b16 a[140:141], v5 offset:2056
    ds_read_b64_tr_b16 a[142:143], v5 offset:2312
    ds_read_b64_tr_b16 a[144:145], v5 offset:4096
    ds_read_b64_tr_b16 a[146:147], v5 offset:4352
    ds_read_b64_tr_b16 a[148:149], v5 offset:4104
    ds_read_b64_tr_b16 a[150:151], v5 offset:4360
    s_waitcnt lgkmcnt(0)
    ds_read_b64_tr_b16 a[152:153], v5 offset:6144
    ds_read_b64_tr_b16 a[154:155], v5 offset:6400
    ds_read_b64_tr_b16 a[156:157], v5 offset:6152
    ds_read_b64_tr_b16 a[158:159], v5 offset:6408
    ds_read_b64_tr_b16 a[160:161], v5 offset:8192
    ds_read_b64_tr_b16 a[162:163], v5 offset:8448
    ds_read_b64_tr_b16 a[164:165], v5 offset:8200
    ds_read_b64_tr_b16 a[166:167], v5 offset:8456
    ds_read_b64_tr_b16 a[168:169], v5 offset:10240
    ds_read_b64_tr_b16 a[170:171], v5 offset:10496
    ds_read_b64_tr_b16 a[172:173], v5 offset:10248
    ds_read_b64_tr_b16 a[174:175], v5 offset:10504
    s_waitcnt lgkmcnt(0)
    ds_read_b64_tr_b16 a[176:177], v5 offset:12288
    ds_read_b64_tr_b16 a[178:179], v5 offset:12544
    ds_read_b64_tr_b16 a[180:181], v5 offset:12296
    ds_read_b64_tr_b16 a[182:183], v5 offset:12552
    ds_read_b64_tr_b16 a[184:185], v5 offset:14336
    ds_read_b64_tr_b16 a[186:187], v5 offset:14592
    ds_read_b64_tr_b16 a[188:189], v5 offset:14344
    ds_read_b64_tr_b16 a[190:191], v5 offset:14600
    ds_read_b64_tr_b16 a[192:193], v5 offset:16384
    ds_read_b64_tr_b16 a[194:195], v5 offset:16640
    ds_read_b64_tr_b16 a[196:197], v5 offset:16392
    ds_read_b64_tr_b16 a[198:199], v5 offset:16648
    s_waitcnt lgkmcnt(0)
    ds_read_b64_tr_b16 a[200:201], v5 offset:18432
    ds_read_b64_tr_b16 a[202:203], v5 offset:18688
    ds_read_b64_tr_b16 a[204:205], v5 offset:18440
    ds_read_b64_tr_b16 a[206:207], v5 offset:18696
    ds_read_b64_tr_b16 a[208:209], v5 offset:20480
    ds_read_b64_tr_b16 a[210:211], v5 offset:20736
    ds_read_b64_tr_b16 a[212:213], v5 offset:20488
    ds_read_b64_tr_b16 a[214:215], v5 offset:20744
    ds_read_b64_tr_b16 a[216:217], v5 offset:22528
    ds_read_b64_tr_b16 a[218:219], v5 offset:22784
    ds_read_b64_tr_b16 a[220:221], v5 offset:22536
    ds_read_b64_tr_b16 a[222:223], v5 offset:22792
    s_waitcnt lgkmcnt(0)
    ds_read_b64_tr_b16 a[224:225], v5 offset:24576
    ds_read_b64_tr_b16 a[226:227], v5 offset:24832
    ds_read_b64_tr_b16 a[228:229], v5 offset:24584
    ds_read_b64_tr_b16 a[230:231], v5 offset:24840
    ds_read_b64_tr_b16 a[232:233], v5 offset:26624
    ds_read_b64_tr_b16 a[234:235], v5 offset:26880
    ds_read_b64_tr_b16 a[236:237], v5 offset:26632
    ds_read_b64_tr_b16 a[238:239], v5 offset:26888
    ds_read_b64_tr_b16 a[240:241], v5 offset:28672
    ds_read_b64_tr_b16 a[242:243], v5 offset:28928
    ds_read_b64_tr_b16 a[244:245], v5 offset:28680
    ds_read_b64_tr_b16 a[246:247], v5 offset:28936
    s_waitcnt lgkmcnt(0)
    ds_read_b64_tr_b16 a[248:249], v5 offset:30720
    ds_read_b64_tr_b16 a[250:251], v5 offset:30976
    ds_read_b64_tr_b16 a[252:253], v5 offset:30728
    ds_read_b64_tr_b16 a[254:255], v5 offset:30984
    s_waitcnt lgkmcnt(0)
    s_mov_b32 s12, s28
    s_mov_b32 s13, s29
    s_mov_b32 s14, 1835008
    s_add_u32 m0, s25, 0
    s_mov_b32 s34, 0
    buffer_load_dwordx4 v4, s[12:15], s34 offen lds
    s_add_u32 m0, s25, 1024
    s_mov_b32 s34, 8192
    buffer_load_dwordx4 v4, s[12:15], s34 offen lds
    s_add_u32 m0, s25, 2048
    s_mov_b32 s34, 131072
    buffer_load_dwordx4 v4, s[12:15], s34 offen lds
    s_add_u32 m0, s25, 3072
    s_mov_b32 s34, 139264
    buffer_load_dwordx4 v4, s[12:15], s34 offen lds
    s_add_u32 m0, s25, 4096
    s_mov_b32 s34, 262144
    buffer_load_dwordx4 v4, s[12:15], s34 offen lds
    s_add_u32 m0, s25, 5120
    s_mov_b32 s34, 270336
    buffer_load_dwordx4 v4, s[12:15], s34 offen lds
    s_add_u32 m0, s25, 6144
    s_mov_b32 s34, 393216
    buffer_load_dwordx4 v4, s[12:15], s34 offen lds
    s_add_u32 m0, s25, 7168
    s_mov_b32 s34, 401408
    buffer_load_dwordx4 v4, s[12:15], s34 offen lds
    s_add_u32 m0, s25, 8192
    s_mov_b32 s34, 524288
    buffer_load_dwordx4 v4, s[12:15], s34 offen lds
    s_add_u32 m0, s25, 9216
    s_mov_b32 s34, 532480
    buffer_load_dwordx4 v4, s[12:15], s34 offen lds
    s_add_u32 m0, s25, 10240
    s_mov_b32 s34, 655360
    buffer_load_dwordx4 v4, s[12:15], s34 offen lds
    s_add_u32 m0, s25, 11264
    s_mov_b32 s34, 663552
    buffer_load_dwordx4 v4, s[12:15], s34 offen lds
    s_add_u32 m0, s25, 12288
    s_mov_b32 s34, 786432
    buffer_load_dwordx4 v4, s[12:15], s34 offen lds
    s_add_u32 m0, s25, 13312
    s_mov_b32 s34, 794624
    buffer_load_dwordx4 v4, s[12:15], s34 offen lds
    s_add_u32 m0, s25, 14336
    s_mov_b32 s34, 917504
    buffer_load_dwordx4 v4, s[12:15], s34 offen lds
    s_add_u32 m0, s25, 15360
    s_mov_b32 s34, 925696
    buffer_load_dwordx4 v4, s[12:15], s34 offen lds
    s_add_u32 m0, s25, 16384
    s_mov_b32 s34, 1048576
    buffer_load_dwordx4 v4, s[12:15], s34 offen lds
    s_add_u32 m0, s25, 17408
    s_mov_b32 s34, 1056768
    buffer_load_dwordx4 v4, s[12:15], s34 offen lds
    s_add_u32 m0, s25, 18432
    s_mov_b32 s34, 1179648
    buffer_load_dwordx4 v4, s[12:15], s34 offen lds
    s_add_u32 m0, s25, 19456
    s_mov_b32 s34, 1187840
    buffer_load_dwordx4 v4, s[12:15], s34 offen lds
    s_add_u32 m0, s25, 20480
    s_mov_b32 s34, 1310720
    buffer_load_dwordx4 v4, s[12:15], s34 offen lds
    s_add_u32 m0, s25, 21504
    s_mov_b32 s34, 1318912
    buffer_load_dwordx4 v4, s[12:15], s34 offen lds
    s_add_u32 m0, s25, 22528
    s_mov_b32 s34, 1441792
    buffer_load_dwordx4 v4, s[12:15], s34 offen lds
    s_add_u32 m0, s25, 23552
    s_mov_b32 s34, 1449984
    buffer_load_dwordx4 v4, s[12:15], s34 offen lds
    s_add_u32 m0, s25, 24576
    s_mov_b32 s34, 1572864
    buffer_load_dwordx4 v4, s[12:15], s34 offen lds
    s_add_u32 m0, s25, 25600
    s_mov_b32 s34, 1581056
    buffer_load_dwordx4 v4, s[12:15], s34 offen lds
    s_add_u32 m0, s25, 26624
    s_mov_b32 s34, 1703936
    buffer_load_dwordx4 v4, s[12:15], s34 offen lds
    s_add_u32 m0, s25, 27648
    s_mov_b32 s34, 1712128
    buffer_load_dwordx4 v4, s[12:15], s34 offen lds
L_g2_seg:
    s_lshr_b32 s81, s85, 3
    s_lshl_b32 s81, s81, 2
    s_add_u32 s81, s81, 87098368
    s_mov_b32 s75, 0
L_wf_g1:
    buffer_load_dword v14, v12, s[4:7], s81 offen sc0 sc1
    s_add_u32 s75, s75, 1
    s_cmp_lt_u32 s75, 65536
    s_cbranch_scc0 L_rec_exit
    s_waitcnt vmcnt(0)
    v_readfirstlane_b32 s84, v14
    s_nop 0
    s_cmp_eq_u32 s84, 7
    s_cbranch_scc1 L_wfd_g1
    s_sleep 8
    s_branch L_wf_g1
L_wfd_g1:
    s_mul_i32 s35, s85, 57344
    s_add_u32 s35, s35, 69206016
    s_lshl_b32 s36, s85, 14
    buffer_load_dwordx4 v[40:43], v6, s[44:47], s36 offen
    s_add_u32 s34, s35, 0
    buffer_load_dwordx4 v[44:47], v3, s[4:7], s34 offen sc1
    s_add_u32 s34, s35, 4096
    buffer_load_dwordx4 v[48:51], v3, s[4:7], s34 offen sc1
    s_add_u32 s34, s35, 8192
    buffer_load_dwordx4 v[52:55], v3, s[4:7], s34 offen sc1
    s_add_u32 s34, s35, 12288
    buffer_load_dwordx4 v[56:59], v3, s[4:7], s34 offen sc1
    s_add_u32 s34, s35, 16384
    buffer_load_dwordx4 v[60:63], v3, s[4:7], s34 offen sc1
    s_add_u32 s34, s35, 20480
    buffer_load_dwordx4 v[64:67], v3, s[4:7], s34 offen sc1
    s_add_u32 s34, s35, 24576
    buffer_load_dwordx4 v[68:71], v3, s[4:7], s34 offen sc1
    s_add_u32 s34, s35, 28672
    buffer_load_dwordx4 v[72:75], v3, s[4:7], s34 offen sc1
    s_add_u32 s34, s35, 32768
    buffer_load_dwordx4 v[76:79], v3, s[4:7], s34 offen sc1
    s_add_u32 s34, s35, 36864
    buffer_load_dwordx4 v[80:83], v3, s[4:7], s34 offen sc1
    s_add_u32 s34, s35, 40960
    buffer_load_dwordx4 v[84:87], v3, s[4:7], s34 offen sc1
    s_add_u32 s34, s35, 45056
    buffer_load_dwordx4 v[88:91], v3, s[4:7], s34 offen sc1
    s_add_u32 s34, s35, 49152
    buffer_load_dwordx4 v[92:95], v3, s[4:7], s34 offen sc1
    s_add_u32 s34, s35, 53248
    buffer_load_dwordx4 v[96:99], v3, s[4:7], s34 offen sc1
    ds_read_b64_tr_b16 v[32:33], v5 offset:0
    ds_read_b64_tr_b16 v[34:35], v5 offset:256
    ds_read_b64_tr_b16 v[36:37], v5 offset:8
    ds_read_b64_tr_b16 v[38:39], v5 offset:264
    s_waitcnt vmcnt(13) lgkmcnt(0)
    v_mfma_f32_16x16x32_bf16 v[16:19], v[32:35], v[44:47], 0
    v_mfma_f32_16x16x32_bf16 v[20:23], v[36:39], v[44:47], 0
    ds_read_b64_tr_b16 v[32:33], v5 offset:2048
    ds_read_b64_tr_b16 v[34:35], v5 offset:2304
    ds_read_b64_tr_b16 v[36:37], v5 offset:2056
    ds_read_b64_tr_b16 v[38:39], v5 offset:2312
    s_waitcnt vmcnt(12) lgkmcnt(0)
    v_mfma_f32_16x16x32_bf16 v[16:19], v[32:35], v[48:51], v[16:19]
    v_mfma_f32_16x16x32_bf16 v[20:23], v[36:39], v[48:51], v[20:23]
    ds_read_b64_tr_b16 v[32:33], v5 offset:4096
    ds_read_b64_tr_b16 v[34:35], v5 offset:4352
    ds_read_b64_tr_b16 v[36:37], v5 offset:4104
    ds_read_b64_tr_b16 v[38:39], v5 offset:4360
    s_waitcnt vmcnt(11) lgkmcnt(0)
    v_mfma_f32_16x16x32_bf16 v[16:19], v[32:35], v[52:55], v[16:19]
    v_mfma_f32_16x16x32_bf16 v[20:23], v[36:39], v[52:55], v[20:23]
    ds_read_b64_tr_b16 v[32:33], v5 offset:6144
    ds_read_b64_tr_b16 v[34:35], v5 offset:6400
    ds_read_b64_tr_b16 v[36:37], v5 offset:6152
    ds_read_b64_tr_b16 v[38:39], v5 offset:6408
    s_waitcnt vmcnt(10) lgkmcnt(0)
    v_mfma_f32_16x16x32_bf16 v[16:19], v[32:35], v[56:59], v[16:19]
    v_mfma_f32_16x16x32_bf16 v[20:23], v[36:39], v[56:59], v[20:23]
    ds_read_b64_tr_b16 v[32:33], v5 offset:8192
    ds_read_b64_tr_b16 v[34:35], v5 offset:8448
    ds_read_b64_tr_b16 v[36:37], v5 offset:8200
    ds_read_b64_tr_b16 v[38:39], v5 offset:8456
    s_waitcnt vmcnt(9) lgkmcnt(0)
    v_mfma_f32_16x16x32_bf16 v[16:19], v[32:35], v[60:63], v[16:19]
    v_mfma_f32_16x16x32_bf16 v[20:23], v[36:39], v[60:63], v[20:23]
    ds_read_b64_tr_b16 v[32:33], v5 offset:10240
    ds_read_b64_tr_b16 v[34:35], v5 offset:10496
    ds_read_b64_tr_b16 v[36:37], v5 offset:10248
    ds_read_b64_tr_b16 v[38:39], v5 offset:10504
    s_waitcnt vmcnt(8) lgkmcnt(0)
    v_mfma_f32_16x16x32_bf16 v[16:19], v[32:35], v[64:67], v[16:19]
    v_mfma_f32_16x16x32_bf16 v[20:23], v[36:39], v[64:67], v[20:23]
    ds_read_b64_tr_b16 v[32:33], v5 offset:12288
    ds_read_b64_tr_b16 v[34:35], v5 offset:12544
    ds_read_b64_tr_b16 v[36:37], v5 offset:12296
    ds_read_b64_tr_b16 v[38:39], v5 offset:12552
    s_waitcnt vmcnt(7) lgkmcnt(0)
    v_mfma_f32_16x16x32_bf16 v[16:19], v[32:35], v[68:71], v[16:19]
    v_mfma_f32_16x16x32_bf16 v[20:23], v[36:39], v[68:71], v[20:23]
    ds_read_b64_tr_b16 v[32:33], v5 offset:14336
    ds_read_b64_tr_b16 v[34:35], v5 offset:14592
    ds_read_b64_tr_b16 v[36:37], v5 offset:14344
    ds_read_b64_tr_b16 v[38:39], v5 offset:14600
    s_waitcnt vmcnt(6) lgkmcnt(0)
    v_mfma_f32_16x16x32_bf16 v[16:19], v[32:35], v[72:75], v[16:19]
    v_mfma_f32_16x16x32_bf16 v[20:23], v[36:39], v[72:75], v[20:23]
    ds_read_b64_tr_b16 v[32:33], v5 offset:16384
    ds_read_b64_tr_b16 v[34:35], v5 offset:16640
    ds_read_b64_tr_b16 v[36:37], v5 offset:16392
    ds_read_b64_tr_b16 v[38:39], v5 offset:16648
    s_waitcnt vmcnt(5) lgkmcnt(0)
    v_mfma_f32_16x16x32_bf16 v[16:19], v[32:35], v[76:79], v[16:19]
    v_mfma_f32_16x16x32_bf16 v[20:23], v[36:39], v[76:79], v[20:23]
    ds_read_b64_tr_b16 v[32:33], v5 offset:18432
    ds_read_b64_tr_b16 v[34:35], v5 offset:18688
    ds_read_b64_tr_b16 v[36:37], v5 offset:18440
    ds_read_b64_tr_b16 v[38:39], v5 offset:18696
    s_waitcnt vmcnt(4) lgkmcnt(0)
    v_mfma_f32_16x16x32_bf16 v[16:19], v[32:35], v[80:83], v[16:19]
    v_mfma_f32_16x16x32_bf16 v[20:23], v[36:39], v[80:83], v[20:23]
    ds_read_b64_tr_b16 v[32:33], v5 offset:20480
    ds_read_b64_tr_b16 v[34:35], v5 offset:20736
    ds_read_b64_tr_b16 v[36:37], v5 offset:20488
    ds_read_b64_tr_b16 v[38:39], v5 offset:20744
    s_waitcnt vmcnt(3) lgkmcnt(0)
    v_mfma_f32_16x16x32_bf16 v[16:19], v[32:35], v[84:87], v[16:19]
    v_mfma_f32_16x16x32_bf16 v[20:23], v[36:39], v[84:87], v[20:23]
    ds_read_b64_tr_b16 v[32:33], v5 offset:22528
    ds_read_b64_tr_b16 v[34:35], v5 offset:22784
    ds_read_b64_tr_b16 v[36:37], v5 offset:22536
    ds_read_b64_tr_b16 v[38:39], v5 offset:22792
    s_waitcnt vmcnt(2) lgkmcnt(0)
    v_mfma_f32_16x16x32_bf16 v[16:19], v[32:35], v[88:91], v[16:19]
    v_mfma_f32_16x16x32_bf16 v[20:23], v[36:39], v[88:91], v[20:23]
    ds_read_b64_tr_b16 v[32:33], v5 offset:24576
    ds_read_b64_tr_b16 v[34:35], v5 offset:24832
    ds_read_b64_tr_b16 v[36:37], v5 offset:24584
    ds_read_b64_tr_b16 v[38:39], v5 offset:24840
    s_waitcnt vmcnt(1) lgkmcnt(0)
    v_mfma_f32_16x16x32_bf16 v[16:19], v[32:35], v[92:95], v[16:19]
    v_mfma_f32_16x16x32_bf16 v[20:23], v[36:39], v[92:95], v[20:23]
    ds_read_b64_tr_b16 v[32:33], v5 offset:26624
    ds_read_b64_tr_b16 v[34:35], v5 offset:26880
    ds_read_b64_tr_b16 v[36:37], v5 offset:26632
    ds_read_b64_tr_b16 v[38:39], v5 offset:26888
    s_waitcnt vmcnt(0) lgkmcnt(0)
    v_mfma_f32_16x16x32_bf16 v[16:19], v[32:35], v[96:99], v[16:19]
    v_mfma_f32_16x16x32_bf16 v[20:23], v[36:39], v[96:99], v[20:23]
    s_lshr_b32 s81, s85, 1
    s_lshl_b32 s81, s81, 6
    s_add_u32 s81, s81, 87101440
    s_lshl_b32 s35, s85, 17
    s_add_u32 s35, s35, 52428800
    s_cmp_lg_u32 s60, 0
    s_cbranch_scc1 L_wfd_g2
    s_mov_b32 s75, 0
L_wf_g2:
    buffer_load_dword v14, v12, s[4:7], s81 offen sc0 sc1
    s_add_u32 s75, s75, 1
    s_cmp_lt_u32 s75, 65536
    s_cbranch_scc0 L_rec_exit
    s_waitcnt vmcnt(0)
    v_readfirstlane_b32 s84, v14
    s_nop 0
    s_cmp_eq_u32 s84, 8
    s_cbranch_scc1 L_wfd_g2
    s_sleep 2
    s_cmp_lg_u32 s84, 0
    s_cbranch_scc1 L_wf_g2
    s_sleep 6
    s_branch L_wf_g2
L_wfd_g2:
    s_barrier
    s_add_u32 s34, s35, 0
    buffer_load_dwordx4 v[44:47], v3, s[4:7], s34 offen sc1
    s_add_u32 s34, s35, 4096
    buffer_load_dwordx4 v[48:51], v3, s[4:7], s34 offen sc1
    s_add_u32 s34, s35, 8192
    buffer_load_dwordx4 v[52:55], v3, s[4:7], s34 offen sc1
    s_add_u32 s34, s35, 12288
    buffer_load_dwordx4 v[56:59], v3, s[4:7], s34 offen sc1
    s_add_u32 s34, s35, 16384
    buffer_load_dwordx4 v[60:63], v3, s[4:7], s34 offen sc1
    s_add_u32 s34, s35, 20480
    buffer_load_dwordx4 v[64:67], v3, s[4:7], s34 offen sc1
    s_add_u32 s34, s35, 24576
    buffer_load_dwordx4 v[68:71], v3, s[4:7], s34 offen sc1
    s_add_u32 s34, s35, 28672
    buffer_load_dwordx4 v[72:75], v3, s[4:7], s34 offen sc1
    s_add_u32 s34, s35, 32768
    buffer_load_dwordx4 v[76:79], v3, s[4:7], s34 offen sc1
    s_add_u32 s34, s35, 36864
    buffer_load_dwordx4 v[80:83], v3, s[4:7], s34 offen sc1
    s_add_u32 s34, s35, 40960
    buffer_load_dwordx4 v[84:87], v3, s[4:7], s34 offen sc1
    s_add_u32 s34, s35, 45056
    buffer_load_dwordx4 v[88:91], v3, s[4:7], s34 offen sc1
    s_add_u32 s34, s35, 49152
    buffer_load_dwordx4 v[92:95], v3, s[4:7], s34 offen sc1
    s_add_u32 s34, s35, 53248
    buffer_load_dwordx4 v[96:99], v3, s[4:7], s34 offen sc1
    s_add_u32 s34, s35, 57344
    buffer_load_dwordx4 v[100:103], v3, s[4:7], s34 offen sc1
    s_add_u32 s34, s35, 61440
    buffer_load_dwordx4 v[104:107], v3, s[4:7], s34 offen sc1
    s_add_u32 s34, s35, 65536
    buffer_load_dwordx4 v[108:111], v3, s[4:7], s34 offen sc1
    s_add_u32 s34, s35, 69632
    buffer_load_dwordx4 v[112:115], v3, s[4:7], s34 offen sc1
    s_add_u32 s34, s35, 73728
    buffer_load_dwordx4 v[116:119], v3, s[4:7], s34 offen sc1
    s_add_u32 s34, s35, 77824
    buffer_load_dwordx4 v[120:123], v3, s[4:7], s34 offen sc1
    s_add_u32 s34, s35, 81920
    buffer_load_dwordx4 v[124:127], v3, s[4:7], s34 offen sc1
    s_add_u32 s34, s35, 86016
    buffer_load_dwordx4 v[128:131], v3, s[4:7], s34 offen sc1
    s_add_u32 s34, s35, 90112
    buffer_load_dwordx4 v[132:135], v3, s[4:7], s34 offen sc1
    s_add_u32 s34, s35, 94208
    buffer_load_dwordx4 v[136:139], v3, s[4:7], s34 offen sc1
    s_add_u32 s34, s35, 98304
    buffer_load_dwordx4 v[140:143], v3, s[4:7], s34 offen sc1
    s_add_u32 s34, s35, 102400
    buffer_load_dwordx4 v[144:147], v3, s[4:7], s34 offen sc1
    s_add_u32 s34, s35, 106496
    buffer_load_dwordx4 v[148:151], v3, s[4:7], s34 offen sc1
    s_add_u32 s34, s35, 110592
    buffer_load_dwordx4 v[152:155], v3, s[4:7], s34 offen sc1
    s_add_u32 s34, s35, 114688
    buffer_load_dwordx4 v[156:159], v3, s[4:7], s34 offen sc1
    s_add_u32 s34, s35, 118784
    buffer_load_dwordx4 v[160:163], v3, s[4:7], s34 offen sc1
    s_add_u32 s34, s35, 122880
    buffer_load_dwordx4 v[164:167], v3, s[4:7], s34 offen sc1
    s_add_u32 s34, s35, 126976
    buffer_load_dwordx4 v[168:171], v3, s[4:7], s34 offen sc1
    s_waitcnt vmcnt(31)
    v_mfma_f32_16x16x32_bf16 v[16:19], a[0:3], v[44:47], v[16:19]
    v_mfma_f32_16x16x32_bf16 v[20:23], a[4:7], v[44:47], v[20:23]
    s_waitcnt vmcnt(30)
    v_mfma_f32_16x16x32_bf16 v[16:19], a[8:11], v[48:51], v[16:19]
    v_mfma_f32_16x16x32_bf16 v[20:23], a[12:15], v[48:51], v[20:23]
    s_waitcnt vmcnt(29)
    v_mfma_f32_16x16x32_bf16 v[16:19], a[16:19], v[52:55], v[16:19]
    v_mfma_f32_16x16x32_bf16 v[20:23], a[20:23], v[52:55], v[20:23]
    s_waitcnt vmcnt(28)
    v_mfma_f32_16x16x32_bf16 v[16:19], a[24:27], v[56:59], v[16:19]
    v_mfma_f32_16x16x32_bf16 v[20:23], a[28:31], v[56:59], v[20:23]
    s_waitcnt vmcnt(27)
    v_mfma_f32_16x16x32_bf16 v[16:19], a[32:35], v[60:63], v[16:19]
    v_mfma_f32_16x16x32_bf16 v[20:23], a[36:39], v[60:63], v[20:23]
    s_waitcnt vmcnt(26)
    v_mfma_f32_16x16x32_bf16 v[16:19], a[40:43], v[64:67], v[16:19]
    v_mfma_f32_16x16x32_bf16 v[20:23], a[44:47], v[64:67], v[20:23]
    s_waitcnt vmcnt(25)
    v_mfma_f32_16x16x32_bf16 v[16:19], a[48:51], v[68:71], v[16:19]
    v_mfma_f32_16x16x32_bf16 v[20:23], a[52:55], v[68:71], v[20:23]
    s_waitcnt vmcnt(24)
    v_mfma_f32_16x16x32_bf16 v[16:19], a[56:59], v[72:75], v[16:19]
    v_mfma_f32_16x16x32_bf16 v[20:23], a[60:63], v[72:75], v[20:23]
    s_waitcnt vmcnt(23)
    v_mfma_f32_16x16x32_bf16 v[16:19], a[64:67], v[76:79], v[16:19]
    v_mfma_f32_16x16x32_bf16 v[20:23], a[68:71], v[76:79], v[20:23]
    s_waitcnt vmcnt(22)
    v_mfma_f32_16x16x32_bf16 v[16:19], a[72:75], v[80:83], v[16:19]
    v_mfma_f32_16x16x32_bf16 v[20:23], a[76:79], v[80:83], v[20:23]
    s_waitcnt vmcnt(21)
    v_mfma_f32_16x16x32_bf16 v[16:19], a[80:83], v[84:87], v[16:19]
    v_mfma_f32_16x16x32_bf16 v[20:23], a[84:87], v[84:87], v[20:23]
    s_waitcnt vmcnt(20)
    v_mfma_f32_16x16x32_bf16 v[16:19], a[88:91], v[88:91], v[16:19]
    v_mfma_f32_16x16x32_bf16 v[20:23], a[92:95], v[88:91], v[20:23]
    s_waitcnt vmcnt(19)
    v_mfma_f32_16x16x32_bf16 v[16:19], a[96:99], v[92:95], v[16:19]
    v_mfma_f32_16x16x32_bf16 v[20:23], a[100:103], v[92:95], v[20:23]
    s_waitcnt vmcnt(18)
    v_mfma_f32_16x16x32_bf16 v[16:19], a[104:107], v[96:99], v[16:19]
    v_mfma_f32_16x16x32_bf16 v[20:23], a[108:111], v[96:99], v[20:23]
    s_waitcnt vmcnt(17)
    v_mfma_f32_16x16x32_bf16 v[16:19], a[112:115], v[100:103], v[16:19]
    v_mfma_f32_16x16x32_bf16 v[20:23], a[116:119], v[100:103], v[20:23]
    s_waitcnt vmcnt(16)
    v_mfma_f32_16x16x32_bf16 v[16:19], a[120:123], v[104:107], v[16:19]
    v_mfma_f32_16x16x32_bf16 v[20:23], a[124:127], v[104:107], v[20:23]
    s_waitcnt vmcnt(15)
    v_mfma_f32_16x16x32_bf16 v[16:19], a[128:131], v[108:111], v[16:19]
    v_mfma_f32_16x16x32_bf16 v[20:23], a[132:135], v[108:111], v[20:23]
    s_waitcnt vmcnt(14)
    v_mfma_f32_16x16x32_bf16 v[16:19], a[136:139], v[112:115], v[16:19]
    v_mfma_f32_16x16x32_bf16 v[20:23], a[140:143], v[112:115], v[20:23]
    s_waitcnt vmcnt(13)
    v_mfma_f32_16x16x32_bf16 v[16:19], a[144:147], v[116:119], v[16:19]
    v_mfma_f32_16x16x32_bf16 v[20:23], a[148:151], v[116:119], v[20:23]
    s_waitcnt vmcnt(12)
    v_mfma_f32_16x16x32_bf16 v[16:19], a[152:155], v[120:123], v[16:19]
    v_mfma_f32_16x16x32_bf16 v[20:23], a[156:159], v[120:123], v[20:23]
    s_waitcnt vmcnt(11)
    v_mfma_f32_16x16x32_bf16 v[16:19], a[160:163], v[124:127], v[16:19]
    v_mfma_f32_16x16x32_bf16 v[20:23], a[164:167], v[124:127], v[20:23]
    s_waitcnt vmcnt(10)
    v_mfma_f32_16x16x32_bf16 v[16:19], a[168:171], v[128:131], v[16:19]
    v_mfma_f32_16x16x32_bf16 v[20:23], a[172:175], v[128:131], v[20:23]
    s_waitcnt vmcnt(9)
    v_mfma_f32_16x16x32_bf16 v[16:19], a[176:179], v[132:135], v[16:19]
    v_mfma_f32_16x16x32_bf16 v[20:23], a[180:183], v[132:135], v[20:23]
    s_waitcnt vmcnt(8)
    v_mfma_f32_16x16x32_bf16 v[16:19], a[184:187], v[136:139], v[16:19]
    v_mfma_f32_16x16x32_bf16 v[20:23], a[188:191], v[136:139], v[20:23]
    s_waitcnt vmcnt(7)
    v_mfma_f32_16x16x32_bf16 v[16:19], a[192:195], v[140:143], v[16:19]
    v_mfma_f32_16x16x32_bf16 v[20:23], a[196:199], v[140:143], v[20:23]
    s_waitcnt vmcnt(6)
    v_mfma_f32_16x16x32_bf16 v[16:19], a[200:203], v[144:147], v[16:19]
    v_mfma_f32_16x16x32_bf16 v[20:23], a[204:207], v[144:147], v[20:23]
    s_waitcnt vmcnt(5)
    v_mfma_f32_16x16x32_bf16 v[16:19], a[208:211], v[148:151], v[16:19]
    v_mfma_f32_16x16x32_bf16 v[20:23], a[212:215], v[148:151], v[20:23]
    s_waitcnt vmcnt(4)
    v_mfma_f32_16x16x32_bf16 v[16:19], a[216:219], v[152:155], v[16:19]
    v_mfma_f32_16x16x32_bf16 v[20:23], a[220:223], v[152:155], v[20:23]
    s_waitcnt vmcnt(3)
    v_mfma_f32_16x16x32_bf16 v[16:19], a[224:227], v[156:159], v[16:19]
    v_mfma_f32_16x16x32_bf16 v[20:23], a[228:231], v[156:159], v[20:23]
    s_waitcnt vmcnt(2)
    v_mfma_f32_16x16x32_bf16 v[16:19], a[232:235], v[160:163], v[16:19]
    v_mfma_f32_16x16x32_bf16 v[20:23], a[236:239], v[160:163], v[20:23]
    s_waitcnt vmcnt(1)
    v_mfma_f32_16x16x32_bf16 v[16:19], a[240:243], v[164:167], v[16:19]
    v_mfma_f32_16x16x32_bf16 v[20:23], a[244:247], v[164:167], v[20:23]
    s_waitcnt vmcnt(0)
    v_mfma_f32_16x16x32_bf16 v[16:19], a[248:251], v[168:171], v[16:19]
    v_mfma_f32_16x16x32_bf16 v[20:23], a[252:255], v[168:171], v[20:23]
    s_lshl_b32 s81, s60, 11
    s_add_u32 s81, s81, 131072
    v_add_u32 v8, s81, v7
    s_nop 0
    ds_write_b128 v8, v[16:19] offset:0
    s_nop 2
    ds_write_b128 v8, v[20:23] offset:1024
    s_waitcnt lgkmcnt(0)
    s_barrier
    s_cmp_ge_u32 s60, 1
    s_cbranch_scc1 L_g2_skip
    ds_read_b128 v[52:55], v8 offset:2048
    ds_read_b128 v[56:59], v8 offset:3072
    ds_read_b128 v[60:63], v8 offset:4096
    ds_read_b128 v[64:67], v8 offset:5120
    ds_read_b128 v[68:71], v8 offset:6144
    ds_read_b128 v[72:75], v8 offset:7168
    s_waitcnt lgkmcnt(0)
    v_add_f32 v44, v16, v52
    v_add_f32 v60, v60, v68
    v_add_f32 v45, v17, v53
    v_add_f32 v61, v61, v69
    v_add_f32 v46, v18, v54
    v_add_f32 v62, v62, v70
    v_add_f32 v47, v19, v55
    v_add_f32 v63, v63, v71
    v_add_f32 v48, v20, v56
    v_add_f32 v64, v64, v72
    v_add_f32 v49, v21, v57
    v_add_f32 v65, v65, v73
    v_add_f32 v50, v22, v58
    v_add_f32 v66, v66, v74
    v_add_f32 v51, v23, v59
    v_add_f32 v67, v67, v75
    v_add_f32 v44, v44, v60
    v_add_f32 v45, v45, v61
    v_add_f32 v46, v46, v62
    v_add_f32 v47, v47, v63
    v_add_f32 v48, v48, v64
    v_add_f32 v49, v49, v65
    v_add_f32 v50, v50, v66
    v_add_f32 v51, v51, v67
    v_lshlrev_b32 v32, 16, v40
    v_and_b32 v33, 0xffff0000, v40
    v_add_f32 v44, v44, v32
    v_add_f32 v45, v45, v33
    v_cvt_pk_bf16_f32 v76, v44, v45
    v_lshlrev_b32 v32, 16, v41
    v_and_b32 v33, 0xffff0000, v41
    v_add_f32 v46, v46, v32
    v_add_f32 v47, v47, v33
    v_cvt_pk_bf16_f32 v77, v46, v47
    v_lshlrev_b32 v32, 16, v42
    v_and_b32 v33, 0xffff0000, v42
    v_add_f32 v48, v48, v32
    v_add_f32 v49, v49, v33
    v_cvt_pk_bf16_f32 v78, v48, v49
    v_lshlrev_b32 v32, 16, v43
    v_and_b32 v33, 0xffff0000, v43
    v_add_f32 v50, v50, v32
    v_add_f32 v51, v51, v33
    v_cvt_pk_bf16_f32 v79, v50, v51
    buffer_store_dwordx4 v[76:79], v6, s[40:43], s36 offen
L_g2_skip:
    s_barrier
    s_add_u32 s85, s85, 7
    s_cmp_lt_u32 s85, 128
    s_cbranch_scc1 L_g2_seg
    s_endpgm
.section .rodata,"a"
.p2align 6
.amdhsa_kernel parallel_sum__memory_aug_recurrent_mem_tr__dense_activation_silu__prompt_kernel
  .amdhsa_next_free_vgpr 512
  .amdhsa_next_free_sgpr 102
  .amdhsa_accum_offset 256
  .amdhsa_group_segment_fixed_size 0
  .amdhsa_kernarg_size 104
  .amdhsa_user_sgpr_count 2
  .amdhsa_user_sgpr_kernarg_segment_ptr 1
  .amdhsa_system_sgpr_workgroup_id_x 1
.end_amdhsa_kernel
```
